```python
import torch

def _softmax(x, axis=-1):
    return torch.softmax(x, dim=axis)

def _gelu(x):
    return torch.nn.functional.gelu(x, approximate='tanh')

def _silu(x):
    return torch.nn.functional.silu(x)

def _sigmoid(x):
    return torch.sigmoid(x)

def _layernorm(x, axis=-1, eps=1e-05):
    m = x.mean(dim=axis, keepdim=True)
    v = x.var(dim=axis, keepdim=True, unbiased=False)
    return (x - m) / torch.sqrt(v + eps)

def _scatter_add(tgt, idx, src, axis=0):
    return tgt.clone().index_add_(axis, idx, src)

def _segment_sum(src, seg, n):
    out = torch.zeros((n,) + src.shape[1:], dtype=src.dtype)
    return out.index_add_(0, seg, src)

def _pad(x, pw):
    flat = tuple((v for pair in reversed(pw) for v in pair))
    return torch.nn.functional.pad(x, flat)
kernel_name = 'adaLN_cond__mha_block_cached__moe_arch_mod__prompt'

def setup_inputs():

    _w = lambda a: (lambda t: t.to(torch.bfloat16) if t.is_floating_point() else t)(torch.as_tensor(a))

    def _A_setup():
        B, Sq, D = (1, 2048, 512)
        H, Sk, Dh = (32, 2048, 128)
        return {'x': _w((lambda *s: torch.randn(*s, dtype=torch.bfloat16) * 0.1)(B, Sq, D)), 'k_cache': _w((lambda *s: torch.randn(*s, dtype=torch.bfloat16) * 0.8)(B, H, Sk, Dh)), 'v_cache': _w((lambda *s: torch.randn(*s, dtype=torch.bfloat16) * 1.6)(B, H, Sk, Dh)), 'wq': _w((lambda *s: torch.randn(*s, dtype=torch.bfloat16) * 0.8)(D, H * Dh) * D ** (-0.5)), 'wo': _w((lambda *s: torch.randn(*s, dtype=torch.bfloat16) * 1.6)(H * Dh, D) * (H * Dh) ** (-0.5))}
    _A_in = _A_setup()

    def _B_setup():
        B, S, D, F, C = (1, 2048, 512, 1792, 8)
        return {'x': _w((lambda *s: torch.randn(*s, dtype=torch.bfloat16) * 0.1)(B, S, D)), 'w_r': _w((lambda *s: torch.randn(*s, dtype=torch.bfloat16) * 3.2)(D)), 'w_gate': _w((lambda *s: torch.randn(*s, dtype=torch.bfloat16) * 3.2)(D, F)), 'w_up': _w((lambda *s: torch.randn(*s, dtype=torch.bfloat16) * 3.2)(D, F)), 'w_down': _w((lambda *s: torch.randn(*s, dtype=torch.bfloat16) * 3.2)(F, D))}
    _B_in = _B_setup()
    return {'A_x': _A_in['x'], 'A_k_cache': _A_in['k_cache'], 'A_v_cache': _A_in['v_cache'], 'A_wq': _A_in['wq'], 'A_wo': _A_in['wo'], 'B_x': _B_in['x'], 'B_w_r': _B_in['w_r'], 'B_w_gate': _B_in['w_gate'], 'B_w_up': _B_in['w_up'], 'B_w_down': _B_in['w_down'], 'c': _w((lambda *s: torch.randn(*s, dtype=torch.bfloat16) * 0.2)(1, 512) * 8.0), 'w_mod': _w((lambda *s: torch.randn(*s, dtype=torch.bfloat16) * 0.2)(512, 6 * 512) * 512 ** (-0.5) * 8.0)}

def reference(A_x, A_k_cache, A_v_cache, A_wq, A_wo, B_x, B_w_r, B_w_gate, B_w_up, B_w_down, c, w_mod):

    def _A_ref(x, k_cache, v_cache, wq, wo):
        B, Sq, D = x.shape
        H, Dh = (32, 128)
        q = (lambda x, *d: x.permute(*d))((x @ wq).reshape(B, Sq, H, Dh), 0, 2, 1, 3)
        scores = torch.einsum('bhqd,bhkd->bhqk', q, k_cache) * Dh ** (-0.5)
        p = _softmax(scores, axis=-1)
        o = torch.einsum('bhqk,bhkd->bhqd', p, v_cache)
        return (lambda x, *d: x.permute(*d))(o, 0, 2, 1, 3).reshape(B, Sq, H * Dh) @ wo

    def _B_ref(x, w_r, w_gate, w_up, w_down):
        B, S, D = x.shape
        C = 8
        r = x @ w_r
        idx = torch.argsort(-r, axis=-1)[:, :C]
        idx_e = (lambda x, n, axis: torch.repeat_interleave(x, n, dim=axis))(idx.reshape(B, C, 1), D, axis=2)
        x_sel = (lambda x, i, axis: torch.take_along_dim(x, i, dim=axis))(x, idx_e, axis=1)
        g = _silu(x_sel @ w_gate)
        u = x_sel @ w_up
        y = g * u @ w_down
        r_sel = _sigmoid((lambda x, i, axis: torch.take_along_dim(x, i, dim=axis))(r, idx, axis=1))
        y = y * r_sel.reshape(B, C, 1)
        b_off = (torch.arange(B) * S).reshape(B, 1)
        flat_idx = (idx + b_off).reshape(B * C)
        zero = (x * 0.0).reshape(B * S, D)
        upd = _scatter_add(zero, flat_idx, y.reshape(B * C, D), axis=0)
        return x + upd.reshape(B, S, D)
    x = A_x
    mod = (_silu(c) @ w_mod).reshape(c.shape[0], 6, 1, -1)
    sa, ca, ga, sb, cb, gb = (mod[:, 0].clone(), mod[:, 1].clone(), mod[:, 2].clone(), mod[:, 3].clone(), mod[:, 4].clone(), mod[:, 5].clone())
    h = _layernorm(x, axis=-1) * (1 + ca) + sa
    x = x + ga * _A_ref(h, A_k_cache, A_v_cache, A_wq, A_wo)
    h = _layernorm(x, axis=-1) * (1 + cb) + sb
    x = x + gb * _B_ref(h, B_w_r, B_w_gate, B_w_up, B_w_down)
    return x
```

```asm
; @launch kernel=k1_mod_kernel grid=(48,1,1) block=(256,1,1) lds=8192
; @launch kernel=k2_ln1_kernel grid=(256,1,1) block=(512,1,1) lds=0
; @launch kernel=k3_attn_kernel grid=(256,1,1) block=(512,1,1) lds=163840
; @launch kernel=k5_tail_kernel grid=(256,1,1) block=(640,1,1) lds=107520
.amdgcn_target "amdgcn-amd-amdhsa--gfx950"
.text
.globl k1_mod_kernel
.p2align 8
.type k1_mod_kernel,@function
k1_mod_kernel:
    s_cmp_ge_u32 s2, 48
    s_cbranch_scc1 L_k1_done
    s_load_dwordx4 s[4:7], s[0:1], 80
    s_load_dwordx2 s[20:21], s[0:1], 112
    v_and_b32 v1, 7, v0
    v_lshrrev_b32 v2, 3, v0
    s_waitcnt lgkmcnt(0)
    s_mov_b32 s8, s4
    s_mov_b32 s9, s5
    s_mov_b32 s10, 0x400
    s_mov_b32 s11, 0x00020000
    s_mov_b32 s12, s6
    s_mov_b32 s13, s7
    s_mov_b32 s14, 0x300000
    s_mov_b32 s15, 0x00020000
    s_mov_b32 s16, s20
    s_mov_b32 s17, s21
    s_mov_b32 s18, 0x3000
    s_mov_b32 s19, 0x00020000
    s_cmp_lg_u32 s2, 0
    s_cbranch_scc1 L_k1_noflag
    s_add_u32 s28, s20, 0x40000
    s_addc_u32 s29, s21, 0
    s_mov_b32 s30, 0x9000
    s_mov_b32 s31, 0x00020000
    v_lshlrev_b32 v3, 6, v0
    v_mov_b32 v4, 0
    buffer_store_dword v4, v3, s[28:31], 0 offen
    s_mov_b32 s22, 20480
    buffer_store_dword v4, v3, s[28:31], s22 offen
    v_and_b32 v3, 0xfff, v3
    s_mov_b32 s22, 16384
    buffer_store_dword v4, v3, s[28:31], s22 offen
L_k1_noflag:
    v_lshlrev_b32 v3, 5, v2
    buffer_load_dwordx4 v[8:11], v3, s[8:11], 0 offen
    buffer_load_dwordx4 v[12:15], v3, s[8:11], 0 offen offset:16
    s_mov_b32 s22, 98304
    v_mul_lo_u32 v4, v2, s22
    v_lshlrev_b32 v5, 4, v1
    v_add_u32 v4, v4, v5
    s_lshl_b32 s23, s2, 7
    v_add_u32 v4, s23, v4
    s_mov_b32 s24, 0
    buffer_load_dwordx4 v[32:35], v4, s[12:15], s24 offen
    s_mov_b32 s24, 6144
    buffer_load_dwordx4 v[36:39], v4, s[12:15], s24 offen
    s_mov_b32 s24, 12288
    buffer_load_dwordx4 v[40:43], v4, s[12:15], s24 offen
    s_mov_b32 s24, 18432
    buffer_load_dwordx4 v[44:47], v4, s[12:15], s24 offen
    s_mov_b32 s24, 24576
    buffer_load_dwordx4 v[48:51], v4, s[12:15], s24 offen
    s_mov_b32 s24, 30720
    buffer_load_dwordx4 v[52:55], v4, s[12:15], s24 offen
    s_mov_b32 s24, 36864
    buffer_load_dwordx4 v[56:59], v4, s[12:15], s24 offen
    s_mov_b32 s24, 43008
    buffer_load_dwordx4 v[60:63], v4, s[12:15], s24 offen
    s_mov_b32 s24, 49152
    buffer_load_dwordx4 v[64:67], v4, s[12:15], s24 offen
    s_mov_b32 s24, 55296
    buffer_load_dwordx4 v[68:71], v4, s[12:15], s24 offen
    s_mov_b32 s24, 61440
    buffer_load_dwordx4 v[72:75], v4, s[12:15], s24 offen
    s_mov_b32 s24, 67584
    buffer_load_dwordx4 v[76:79], v4, s[12:15], s24 offen
    s_mov_b32 s24, 73728
    buffer_load_dwordx4 v[80:83], v4, s[12:15], s24 offen
    s_mov_b32 s24, 79872
    buffer_load_dwordx4 v[84:87], v4, s[12:15], s24 offen
    s_mov_b32 s24, 86016
    buffer_load_dwordx4 v[88:91], v4, s[12:15], s24 offen
    s_mov_b32 s24, 92160
    buffer_load_dwordx4 v[92:95], v4, s[12:15], s24 offen
    s_waitcnt vmcnt(16)
    v_lshlrev_b32 v16, 16, v8
    v_and_b32 v17, 0xffff0000, v8
    v_lshlrev_b32 v18, 16, v9
    v_and_b32 v19, 0xffff0000, v9
    v_lshlrev_b32 v20, 16, v10
    v_and_b32 v21, 0xffff0000, v10
    v_lshlrev_b32 v22, 16, v11
    v_and_b32 v23, 0xffff0000, v11
    v_lshlrev_b32 v24, 16, v12
    v_and_b32 v25, 0xffff0000, v12
    v_lshlrev_b32 v26, 16, v13
    v_and_b32 v27, 0xffff0000, v13
    v_lshlrev_b32 v28, 16, v14
    v_and_b32 v29, 0xffff0000, v14
    v_lshlrev_b32 v30, 16, v15
    v_and_b32 v31, 0xffff0000, v15
    v_mul_f32 v104, 0xbfb8aa3b, v16
    v_exp_f32 v104, v104
    s_nop 0
    v_add_f32 v104, 1.0, v104
    v_rcp_f32 v104, v104
    s_nop 0
    v_mul_f32 v16, v16, v104
    v_cvt_pk_bf16_f32 v16, v16, v16
    v_lshlrev_b32 v16, 16, v16
    v_mul_f32 v104, 0xbfb8aa3b, v17
    v_exp_f32 v104, v104
    s_nop 0
    v_add_f32 v104, 1.0, v104
    v_rcp_f32 v104, v104
    s_nop 0
    v_mul_f32 v17, v17, v104
    v_cvt_pk_bf16_f32 v17, v17, v17
    v_lshlrev_b32 v17, 16, v17
    v_mul_f32 v104, 0xbfb8aa3b, v18
    v_exp_f32 v104, v104
    s_nop 0
    v_add_f32 v104, 1.0, v104
    v_rcp_f32 v104, v104
    s_nop 0
    v_mul_f32 v18, v18, v104
    v_cvt_pk_bf16_f32 v18, v18, v18
    v_lshlrev_b32 v18, 16, v18
    v_mul_f32 v104, 0xbfb8aa3b, v19
    v_exp_f32 v104, v104
    s_nop 0
    v_add_f32 v104, 1.0, v104
    v_rcp_f32 v104, v104
    s_nop 0
    v_mul_f32 v19, v19, v104
    v_cvt_pk_bf16_f32 v19, v19, v19
    v_lshlrev_b32 v19, 16, v19
    v_mul_f32 v104, 0xbfb8aa3b, v20
    v_exp_f32 v104, v104
    s_nop 0
    v_add_f32 v104, 1.0, v104
    v_rcp_f32 v104, v104
    s_nop 0
    v_mul_f32 v20, v20, v104
    v_cvt_pk_bf16_f32 v20, v20, v20
    v_lshlrev_b32 v20, 16, v20
    v_mul_f32 v104, 0xbfb8aa3b, v21
    v_exp_f32 v104, v104
    s_nop 0
    v_add_f32 v104, 1.0, v104
    v_rcp_f32 v104, v104
    s_nop 0
    v_mul_f32 v21, v21, v104
    v_cvt_pk_bf16_f32 v21, v21, v21
    v_lshlrev_b32 v21, 16, v21
    v_mul_f32 v104, 0xbfb8aa3b, v22
    v_exp_f32 v104, v104
    s_nop 0
    v_add_f32 v104, 1.0, v104
    v_rcp_f32 v104, v104
    s_nop 0
    v_mul_f32 v22, v22, v104
    v_cvt_pk_bf16_f32 v22, v22, v22
    v_lshlrev_b32 v22, 16, v22
    v_mul_f32 v104, 0xbfb8aa3b, v23
    v_exp_f32 v104, v104
    s_nop 0
    v_add_f32 v104, 1.0, v104
    v_rcp_f32 v104, v104
    s_nop 0
    v_mul_f32 v23, v23, v104
    v_cvt_pk_bf16_f32 v23, v23, v23
    v_lshlrev_b32 v23, 16, v23
    v_mul_f32 v104, 0xbfb8aa3b, v24
    v_exp_f32 v104, v104
    s_nop 0
    v_add_f32 v104, 1.0, v104
    v_rcp_f32 v104, v104
    s_nop 0
    v_mul_f32 v24, v24, v104
    v_cvt_pk_bf16_f32 v24, v24, v24
    v_lshlrev_b32 v24, 16, v24
    v_mul_f32 v104, 0xbfb8aa3b, v25
    v_exp_f32 v104, v104
    s_nop 0
    v_add_f32 v104, 1.0, v104
    v_rcp_f32 v104, v104
    s_nop 0
    v_mul_f32 v25, v25, v104
    v_cvt_pk_bf16_f32 v25, v25, v25
    v_lshlrev_b32 v25, 16, v25
    v_mul_f32 v104, 0xbfb8aa3b, v26
    v_exp_f32 v104, v104
    s_nop 0
    v_add_f32 v104, 1.0, v104
    v_rcp_f32 v104, v104
    s_nop 0
    v_mul_f32 v26, v26, v104
    v_cvt_pk_bf16_f32 v26, v26, v26
    v_lshlrev_b32 v26, 16, v26
    v_mul_f32 v104, 0xbfb8aa3b, v27
    v_exp_f32 v104, v104
    s_nop 0
    v_add_f32 v104, 1.0, v104
    v_rcp_f32 v104, v104
    s_nop 0
    v_mul_f32 v27, v27, v104
    v_cvt_pk_bf16_f32 v27, v27, v27
    v_lshlrev_b32 v27, 16, v27
    v_mul_f32 v104, 0xbfb8aa3b, v28
    v_exp_f32 v104, v104
    s_nop 0
    v_add_f32 v104, 1.0, v104
    v_rcp_f32 v104, v104
    s_nop 0
    v_mul_f32 v28, v28, v104
    v_cvt_pk_bf16_f32 v28, v28, v28
    v_lshlrev_b32 v28, 16, v28
    v_mul_f32 v104, 0xbfb8aa3b, v29
    v_exp_f32 v104, v104
    s_nop 0
    v_add_f32 v104, 1.0, v104
    v_rcp_f32 v104, v104
    s_nop 0
    v_mul_f32 v29, v29, v104
    v_cvt_pk_bf16_f32 v29, v29, v29
    v_lshlrev_b32 v29, 16, v29
    v_mul_f32 v104, 0xbfb8aa3b, v30
    v_exp_f32 v104, v104
    s_nop 0
    v_add_f32 v104, 1.0, v104
    v_rcp_f32 v104, v104
    s_nop 0
    v_mul_f32 v30, v30, v104
    v_cvt_pk_bf16_f32 v30, v30, v30
    v_lshlrev_b32 v30, 16, v30
    v_mul_f32 v104, 0xbfb8aa3b, v31
    v_exp_f32 v104, v104
    s_nop 0
    v_add_f32 v104, 1.0, v104
    v_rcp_f32 v104, v104
    s_nop 0
    v_mul_f32 v31, v31, v104
    v_cvt_pk_bf16_f32 v31, v31, v31
    v_lshlrev_b32 v31, 16, v31
    v_mov_b32 v96, 0
    v_mov_b32 v97, 0
    v_mov_b32 v98, 0
    v_mov_b32 v99, 0
    v_mov_b32 v100, 0
    v_mov_b32 v101, 0
    v_mov_b32 v102, 0
    v_mov_b32 v103, 0
    s_waitcnt vmcnt(15)
    v_lshlrev_b32 v104, 16, v32
    v_and_b32 v105, 0xffff0000, v32
    v_fmac_f32 v96, v16, v104
    v_fmac_f32 v97, v16, v105
    v_lshlrev_b32 v104, 16, v33
    v_and_b32 v105, 0xffff0000, v33
    v_fmac_f32 v98, v16, v104
    v_fmac_f32 v99, v16, v105
    v_lshlrev_b32 v104, 16, v34
    v_and_b32 v105, 0xffff0000, v34
    v_fmac_f32 v100, v16, v104
    v_fmac_f32 v101, v16, v105
    v_lshlrev_b32 v104, 16, v35
    v_and_b32 v105, 0xffff0000, v35
    v_fmac_f32 v102, v16, v104
    v_fmac_f32 v103, v16, v105
    s_waitcnt vmcnt(14)
    v_lshlrev_b32 v104, 16, v36
    v_and_b32 v105, 0xffff0000, v36
    v_fmac_f32 v96, v17, v104
    v_fmac_f32 v97, v17, v105
    v_lshlrev_b32 v104, 16, v37
    v_and_b32 v105, 0xffff0000, v37
    v_fmac_f32 v98, v17, v104
    v_fmac_f32 v99, v17, v105
    v_lshlrev_b32 v104, 16, v38
    v_and_b32 v105, 0xffff0000, v38
    v_fmac_f32 v100, v17, v104
    v_fmac_f32 v101, v17, v105
    v_lshlrev_b32 v104, 16, v39
    v_and_b32 v105, 0xffff0000, v39
    v_fmac_f32 v102, v17, v104
    v_fmac_f32 v103, v17, v105
    s_waitcnt vmcnt(13)
    v_lshlrev_b32 v104, 16, v40
    v_and_b32 v105, 0xffff0000, v40
    v_fmac_f32 v96, v18, v104
    v_fmac_f32 v97, v18, v105
    v_lshlrev_b32 v104, 16, v41
    v_and_b32 v105, 0xffff0000, v41
    v_fmac_f32 v98, v18, v104
    v_fmac_f32 v99, v18, v105
    v_lshlrev_b32 v104, 16, v42
    v_and_b32 v105, 0xffff0000, v42
    v_fmac_f32 v100, v18, v104
    v_fmac_f32 v101, v18, v105
    v_lshlrev_b32 v104, 16, v43
    v_and_b32 v105, 0xffff0000, v43
    v_fmac_f32 v102, v18, v104
    v_fmac_f32 v103, v18, v105
    s_waitcnt vmcnt(12)
    v_lshlrev_b32 v104, 16, v44
    v_and_b32 v105, 0xffff0000, v44
    v_fmac_f32 v96, v19, v104
    v_fmac_f32 v97, v19, v105
    v_lshlrev_b32 v104, 16, v45
    v_and_b32 v105, 0xffff0000, v45
    v_fmac_f32 v98, v19, v104
    v_fmac_f32 v99, v19, v105
    v_lshlrev_b32 v104, 16, v46
    v_and_b32 v105, 0xffff0000, v46
    v_fmac_f32 v100, v19, v104
    v_fmac_f32 v101, v19, v105
    v_lshlrev_b32 v104, 16, v47
    v_and_b32 v105, 0xffff0000, v47
    v_fmac_f32 v102, v19, v104
    v_fmac_f32 v103, v19, v105
    s_waitcnt vmcnt(11)
    v_lshlrev_b32 v104, 16, v48
    v_and_b32 v105, 0xffff0000, v48
    v_fmac_f32 v96, v20, v104
    v_fmac_f32 v97, v20, v105
    v_lshlrev_b32 v104, 16, v49
    v_and_b32 v105, 0xffff0000, v49
    v_fmac_f32 v98, v20, v104
    v_fmac_f32 v99, v20, v105
    v_lshlrev_b32 v104, 16, v50
    v_and_b32 v105, 0xffff0000, v50
    v_fmac_f32 v100, v20, v104
    v_fmac_f32 v101, v20, v105
    v_lshlrev_b32 v104, 16, v51
    v_and_b32 v105, 0xffff0000, v51
    v_fmac_f32 v102, v20, v104
    v_fmac_f32 v103, v20, v105
    s_waitcnt vmcnt(10)
    v_lshlrev_b32 v104, 16, v52
    v_and_b32 v105, 0xffff0000, v52
    v_fmac_f32 v96, v21, v104
    v_fmac_f32 v97, v21, v105
    v_lshlrev_b32 v104, 16, v53
    v_and_b32 v105, 0xffff0000, v53
    v_fmac_f32 v98, v21, v104
    v_fmac_f32 v99, v21, v105
    v_lshlrev_b32 v104, 16, v54
    v_and_b32 v105, 0xffff0000, v54
    v_fmac_f32 v100, v21, v104
    v_fmac_f32 v101, v21, v105
    v_lshlrev_b32 v104, 16, v55
    v_and_b32 v105, 0xffff0000, v55
    v_fmac_f32 v102, v21, v104
    v_fmac_f32 v103, v21, v105
    s_waitcnt vmcnt(9)
    v_lshlrev_b32 v104, 16, v56
    v_and_b32 v105, 0xffff0000, v56
    v_fmac_f32 v96, v22, v104
    v_fmac_f32 v97, v22, v105
    v_lshlrev_b32 v104, 16, v57
    v_and_b32 v105, 0xffff0000, v57
    v_fmac_f32 v98, v22, v104
    v_fmac_f32 v99, v22, v105
    v_lshlrev_b32 v104, 16, v58
    v_and_b32 v105, 0xffff0000, v58
    v_fmac_f32 v100, v22, v104
    v_fmac_f32 v101, v22, v105
    v_lshlrev_b32 v104, 16, v59
    v_and_b32 v105, 0xffff0000, v59
    v_fmac_f32 v102, v22, v104
    v_fmac_f32 v103, v22, v105
    s_waitcnt vmcnt(8)
    v_lshlrev_b32 v104, 16, v60
    v_and_b32 v105, 0xffff0000, v60
    v_fmac_f32 v96, v23, v104
    v_fmac_f32 v97, v23, v105
    v_lshlrev_b32 v104, 16, v61
    v_and_b32 v105, 0xffff0000, v61
    v_fmac_f32 v98, v23, v104
    v_fmac_f32 v99, v23, v105
    v_lshlrev_b32 v104, 16, v62
    v_and_b32 v105, 0xffff0000, v62
    v_fmac_f32 v100, v23, v104
    v_fmac_f32 v101, v23, v105
    v_lshlrev_b32 v104, 16, v63
    v_and_b32 v105, 0xffff0000, v63
    v_fmac_f32 v102, v23, v104
    v_fmac_f32 v103, v23, v105
    s_waitcnt vmcnt(7)
    v_lshlrev_b32 v104, 16, v64
    v_and_b32 v105, 0xffff0000, v64
    v_fmac_f32 v96, v24, v104
    v_fmac_f32 v97, v24, v105
    v_lshlrev_b32 v104, 16, v65
    v_and_b32 v105, 0xffff0000, v65
    v_fmac_f32 v98, v24, v104
    v_fmac_f32 v99, v24, v105
    v_lshlrev_b32 v104, 16, v66
    v_and_b32 v105, 0xffff0000, v66
    v_fmac_f32 v100, v24, v104
    v_fmac_f32 v101, v24, v105
    v_lshlrev_b32 v104, 16, v67
    v_and_b32 v105, 0xffff0000, v67
    v_fmac_f32 v102, v24, v104
    v_fmac_f32 v103, v24, v105
    s_waitcnt vmcnt(6)
    v_lshlrev_b32 v104, 16, v68
    v_and_b32 v105, 0xffff0000, v68
    v_fmac_f32 v96, v25, v104
    v_fmac_f32 v97, v25, v105
    v_lshlrev_b32 v104, 16, v69
    v_and_b32 v105, 0xffff0000, v69
    v_fmac_f32 v98, v25, v104
    v_fmac_f32 v99, v25, v105
    v_lshlrev_b32 v104, 16, v70
    v_and_b32 v105, 0xffff0000, v70
    v_fmac_f32 v100, v25, v104
    v_fmac_f32 v101, v25, v105
    v_lshlrev_b32 v104, 16, v71
    v_and_b32 v105, 0xffff0000, v71
    v_fmac_f32 v102, v25, v104
    v_fmac_f32 v103, v25, v105
    s_waitcnt vmcnt(5)
    v_lshlrev_b32 v104, 16, v72
    v_and_b32 v105, 0xffff0000, v72
    v_fmac_f32 v96, v26, v104
    v_fmac_f32 v97, v26, v105
    v_lshlrev_b32 v104, 16, v73
    v_and_b32 v105, 0xffff0000, v73
    v_fmac_f32 v98, v26, v104
    v_fmac_f32 v99, v26, v105
    v_lshlrev_b32 v104, 16, v74
    v_and_b32 v105, 0xffff0000, v74
    v_fmac_f32 v100, v26, v104
    v_fmac_f32 v101, v26, v105
    v_lshlrev_b32 v104, 16, v75
    v_and_b32 v105, 0xffff0000, v75
    v_fmac_f32 v102, v26, v104
    v_fmac_f32 v103, v26, v105
    s_waitcnt vmcnt(4)
    v_lshlrev_b32 v104, 16, v76
    v_and_b32 v105, 0xffff0000, v76
    v_fmac_f32 v96, v27, v104
    v_fmac_f32 v97, v27, v105
    v_lshlrev_b32 v104, 16, v77
    v_and_b32 v105, 0xffff0000, v77
    v_fmac_f32 v98, v27, v104
    v_fmac_f32 v99, v27, v105
    v_lshlrev_b32 v104, 16, v78
    v_and_b32 v105, 0xffff0000, v78
    v_fmac_f32 v100, v27, v104
    v_fmac_f32 v101, v27, v105
    v_lshlrev_b32 v104, 16, v79
    v_and_b32 v105, 0xffff0000, v79
    v_fmac_f32 v102, v27, v104
    v_fmac_f32 v103, v27, v105
    s_waitcnt vmcnt(3)
    v_lshlrev_b32 v104, 16, v80
    v_and_b32 v105, 0xffff0000, v80
    v_fmac_f32 v96, v28, v104
    v_fmac_f32 v97, v28, v105
    v_lshlrev_b32 v104, 16, v81
    v_and_b32 v105, 0xffff0000, v81
    v_fmac_f32 v98, v28, v104
    v_fmac_f32 v99, v28, v105
    v_lshlrev_b32 v104, 16, v82
    v_and_b32 v105, 0xffff0000, v82
    v_fmac_f32 v100, v28, v104
    v_fmac_f32 v101, v28, v105
    v_lshlrev_b32 v104, 16, v83
    v_and_b32 v105, 0xffff0000, v83
    v_fmac_f32 v102, v28, v104
    v_fmac_f32 v103, v28, v105
    s_waitcnt vmcnt(2)
    v_lshlrev_b32 v104, 16, v84
    v_and_b32 v105, 0xffff0000, v84
    v_fmac_f32 v96, v29, v104
    v_fmac_f32 v97, v29, v105
    v_lshlrev_b32 v104, 16, v85
    v_and_b32 v105, 0xffff0000, v85
    v_fmac_f32 v98, v29, v104
    v_fmac_f32 v99, v29, v105
    v_lshlrev_b32 v104, 16, v86
    v_and_b32 v105, 0xffff0000, v86
    v_fmac_f32 v100, v29, v104
    v_fmac_f32 v101, v29, v105
    v_lshlrev_b32 v104, 16, v87
    v_and_b32 v105, 0xffff0000, v87
    v_fmac_f32 v102, v29, v104
    v_fmac_f32 v103, v29, v105
    s_waitcnt vmcnt(1)
    v_lshlrev_b32 v104, 16, v88
    v_and_b32 v105, 0xffff0000, v88
    v_fmac_f32 v96, v30, v104
    v_fmac_f32 v97, v30, v105
    v_lshlrev_b32 v104, 16, v89
    v_and_b32 v105, 0xffff0000, v89
    v_fmac_f32 v98, v30, v104
    v_fmac_f32 v99, v30, v105
    v_lshlrev_b32 v104, 16, v90
    v_and_b32 v105, 0xffff0000, v90
    v_fmac_f32 v100, v30, v104
    v_fmac_f32 v101, v30, v105
    v_lshlrev_b32 v104, 16, v91
    v_and_b32 v105, 0xffff0000, v91
    v_fmac_f32 v102, v30, v104
    v_fmac_f32 v103, v30, v105
    s_waitcnt vmcnt(0)
    v_lshlrev_b32 v104, 16, v92
    v_and_b32 v105, 0xffff0000, v92
    v_fmac_f32 v96, v31, v104
    v_fmac_f32 v97, v31, v105
    v_lshlrev_b32 v104, 16, v93
    v_and_b32 v105, 0xffff0000, v93
    v_fmac_f32 v98, v31, v104
    v_fmac_f32 v99, v31, v105
    v_lshlrev_b32 v104, 16, v94
    v_and_b32 v105, 0xffff0000, v94
    v_fmac_f32 v100, v31, v104
    v_fmac_f32 v101, v31, v105
    v_lshlrev_b32 v104, 16, v95
    v_and_b32 v105, 0xffff0000, v95
    v_fmac_f32 v102, v31, v104
    v_fmac_f32 v103, v31, v105
    v_lshlrev_b32 v6, 8, v2
    v_lshlrev_b32 v7, 5, v1
    v_add_u32 v6, v6, v7
    ds_write_b128 v6, v[96:99]
    ds_write_b128 v6, v[100:103] offset:16
    s_waitcnt lgkmcnt(0)
    s_barrier
    v_cmp_gt_u32 vcc, 64, v0
    s_and_saveexec_b64 s[26:27], vcc
    s_cbranch_execz L_k1_done
    v_lshlrev_b32 v6, 2, v0
    ds_read_b32 v32, v6 offset:0
    ds_read_b32 v33, v6 offset:256
    ds_read_b32 v34, v6 offset:512
    ds_read_b32 v35, v6 offset:768
    ds_read_b32 v36, v6 offset:1024
    ds_read_b32 v37, v6 offset:1280
    ds_read_b32 v38, v6 offset:1536
    ds_read_b32 v39, v6 offset:1792
    ds_read_b32 v40, v6 offset:2048
    ds_read_b32 v41, v6 offset:2304
    ds_read_b32 v42, v6 offset:2560
    ds_read_b32 v43, v6 offset:2816
    ds_read_b32 v44, v6 offset:3072
    ds_read_b32 v45, v6 offset:3328
    ds_read_b32 v46, v6 offset:3584
    ds_read_b32 v47, v6 offset:3840
    ds_read_b32 v48, v6 offset:4096
    ds_read_b32 v49, v6 offset:4352
    ds_read_b32 v50, v6 offset:4608
    ds_read_b32 v51, v6 offset:4864
    ds_read_b32 v52, v6 offset:5120
    ds_read_b32 v53, v6 offset:5376
    ds_read_b32 v54, v6 offset:5632
    ds_read_b32 v55, v6 offset:5888
    ds_read_b32 v56, v6 offset:6144
    ds_read_b32 v57, v6 offset:6400
    ds_read_b32 v58, v6 offset:6656
    ds_read_b32 v59, v6 offset:6912
    ds_read_b32 v60, v6 offset:7168
    ds_read_b32 v61, v6 offset:7424
    ds_read_b32 v62, v6 offset:7680
    ds_read_b32 v63, v6 offset:7936
    s_waitcnt lgkmcnt(0)
    v_add_f32 v32, v32, v33
    v_add_f32 v32, v32, v34
    v_add_f32 v32, v32, v35
    v_add_f32 v32, v32, v36
    v_add_f32 v32, v32, v37
    v_add_f32 v32, v32, v38
    v_add_f32 v32, v32, v39
    v_add_f32 v32, v32, v40
    v_add_f32 v32, v32, v41
    v_add_f32 v32, v32, v42
    v_add_f32 v32, v32, v43
    v_add_f32 v32, v32, v44
    v_add_f32 v32, v32, v45
    v_add_f32 v32, v32, v46
    v_add_f32 v32, v32, v47
    v_add_f32 v32, v32, v48
    v_add_f32 v32, v32, v49
    v_add_f32 v32, v32, v50
    v_add_f32 v32, v32, v51
    v_add_f32 v32, v32, v52
    v_add_f32 v32, v32, v53
    v_add_f32 v32, v32, v54
    v_add_f32 v32, v32, v55
    v_add_f32 v32, v32, v56
    v_add_f32 v32, v32, v57
    v_add_f32 v32, v32, v58
    v_add_f32 v32, v32, v59
    v_add_f32 v32, v32, v60
    v_add_f32 v32, v32, v61
    v_add_f32 v32, v32, v62
    v_add_f32 v32, v32, v63
    v_cvt_pk_bf16_f32 v32, v32, v32
    v_lshlrev_b32 v32, 16, v32
    s_lshl_b32 s23, s2, 8
    v_add_u32 v6, s23, v6
    buffer_store_dword v32, v6, s[16:19], 0 offen
L_k1_done:
    s_endpgm
.globl k2_ln1_kernel
.p2align 8
.type k2_ln1_kernel,@function
k2_ln1_kernel:
    s_cmp_ge_u32 s2, 256
    s_cbranch_scc1 L_k2_done
    s_load_dwordx2 s[4:5], s[0:1], 0
    s_load_dwordx2 s[20:21], s[0:1], 112
    v_and_b32 v1, 63, v0
    v_lshrrev_b32 v2, 6, v0
    s_waitcnt lgkmcnt(0)
    s_mov_b32 s8, s4
    s_mov_b32 s9, s5
    s_mov_b32 s10, 0x200000
    s_mov_b32 s11, 0x00020000
    s_mov_b32 s12, s20
    s_mov_b32 s13, s21
    s_mov_b32 s14, 0x3000
    s_mov_b32 s15, 0x00020000
    s_add_u32 s16, s20, 0x100000
    s_addc_u32 s17, s21, 0
    s_mov_b32 s18, 0x200000
    s_mov_b32 s19, 0x00020000
    s_lshl_b32 s22, s2, 13
    v_lshlrev_b32 v3, 10, v2
    v_lshlrev_b32 v4, 4, v1
    v_add3_u32 v3, v3, v4, s22
    buffer_load_dwordx4 v[8:11], v3, s[8:11], 0 offen
    v_lshlrev_b32 v5, 5, v1
    buffer_load_dwordx4 v[24:27], v5, s[12:15], 0 offen
    buffer_load_dwordx4 v[28:31], v5, s[12:15], 0 offen offset:16
    buffer_load_dwordx4 v[32:35], v5, s[12:15], 0 offen offset:2048
    buffer_load_dwordx4 v[36:39], v5, s[12:15], 0 offen offset:2064
    s_waitcnt vmcnt(4)
    v_lshlrev_b32 v16, 16, v8
    v_and_b32 v17, 0xffff0000, v8
    v_lshlrev_b32 v18, 16, v9
    v_and_b32 v19, 0xffff0000, v9
    v_lshlrev_b32 v20, 16, v10
    v_and_b32 v21, 0xffff0000, v10
    v_lshlrev_b32 v22, 16, v11
    v_and_b32 v23, 0xffff0000, v11
    v_add_f32 v40, v16, v17
    v_add_f32 v40, v40, v18
    v_add_f32 v40, v40, v19
    v_add_f32 v40, v40, v20
    v_add_f32 v40, v40, v21
    v_add_f32 v40, v40, v22
    v_add_f32 v40, v40, v23
    s_nop 1
    v_add_f32_dpp v41, v40, v40 quad_perm:[1,0,3,2] row_mask:0xf bank_mask:0xf
    v_mov_b32 v40, v41
    s_nop 1
    v_add_f32_dpp v41, v40, v40 quad_perm:[2,3,0,1] row_mask:0xf bank_mask:0xf
    v_mov_b32 v40, v41
    s_nop 1
    v_add_f32_dpp v41, v40, v40 row_half_mirror row_mask:0xf bank_mask:0xf
    v_mov_b32 v40, v41
    s_nop 1
    v_add_f32_dpp v41, v40, v40 row_mirror row_mask:0xf bank_mask:0xf
    v_mov_b32 v40, v41
    ds_swizzle_b32 v41, v40 offset:0x401F
    s_waitcnt lgkmcnt(0)
    v_add_f32 v40, v40, v41
    v_mov_b32 v41, v40
    s_nop 1
    v_permlane32_swap_b32 v40, v41
    s_nop 1
    v_add_f32 v40, v40, v41
    v_mul_f32 v42, 0x3b000000, v40
    v_mov_b32 v43, v42
    v_cvt_pk_bf16_f32 v43, v43, v43
    v_lshlrev_b32 v43, 16, v43
    v_mov_b32 v40, 0
    v_sub_f32 v46, v16, v42
    v_fmac_f32 v40, v46, v46
    v_sub_f32 v46, v17, v42
    v_fmac_f32 v40, v46, v46
    v_sub_f32 v46, v18, v42
    v_fmac_f32 v40, v46, v46
    v_sub_f32 v46, v19, v42
    v_fmac_f32 v40, v46, v46
    v_sub_f32 v46, v20, v42
    v_fmac_f32 v40, v46, v46
    v_sub_f32 v46, v21, v42
    v_fmac_f32 v40, v46, v46
    v_sub_f32 v46, v22, v42
    v_fmac_f32 v40, v46, v46
    v_sub_f32 v46, v23, v42
    v_fmac_f32 v40, v46, v46
    s_nop 1
    v_add_f32_dpp v41, v40, v40 quad_perm:[1,0,3,2] row_mask:0xf bank_mask:0xf
    v_mov_b32 v40, v41
    s_nop 1
    v_add_f32_dpp v41, v40, v40 quad_perm:[2,3,0,1] row_mask:0xf bank_mask:0xf
    v_mov_b32 v40, v41
    s_nop 1
    v_add_f32_dpp v41, v40, v40 row_half_mirror row_mask:0xf bank_mask:0xf
    v_mov_b32 v40, v41
    s_nop 1
    v_add_f32_dpp v41, v40, v40 row_mirror row_mask:0xf bank_mask:0xf
    v_mov_b32 v40, v41
    ds_swizzle_b32 v41, v40 offset:0x401F
    s_waitcnt lgkmcnt(0)
    v_add_f32 v40, v40, v41
    v_mov_b32 v41, v40
    s_nop 1
    v_permlane32_swap_b32 v40, v41
    s_nop 1
    v_add_f32 v40, v40, v41
    v_mul_f32 v44, 0x3b000000, v40
    v_cvt_pk_bf16_f32 v44, v44, v44
    v_lshlrev_b32 v44, 16, v44
    v_add_f32 v44, 0x3727c5ac, v44
    v_cvt_pk_bf16_f32 v44, v44, v44
    v_lshlrev_b32 v44, 16, v44
    v_sqrt_f32 v44, v44
    s_nop 0
    v_cvt_pk_bf16_f32 v44, v44, v44
    v_lshlrev_b32 v44, 16, v44
    v_rcp_f32 v45, v44
    s_nop 0
    v_sub_f32 v16, v16, v43
    v_sub_f32 v17, v17, v43
    v_cvt_pk_bf16_f32 v41, v16, v17
    v_lshlrev_b32 v16, 16, v41
    v_and_b32 v17, 0xffff0000, v41
    v_mul_f32 v46, v16, v45
    v_fma_f32 v47, -v46, v44, v16
    v_fma_f32 v16, v47, v45, v46
    v_mul_f32 v46, v17, v45
    v_fma_f32 v47, -v46, v44, v17
    v_fma_f32 v17, v47, v45, v46
    v_cvt_pk_bf16_f32 v41, v16, v17
    v_lshlrev_b32 v16, 16, v41
    v_and_b32 v17, 0xffff0000, v41
    v_sub_f32 v18, v18, v43
    v_sub_f32 v19, v19, v43
    v_cvt_pk_bf16_f32 v41, v18, v19
    v_lshlrev_b32 v18, 16, v41
    v_and_b32 v19, 0xffff0000, v41
    v_mul_f32 v46, v18, v45
    v_fma_f32 v47, -v46, v44, v18
    v_fma_f32 v18, v47, v45, v46
    v_mul_f32 v46, v19, v45
    v_fma_f32 v47, -v46, v44, v19
    v_fma_f32 v19, v47, v45, v46
    v_cvt_pk_bf16_f32 v41, v18, v19
    v_lshlrev_b32 v18, 16, v41
    v_and_b32 v19, 0xffff0000, v41
    v_sub_f32 v20, v20, v43
    v_sub_f32 v21, v21, v43
    v_cvt_pk_bf16_f32 v41, v20, v21
    v_lshlrev_b32 v20, 16, v41
    v_and_b32 v21, 0xffff0000, v41
    v_mul_f32 v46, v20, v45
    v_fma_f32 v47, -v46, v44, v20
    v_fma_f32 v20, v47, v45, v46
    v_mul_f32 v46, v21, v45
    v_fma_f32 v47, -v46, v44, v21
    v_fma_f32 v21, v47, v45, v46
    v_cvt_pk_bf16_f32 v41, v20, v21
    v_lshlrev_b32 v20, 16, v41
    v_and_b32 v21, 0xffff0000, v41
    v_sub_f32 v22, v22, v43
    v_sub_f32 v23, v23, v43
    v_cvt_pk_bf16_f32 v41, v22, v23
    v_lshlrev_b32 v22, 16, v41
    v_and_b32 v23, 0xffff0000, v41
    v_mul_f32 v46, v22, v45
    v_fma_f32 v47, -v46, v44, v22
    v_fma_f32 v22, v47, v45, v46
    v_mul_f32 v46, v23, v45
    v_fma_f32 v47, -v46, v44, v23
    v_fma_f32 v23, v47, v45, v46
    v_cvt_pk_bf16_f32 v41, v22, v23
    v_lshlrev_b32 v22, 16, v41
    v_and_b32 v23, 0xffff0000, v41
    s_waitcnt vmcnt(0)
    v_add_f32 v32, 1.0, v32
    v_add_f32 v33, 1.0, v33
    v_cvt_pk_bf16_f32 v40, v32, v33
    v_lshlrev_b32 v32, 16, v40
    v_and_b32 v33, 0xffff0000, v40
    v_mul_f32 v16, v16, v32
    v_mul_f32 v17, v17, v33
    v_cvt_pk_bf16_f32 v40, v16, v17
    v_lshlrev_b32 v16, 16, v40
    v_and_b32 v17, 0xffff0000, v40
    v_add_f32 v16, v16, v24
    v_add_f32 v17, v17, v25
    v_cvt_pk_bf16_f32 v40, v16, v17
    v_lshlrev_b32 v16, 16, v40
    v_and_b32 v17, 0xffff0000, v40
    v_add_f32 v34, 1.0, v34
    v_add_f32 v35, 1.0, v35
    v_cvt_pk_bf16_f32 v40, v34, v35
    v_lshlrev_b32 v34, 16, v40
    v_and_b32 v35, 0xffff0000, v40
    v_mul_f32 v18, v18, v34
    v_mul_f32 v19, v19, v35
    v_cvt_pk_bf16_f32 v40, v18, v19
    v_lshlrev_b32 v18, 16, v40
    v_and_b32 v19, 0xffff0000, v40
    v_add_f32 v18, v18, v26
    v_add_f32 v19, v19, v27
    v_cvt_pk_bf16_f32 v40, v18, v19
    v_lshlrev_b32 v18, 16, v40
    v_and_b32 v19, 0xffff0000, v40
    v_add_f32 v36, 1.0, v36
    v_add_f32 v37, 1.0, v37
    v_cvt_pk_bf16_f32 v40, v36, v37
    v_lshlrev_b32 v36, 16, v40
    v_and_b32 v37, 0xffff0000, v40
    v_mul_f32 v20, v20, v36
    v_mul_f32 v21, v21, v37
    v_cvt_pk_bf16_f32 v40, v20, v21
    v_lshlrev_b32 v20, 16, v40
    v_and_b32 v21, 0xffff0000, v40
    v_add_f32 v20, v20, v28
    v_add_f32 v21, v21, v29
    v_cvt_pk_bf16_f32 v40, v20, v21
    v_lshlrev_b32 v20, 16, v40
    v_and_b32 v21, 0xffff0000, v40
    v_add_f32 v38, 1.0, v38
    v_add_f32 v39, 1.0, v39
    v_cvt_pk_bf16_f32 v40, v38, v39
    v_lshlrev_b32 v38, 16, v40
    v_and_b32 v39, 0xffff0000, v40
    v_mul_f32 v22, v22, v38
    v_mul_f32 v23, v23, v39
    v_cvt_pk_bf16_f32 v40, v22, v23
    v_lshlrev_b32 v22, 16, v40
    v_and_b32 v23, 0xffff0000, v40
    v_add_f32 v22, v22, v30
    v_add_f32 v23, v23, v31
    v_cvt_pk_bf16_f32 v40, v22, v23
    v_lshlrev_b32 v22, 16, v40
    v_and_b32 v23, 0xffff0000, v40
    v_cvt_pk_bf16_f32 v8, v16, v17
    v_cvt_pk_bf16_f32 v9, v18, v19
    v_cvt_pk_bf16_f32 v10, v20, v21
    v_cvt_pk_bf16_f32 v11, v22, v23
    s_lshl_b32 s22, s2, 3
    v_add_u32 v40, s22, v2
    v_lshrrev_b32 v41, 5, v40
    v_lshlrev_b32 v41, 15, v41
    v_lshrrev_b32 v42, 2, v1
    v_lshl_add_u32 v41, v42, 11, v41
    v_bfe_u32 v42, v40, 4, 1
    v_lshl_add_u32 v41, v42, 10, v41
    v_and_b32 v42, 1, v1
    v_lshl_add_u32 v41, v42, 9, v41
    v_and_b32 v42, 15, v40
    v_lshl_add_u32 v41, v42, 4, v41
    v_bfe_u32 v42, v1, 1, 1
    v_lshl_add_u32 v41, v42, 3, v41
    buffer_store_dwordx2 v[8:9], v41, s[16:19], 0 offen
    buffer_store_dwordx2 v[10:11], v41, s[16:19], 0 offen offset:256
L_k2_done:
    s_endpgm
.globl k3_attn_kernel
.p2align 8
.type k3_attn_kernel,@function
k3_attn_kernel:
    s_cmp_ge_u32 s2, 256
    s_cbranch_scc1 L_k3_done
    s_load_dwordx4 s[4:7], s[0:1], 8
    s_load_dwordx2 s[28:29], s[0:1], 24
    s_load_dwordx2 s[30:31], s[0:1], 112
    s_load_dwordx2 s[80:81], s[0:1], 32
    s_load_dwordx4 s[84:87], s[0:1], 56
    s_load_dwordx2 s[88:89], s[0:1], 72
    s_load_dwordx2 s[82:83], s[0:1], 0
    s_and_b32 s52, s2, 31
    s_lshr_b32 s53, s2, 5
    v_lshrrev_b32 v4, 6, v0
    v_and_b32 v5, 63, v0
    v_readfirstlane_b32 s33, v4
    v_and_b32 v8, 15, v5
    v_lshrrev_b32 v9, 4, v5
    s_waitcnt lgkmcnt(0)
    s_lshl_b32 s44, s52, 19
    s_add_u32 s8, s4, s44
    s_addc_u32 s9, s5, 0
    s_mov_b32 s10, 524288
    s_mov_b32 s11, 0x00020000
    s_add_u32 s12, s6, s44
    s_addc_u32 s13, s7, 0
    s_mov_b32 s14, 524288
    s_mov_b32 s15, 0x00020000
    s_lshl_b32 s44, s52, 8
    s_add_u32 s16, s28, s44
    s_addc_u32 s17, s29, 0
    s_sub_u32 s18, 4194304, s44
    s_mov_b32 s19, 0x00020000
    s_lshl_b32 s45, s53, 18
    s_add_u32 s45, s45, 0x100000
    s_add_u32 s20, s30, s45
    s_addc_u32 s21, s31, 0
    s_mov_b32 s22, 262144
    s_mov_b32 s23, 0x00020000
    s_lshl_b32 s45, s53, 21
    s_add_u32 s45, s45, s44
    s_add_u32 s45, s45, 0x800000
    s_add_u32 s24, s30, s45
    s_addc_u32 s25, s31, 0
    s_sub_u32 s26, 2097152, s44
    s_mov_b32 s27, 0x00020000
    s_mov_b32 s34, 0x3db504f3
    s_mov_b32 s32, 0x3fb8aa3b
    s_lshl_b32 s46, s33, 11
    s_add_u32 s37, s46, 0
    s_add_u32 s40, s46, 49152
    s_add_u32 s38, s46, 16384
    s_add_u32 s41, s46, 65536
    s_add_u32 s39, s46, 32768
    s_add_u32 s42, s46, 81920
    s_mov_b32 s35, 0
    s_mov_b32 s36, 0
    v_xor_b32 v10, v9, v8
    v_lshlrev_b32 v10, 4, v10
    v_lshl_add_u32 v16, v8, 8, v10
    v_xor_b32 v17, 64, v16
    v_xor_b32 v18, 128, v16
    v_xor_b32 v19, 192, v16
    v_lshrrev_b32 v10, 2, v8
    v_lshl_add_u32 v11, v9, 2, v10
    v_and_b32 v12, 7, v11
    v_lshlrev_b32 v11, 8, v11
    v_lshl_add_u32 v11, v12, 5, v11
    v_and_b32 v12, 3, v8
    v_lshl_add_u32 v20, v12, 3, v11
    v_xor_b32 v21, 32, v20
    v_xor_b32 v22, 64, v20
    v_xor_b32 v23, 96, v20
    v_xor_b32 v24, 128, v20
    v_xor_b32 v25, 160, v20
    v_xor_b32 v26, 192, v20
    v_xor_b32 v27, 224, v20
    s_lshl_b32 s47, s33, 3
    v_add_u32 v10, s47, v9
    v_and_b32 v11, 15, v10
    v_xor_b32 v11, v11, v8
    v_lshlrev_b32 v11, 4, v11
    v_lshl_add_u32 v28, v10, 8, v11
    v_add_u32 v12, 4, v10
    v_and_b32 v11, 15, v12
    v_xor_b32 v11, v11, v8
    v_lshlrev_b32 v11, 4, v11
    v_lshl_add_u32 v29, v10, 8, v11
    v_lshlrev_b32 v11, 1, v9
    v_xor_b32 v11, v11, v8
    v_lshlrev_b32 v11, 4, v11
    v_xor_b32 v12, 0x80, v11
    v_lshl_add_u32 v30, v10, 8, v11
    v_lshl_add_u32 v31, v10, 8, v12
    v_lshl_add_u32 v13, v10, 13, v11
    v_lshl_add_u32 v14, v10, 13, v12
    v_add_u32 v14, 31744, v14
    s_lshl_b32 s50, s33, 15
    v_lshlrev_b32 v15, 4, v5
    v_add_u32 v15, s50, v15
    v_lshrrev_b32 v10, 1, v9
    v_xor_b32 v10, v10, v8
    v_lshlrev_b32 v10, 4, v10
    v_lshl_add_u32 v10, v8, 8, v10
    v_and_b32 v11, 1, v9
    v_lshl_add_u32 v10, v11, 3, v10
    s_lshl_b32 s55, s33, 13
    s_add_u32 s55, s55, 98304
    v_add_u32 v6, s55, v10
    s_lshl_b32 s47, s33, 5
    v_add_u32 v0, s47, v9
    v_lshlrev_b32 v0, 13, v0
    v_lshl_add_u32 v0, v8, 4, v0
    v_mov_b32 v7, v9
    v_mov_b32 v5, v8
    v_add_u32 v20, 98304, v20
    v_add_u32 v21, 98304, v21
    v_add_u32 v22, 98304, v22
    v_add_u32 v23, 98304, v23
    v_add_u32 v24, 98304, v24
    v_add_u32 v25, 98304, v25
    v_add_u32 v26, 98304, v26
    v_add_u32 v27, 98304, v27
    s_add_u32 s48, s46, 98304
    s_mov_b32 m0, s48
    s_mov_b32 s49, 0
    buffer_load_dwordx4 v13, s[16:19], s49 offen lds
    buffer_load_dwordx4 v14, s[16:19], s49 offen offset:1024 lds
    s_mov_b32 s51, 0
    buffer_load_dwordx4 v[32:35], v15, s[20:23], s51 offen offset:0
    buffer_load_dwordx4 v[36:39], v15, s[20:23], s51 offen offset:1024
    buffer_load_dwordx4 v[40:43], v15, s[20:23], s51 offen offset:2048
    buffer_load_dwordx4 v[44:47], v15, s[20:23], s51 offen offset:3072
    s_add_u32 s48, s46, 114688
    s_mov_b32 m0, s48
    s_mov_b32 s49, 524288
    buffer_load_dwordx4 v13, s[16:19], s49 offen lds
    buffer_load_dwordx4 v14, s[16:19], s49 offen offset:1024 lds
    s_mov_b32 s51, 4096
    buffer_load_dwordx4 v[48:51], v15, s[20:23], s51 offen offset:0
    buffer_load_dwordx4 v[52:55], v15, s[20:23], s51 offen offset:1024
    buffer_load_dwordx4 v[56:59], v15, s[20:23], s51 offen offset:2048
    buffer_load_dwordx4 v[60:63], v15, s[20:23], s51 offen offset:3072
    s_add_u32 s48, s46, 131072
    s_mov_b32 m0, s48
    s_mov_b32 s49, 1048576
    buffer_load_dwordx4 v13, s[16:19], s49 offen lds
    buffer_load_dwordx4 v14, s[16:19], s49 offen offset:1024 lds
    s_mov_b32 s51, 8192
    buffer_load_dwordx4 v[64:67], v15, s[20:23], s51 offen offset:0
    buffer_load_dwordx4 v[68:71], v15, s[20:23], s51 offen offset:1024
    buffer_load_dwordx4 v[72:75], v15, s[20:23], s51 offen offset:2048
    buffer_load_dwordx4 v[76:79], v15, s[20:23], s51 offen offset:3072
    s_waitcnt vmcnt(12)
    s_barrier
    ds_read_b64_tr_b16 v[160:161], v20 offset:0
    ds_read_b64_tr_b16 v[162:163], v20 offset:4096
    ds_read_b64_tr_b16 v[164:165], v21 offset:0
    ds_read_b64_tr_b16 v[166:167], v21 offset:4096
    ds_read_b64_tr_b16 v[168:169], v22 offset:0
    ds_read_b64_tr_b16 v[170:171], v22 offset:4096
    ds_read_b64_tr_b16 v[172:173], v23 offset:0
    ds_read_b64_tr_b16 v[174:175], v23 offset:4096
    ds_read_b64_tr_b16 v[176:177], v24 offset:0
    ds_read_b64_tr_b16 v[178:179], v24 offset:4096
    ds_read_b64_tr_b16 v[180:181], v25 offset:0
    ds_read_b64_tr_b16 v[182:183], v25 offset:4096
    s_waitcnt lgkmcnt(10)
    v_mfma_f32_16x16x32_bf16 v[192:195], v[160:163], v[32:35], 0
    v_mfma_f32_16x16x32_bf16 v[196:199], v[160:163], v[36:39], 0
    ds_read_b64_tr_b16 v[184:185], v26 offset:0
    ds_read_b64_tr_b16 v[186:187], v26 offset:4096
    s_waitcnt lgkmcnt(10)
    v_mfma_f32_16x16x32_bf16 v[200:203], v[164:167], v[32:35], 0
    v_mfma_f32_16x16x32_bf16 v[204:207], v[164:167], v[36:39], 0
    ds_read_b64_tr_b16 v[188:189], v27 offset:0
    ds_read_b64_tr_b16 v[190:191], v27 offset:4096
    s_waitcnt lgkmcnt(10)
    v_mfma_f32_16x16x32_bf16 v[208:211], v[168:171], v[32:35], 0
    v_mfma_f32_16x16x32_bf16 v[212:215], v[168:171], v[36:39], 0
    ds_read_b64_tr_b16 v[160:161], v20 offset:8192
    ds_read_b64_tr_b16 v[162:163], v20 offset:12288
    s_waitcnt lgkmcnt(10)
    v_mfma_f32_16x16x32_bf16 v[216:219], v[172:175], v[32:35], 0
    v_mfma_f32_16x16x32_bf16 v[220:223], v[172:175], v[36:39], 0
    ds_read_b64_tr_b16 v[164:165], v21 offset:8192
    ds_read_b64_tr_b16 v[166:167], v21 offset:12288
    s_waitcnt vmcnt(6)
    s_barrier
    s_add_u32 s48, s46, 147456
    s_mov_b32 m0, s48
    s_mov_b32 s49, 1572864
    buffer_load_dwordx4 v13, s[16:19], s49 offen lds
    buffer_load_dwordx4 v14, s[16:19], s49 offen offset:1024 lds
    s_mov_b32 s51, 12288
    buffer_load_dwordx4 v[80:83], v15, s[20:23], s51 offen offset:0
    buffer_load_dwordx4 v[84:87], v15, s[20:23], s51 offen offset:1024
    buffer_load_dwordx4 v[88:91], v15, s[20:23], s51 offen offset:2048
    buffer_load_dwordx4 v[92:95], v15, s[20:23], s51 offen offset:3072
    s_waitcnt lgkmcnt(10)
    v_mfma_f32_16x16x32_bf16 v[224:227], v[176:179], v[32:35], 0
    v_mfma_f32_16x16x32_bf16 v[228:231], v[176:179], v[36:39], 0
    ds_read_b64_tr_b16 v[168:169], v22 offset:8192
    ds_read_b64_tr_b16 v[170:171], v22 offset:12288
    s_waitcnt lgkmcnt(10)
    v_mfma_f32_16x16x32_bf16 v[232:235], v[180:183], v[32:35], 0
    v_mfma_f32_16x16x32_bf16 v[236:239], v[180:183], v[36:39], 0
    ds_read_b64_tr_b16 v[172:173], v23 offset:8192
    ds_read_b64_tr_b16 v[174:175], v23 offset:12288
    s_waitcnt lgkmcnt(10)
    v_mfma_f32_16x16x32_bf16 v[240:243], v[184:187], v[32:35], 0
    v_mfma_f32_16x16x32_bf16 v[244:247], v[184:187], v[36:39], 0
    ds_read_b64_tr_b16 v[176:177], v24 offset:8192
    ds_read_b64_tr_b16 v[178:179], v24 offset:12288
    s_waitcnt lgkmcnt(10)
    v_mfma_f32_16x16x32_bf16 v[248:251], v[188:191], v[32:35], 0
    v_mfma_f32_16x16x32_bf16 v[252:255], v[188:191], v[36:39], 0
    ds_read_b64_tr_b16 v[180:181], v25 offset:8192
    ds_read_b64_tr_b16 v[182:183], v25 offset:12288
    s_waitcnt lgkmcnt(10)
    v_mfma_f32_16x16x32_bf16 v[192:195], v[160:163], v[40:43], v[192:195]
    v_mfma_f32_16x16x32_bf16 v[196:199], v[160:163], v[44:47], v[196:199]
    ds_read_b64_tr_b16 v[184:185], v26 offset:8192
    ds_read_b64_tr_b16 v[186:187], v26 offset:12288
    s_waitcnt lgkmcnt(10)
    v_mfma_f32_16x16x32_bf16 v[200:203], v[164:167], v[40:43], v[200:203]
    v_mfma_f32_16x16x32_bf16 v[204:207], v[164:167], v[44:47], v[204:207]
    ds_read_b64_tr_b16 v[188:189], v27 offset:8192
    ds_read_b64_tr_b16 v[190:191], v27 offset:12288
    s_waitcnt lgkmcnt(10)
    v_mfma_f32_16x16x32_bf16 v[208:211], v[168:171], v[40:43], v[208:211]
    v_mfma_f32_16x16x32_bf16 v[212:215], v[168:171], v[44:47], v[212:215]
    ds_read_b64_tr_b16 v[160:161], v20 offset:16384
    ds_read_b64_tr_b16 v[162:163], v20 offset:20480
    s_waitcnt lgkmcnt(10)
    v_mfma_f32_16x16x32_bf16 v[216:219], v[172:175], v[40:43], v[216:219]
    v_mfma_f32_16x16x32_bf16 v[220:223], v[172:175], v[44:47], v[220:223]
    ds_read_b64_tr_b16 v[164:165], v21 offset:16384
    ds_read_b64_tr_b16 v[166:167], v21 offset:20480
    s_waitcnt lgkmcnt(10)
    v_mfma_f32_16x16x32_bf16 v[224:227], v[176:179], v[40:43], v[224:227]
    v_mfma_f32_16x16x32_bf16 v[228:231], v[176:179], v[44:47], v[228:231]
    ds_read_b64_tr_b16 v[168:169], v22 offset:16384
    ds_read_b64_tr_b16 v[170:171], v22 offset:20480
    s_waitcnt lgkmcnt(10)
    v_mfma_f32_16x16x32_bf16 v[232:235], v[180:183], v[40:43], v[232:235]
    v_mfma_f32_16x16x32_bf16 v[236:239], v[180:183], v[44:47], v[236:239]
    ds_read_b64_tr_b16 v[172:173], v23 offset:16384
    ds_read_b64_tr_b16 v[174:175], v23 offset:20480
    s_waitcnt lgkmcnt(10)
    v_mfma_f32_16x16x32_bf16 v[240:243], v[184:187], v[40:43], v[240:243]
    v_mfma_f32_16x16x32_bf16 v[244:247], v[184:187], v[44:47], v[244:247]
    ds_read_b64_tr_b16 v[176:177], v24 offset:16384
    ds_read_b64_tr_b16 v[178:179], v24 offset:20480
    s_waitcnt lgkmcnt(10)
    v_mfma_f32_16x16x32_bf16 v[248:251], v[188:191], v[40:43], v[248:251]
    v_mfma_f32_16x16x32_bf16 v[252:255], v[188:191], v[44:47], v[252:255]
    ds_read_b64_tr_b16 v[180:181], v25 offset:16384
    ds_read_b64_tr_b16 v[182:183], v25 offset:20480
    s_waitcnt lgkmcnt(10)
    v_mfma_f32_16x16x32_bf16 v[192:195], v[160:163], v[48:51], v[192:195]
    v_mfma_f32_16x16x32_bf16 v[196:199], v[160:163], v[52:55], v[196:199]
    ds_read_b64_tr_b16 v[184:185], v26 offset:16384
    ds_read_b64_tr_b16 v[186:187], v26 offset:20480
    s_waitcnt lgkmcnt(10)
    v_mfma_f32_16x16x32_bf16 v[200:203], v[164:167], v[48:51], v[200:203]
    v_mfma_f32_16x16x32_bf16 v[204:207], v[164:167], v[52:55], v[204:207]
    ds_read_b64_tr_b16 v[188:189], v27 offset:16384
    ds_read_b64_tr_b16 v[190:191], v27 offset:20480
    s_waitcnt lgkmcnt(10)
    v_mfma_f32_16x16x32_bf16 v[208:211], v[168:171], v[48:51], v[208:211]
    v_mfma_f32_16x16x32_bf16 v[212:215], v[168:171], v[52:55], v[212:215]
    ds_read_b64_tr_b16 v[160:161], v20 offset:24576
    ds_read_b64_tr_b16 v[162:163], v20 offset:28672
    s_waitcnt lgkmcnt(10)
    v_mfma_f32_16x16x32_bf16 v[216:219], v[172:175], v[48:51], v[216:219]
    v_mfma_f32_16x16x32_bf16 v[220:223], v[172:175], v[52:55], v[220:223]
    ds_read_b64_tr_b16 v[164:165], v21 offset:24576
    ds_read_b64_tr_b16 v[166:167], v21 offset:28672
    s_waitcnt vmcnt(6)
    s_barrier
    s_add_u32 s48, s46, 98304
    s_mov_b32 m0, s48
    s_mov_b32 s49, 2097152
    buffer_load_dwordx4 v13, s[16:19], s49 offen lds
    buffer_load_dwordx4 v14, s[16:19], s49 offen offset:1024 lds
    s_mov_b32 s51, 16384
    buffer_load_dwordx4 v[96:99], v15, s[20:23], s51 offen offset:0
    buffer_load_dwordx4 v[100:103], v15, s[20:23], s51 offen offset:1024
    buffer_load_dwordx4 v[104:107], v15, s[20:23], s51 offen offset:2048
    buffer_load_dwordx4 v[108:111], v15, s[20:23], s51 offen offset:3072
    s_waitcnt lgkmcnt(10)
    v_mfma_f32_16x16x32_bf16 v[224:227], v[176:179], v[48:51], v[224:227]
    v_mfma_f32_16x16x32_bf16 v[228:231], v[176:179], v[52:55], v[228:231]
    ds_read_b64_tr_b16 v[168:169], v22 offset:24576
    ds_read_b64_tr_b16 v[170:171], v22 offset:28672
    s_waitcnt lgkmcnt(10)
    v_mfma_f32_16x16x32_bf16 v[232:235], v[180:183], v[48:51], v[232:235]
    v_mfma_f32_16x16x32_bf16 v[236:239], v[180:183], v[52:55], v[236:239]
    ds_read_b64_tr_b16 v[172:173], v23 offset:24576
    ds_read_b64_tr_b16 v[174:175], v23 offset:28672
    s_waitcnt lgkmcnt(10)
    v_mfma_f32_16x16x32_bf16 v[240:243], v[184:187], v[48:51], v[240:243]
    v_mfma_f32_16x16x32_bf16 v[244:247], v[184:187], v[52:55], v[244:247]
    ds_read_b64_tr_b16 v[176:177], v24 offset:24576
    ds_read_b64_tr_b16 v[178:179], v24 offset:28672
    s_waitcnt lgkmcnt(10)
    v_mfma_f32_16x16x32_bf16 v[248:251], v[188:191], v[48:51], v[248:251]
    v_mfma_f32_16x16x32_bf16 v[252:255], v[188:191], v[52:55], v[252:255]
    ds_read_b64_tr_b16 v[180:181], v25 offset:24576
    ds_read_b64_tr_b16 v[182:183], v25 offset:28672
    s_waitcnt lgkmcnt(10)
    v_mfma_f32_16x16x32_bf16 v[192:195], v[160:163], v[56:59], v[192:195]
    v_mfma_f32_16x16x32_bf16 v[196:199], v[160:163], v[60:63], v[196:199]
    ds_read_b64_tr_b16 v[184:185], v26 offset:24576
    ds_read_b64_tr_b16 v[186:187], v26 offset:28672
    s_waitcnt lgkmcnt(10)
    v_mfma_f32_16x16x32_bf16 v[200:203], v[164:167], v[56:59], v[200:203]
    v_mfma_f32_16x16x32_bf16 v[204:207], v[164:167], v[60:63], v[204:207]
    ds_read_b64_tr_b16 v[188:189], v27 offset:24576
    ds_read_b64_tr_b16 v[190:191], v27 offset:28672
    s_waitcnt lgkmcnt(10)
    v_mfma_f32_16x16x32_bf16 v[208:211], v[168:171], v[56:59], v[208:211]
    v_mfma_f32_16x16x32_bf16 v[212:215], v[168:171], v[60:63], v[212:215]
    ds_read_b64_tr_b16 v[160:161], v20 offset:32768
    ds_read_b64_tr_b16 v[162:163], v20 offset:36864
    s_waitcnt lgkmcnt(10)
    v_mfma_f32_16x16x32_bf16 v[216:219], v[172:175], v[56:59], v[216:219]
    v_mfma_f32_16x16x32_bf16 v[220:223], v[172:175], v[60:63], v[220:223]
    ds_read_b64_tr_b16 v[164:165], v21 offset:32768
    ds_read_b64_tr_b16 v[166:167], v21 offset:36864
    s_waitcnt lgkmcnt(10)
    v_mfma_f32_16x16x32_bf16 v[224:227], v[176:179], v[56:59], v[224:227]
    v_mfma_f32_16x16x32_bf16 v[228:231], v[176:179], v[60:63], v[228:231]
    ds_read_b64_tr_b16 v[168:169], v22 offset:32768
    ds_read_b64_tr_b16 v[170:171], v22 offset:36864
    s_waitcnt lgkmcnt(10)
    v_mfma_f32_16x16x32_bf16 v[232:235], v[180:183], v[56:59], v[232:235]
    v_mfma_f32_16x16x32_bf16 v[236:239], v[180:183], v[60:63], v[236:239]
    ds_read_b64_tr_b16 v[172:173], v23 offset:32768
    ds_read_b64_tr_b16 v[174:175], v23 offset:36864
    s_waitcnt lgkmcnt(10)
    v_mfma_f32_16x16x32_bf16 v[240:243], v[184:187], v[56:59], v[240:243]
    v_mfma_f32_16x16x32_bf16 v[244:247], v[184:187], v[60:63], v[244:247]
    ds_read_b64_tr_b16 v[176:177], v24 offset:32768
    ds_read_b64_tr_b16 v[178:179], v24 offset:36864
    s_waitcnt lgkmcnt(10)
    v_mfma_f32_16x16x32_bf16 v[248:251], v[188:191], v[56:59], v[248:251]
    v_mfma_f32_16x16x32_bf16 v[252:255], v[188:191], v[60:63], v[252:255]
    ds_read_b64_tr_b16 v[180:181], v25 offset:32768
    ds_read_b64_tr_b16 v[182:183], v25 offset:36864
    s_waitcnt lgkmcnt(10)
    v_mfma_f32_16x16x32_bf16 v[192:195], v[160:163], v[64:67], v[192:195]
    v_mfma_f32_16x16x32_bf16 v[196:199], v[160:163], v[68:71], v[196:199]
    ds_read_b64_tr_b16 v[184:185], v26 offset:32768
    ds_read_b64_tr_b16 v[186:187], v26 offset:36864
    s_waitcnt lgkmcnt(10)
    v_mfma_f32_16x16x32_bf16 v[200:203], v[164:167], v[64:67], v[200:203]
    v_mfma_f32_16x16x32_bf16 v[204:207], v[164:167], v[68:71], v[204:207]
    ds_read_b64_tr_b16 v[188:189], v27 offset:32768
    ds_read_b64_tr_b16 v[190:191], v27 offset:36864
    s_waitcnt lgkmcnt(10)
    v_mfma_f32_16x16x32_bf16 v[208:211], v[168:171], v[64:67], v[208:211]
    v_mfma_f32_16x16x32_bf16 v[212:215], v[168:171], v[68:71], v[212:215]
    ds_read_b64_tr_b16 v[160:161], v20 offset:40960
    ds_read_b64_tr_b16 v[162:163], v20 offset:45056
    s_waitcnt lgkmcnt(10)
    v_mfma_f32_16x16x32_bf16 v[216:219], v[172:175], v[64:67], v[216:219]
    v_mfma_f32_16x16x32_bf16 v[220:223], v[172:175], v[68:71], v[220:223]
    ds_read_b64_tr_b16 v[164:165], v21 offset:40960
    ds_read_b64_tr_b16 v[166:167], v21 offset:45056
    s_waitcnt vmcnt(6)
    s_barrier
    s_add_u32 s48, s46, 114688
    s_mov_b32 m0, s48
    s_mov_b32 s49, 2621440
    buffer_load_dwordx4 v13, s[16:19], s49 offen lds
    buffer_load_dwordx4 v14, s[16:19], s49 offen offset:1024 lds
    s_mov_b32 s51, 20480
    buffer_load_dwordx4 v[112:115], v15, s[20:23], s51 offen offset:0
    buffer_load_dwordx4 v[116:119], v15, s[20:23], s51 offen offset:1024
    buffer_load_dwordx4 v[120:123], v15, s[20:23], s51 offen offset:2048
    buffer_load_dwordx4 v[124:127], v15, s[20:23], s51 offen offset:3072
    s_waitcnt lgkmcnt(10)
    v_mfma_f32_16x16x32_bf16 v[224:227], v[176:179], v[64:67], v[224:227]
    v_mfma_f32_16x16x32_bf16 v[228:231], v[176:179], v[68:71], v[228:231]
    ds_read_b64_tr_b16 v[168:169], v22 offset:40960
    ds_read_b64_tr_b16 v[170:171], v22 offset:45056
    s_waitcnt lgkmcnt(10)
    v_mfma_f32_16x16x32_bf16 v[232:235], v[180:183], v[64:67], v[232:235]
    v_mfma_f32_16x16x32_bf16 v[236:239], v[180:183], v[68:71], v[236:239]
    ds_read_b64_tr_b16 v[172:173], v23 offset:40960
    ds_read_b64_tr_b16 v[174:175], v23 offset:45056
    s_waitcnt lgkmcnt(10)
    v_mfma_f32_16x16x32_bf16 v[240:243], v[184:187], v[64:67], v[240:243]
    v_mfma_f32_16x16x32_bf16 v[244:247], v[184:187], v[68:71], v[244:247]
    ds_read_b64_tr_b16 v[176:177], v24 offset:40960
    ds_read_b64_tr_b16 v[178:179], v24 offset:45056
    s_waitcnt lgkmcnt(10)
    v_mfma_f32_16x16x32_bf16 v[248:251], v[188:191], v[64:67], v[248:251]
    v_mfma_f32_16x16x32_bf16 v[252:255], v[188:191], v[68:71], v[252:255]
    ds_read_b64_tr_b16 v[180:181], v25 offset:40960
    ds_read_b64_tr_b16 v[182:183], v25 offset:45056
    s_waitcnt lgkmcnt(10)
    v_mfma_f32_16x16x32_bf16 v[192:195], v[160:163], v[72:75], v[192:195]
    v_mfma_f32_16x16x32_bf16 v[196:199], v[160:163], v[76:79], v[196:199]
    ds_read_b64_tr_b16 v[184:185], v26 offset:40960
    ds_read_b64_tr_b16 v[186:187], v26 offset:45056
    s_waitcnt lgkmcnt(10)
    v_mfma_f32_16x16x32_bf16 v[200:203], v[164:167], v[72:75], v[200:203]
    v_mfma_f32_16x16x32_bf16 v[204:207], v[164:167], v[76:79], v[204:207]
    ds_read_b64_tr_b16 v[188:189], v27 offset:40960
    ds_read_b64_tr_b16 v[190:191], v27 offset:45056
    s_waitcnt lgkmcnt(10)
    v_mfma_f32_16x16x32_bf16 v[208:211], v[168:171], v[72:75], v[208:211]
    v_mfma_f32_16x16x32_bf16 v[212:215], v[168:171], v[76:79], v[212:215]
    ds_read_b64_tr_b16 v[160:161], v20 offset:49152
    ds_read_b64_tr_b16 v[162:163], v20 offset:53248
    s_waitcnt lgkmcnt(10)
    v_mfma_f32_16x16x32_bf16 v[216:219], v[172:175], v[72:75], v[216:219]
    v_mfma_f32_16x16x32_bf16 v[220:223], v[172:175], v[76:79], v[220:223]
    ds_read_b64_tr_b16 v[164:165], v21 offset:49152
    ds_read_b64_tr_b16 v[166:167], v21 offset:53248
    s_waitcnt lgkmcnt(10)
    v_mfma_f32_16x16x32_bf16 v[224:227], v[176:179], v[72:75], v[224:227]
    v_mfma_f32_16x16x32_bf16 v[228:231], v[176:179], v[76:79], v[228:231]
    ds_read_b64_tr_b16 v[168:169], v22 offset:49152
    ds_read_b64_tr_b16 v[170:171], v22 offset:53248
    s_waitcnt lgkmcnt(10)
    v_mfma_f32_16x16x32_bf16 v[232:235], v[180:183], v[72:75], v[232:235]
    v_mfma_f32_16x16x32_bf16 v[236:239], v[180:183], v[76:79], v[236:239]
    ds_read_b64_tr_b16 v[172:173], v23 offset:49152
    ds_read_b64_tr_b16 v[174:175], v23 offset:53248
    s_waitcnt lgkmcnt(10)
    v_mfma_f32_16x16x32_bf16 v[240:243], v[184:187], v[72:75], v[240:243]
    v_mfma_f32_16x16x32_bf16 v[244:247], v[184:187], v[76:79], v[244:247]
    ds_read_b64_tr_b16 v[176:177], v24 offset:49152
    ds_read_b64_tr_b16 v[178:179], v24 offset:53248
    s_waitcnt lgkmcnt(10)
    v_mfma_f32_16x16x32_bf16 v[248:251], v[188:191], v[72:75], v[248:251]
    v_mfma_f32_16x16x32_bf16 v[252:255], v[188:191], v[76:79], v[252:255]
    ds_read_b64_tr_b16 v[180:181], v25 offset:49152
    ds_read_b64_tr_b16 v[182:183], v25 offset:53248
    s_waitcnt lgkmcnt(10)
    v_mfma_f32_16x16x32_bf16 v[192:195], v[160:163], v[80:83], v[192:195]
    v_mfma_f32_16x16x32_bf16 v[196:199], v[160:163], v[84:87], v[196:199]
    ds_read_b64_tr_b16 v[184:185], v26 offset:49152
    ds_read_b64_tr_b16 v[186:187], v26 offset:53248
    s_waitcnt lgkmcnt(10)
    v_mfma_f32_16x16x32_bf16 v[200:203], v[164:167], v[80:83], v[200:203]
    v_mfma_f32_16x16x32_bf16 v[204:207], v[164:167], v[84:87], v[204:207]
    ds_read_b64_tr_b16 v[188:189], v27 offset:49152
    ds_read_b64_tr_b16 v[190:191], v27 offset:53248
    s_waitcnt lgkmcnt(10)
    v_mfma_f32_16x16x32_bf16 v[208:211], v[168:171], v[80:83], v[208:211]
    v_mfma_f32_16x16x32_bf16 v[212:215], v[168:171], v[84:87], v[212:215]
    ds_read_b64_tr_b16 v[160:161], v20 offset:57344
    ds_read_b64_tr_b16 v[162:163], v20 offset:61440
    s_waitcnt lgkmcnt(10)
    v_mfma_f32_16x16x32_bf16 v[216:219], v[172:175], v[80:83], v[216:219]
    v_mfma_f32_16x16x32_bf16 v[220:223], v[172:175], v[84:87], v[220:223]
    ds_read_b64_tr_b16 v[164:165], v21 offset:57344
    ds_read_b64_tr_b16 v[166:167], v21 offset:61440
    s_waitcnt vmcnt(6)
    s_barrier
    s_add_u32 s48, s46, 131072
    s_mov_b32 m0, s48
    s_mov_b32 s49, 3145728
    buffer_load_dwordx4 v13, s[16:19], s49 offen lds
    buffer_load_dwordx4 v14, s[16:19], s49 offen offset:1024 lds
    s_mov_b32 s51, 24576
    buffer_load_dwordx4 v[128:131], v15, s[20:23], s51 offen offset:0
    buffer_load_dwordx4 v[132:135], v15, s[20:23], s51 offen offset:1024
    buffer_load_dwordx4 v[136:139], v15, s[20:23], s51 offen offset:2048
    buffer_load_dwordx4 v[140:143], v15, s[20:23], s51 offen offset:3072
    s_waitcnt lgkmcnt(10)
    v_mfma_f32_16x16x32_bf16 v[224:227], v[176:179], v[80:83], v[224:227]
    v_mfma_f32_16x16x32_bf16 v[228:231], v[176:179], v[84:87], v[228:231]
    ds_read_b64_tr_b16 v[168:169], v22 offset:57344
    ds_read_b64_tr_b16 v[170:171], v22 offset:61440
    s_waitcnt lgkmcnt(10)
    v_mfma_f32_16x16x32_bf16 v[232:235], v[180:183], v[80:83], v[232:235]
    v_mfma_f32_16x16x32_bf16 v[236:239], v[180:183], v[84:87], v[236:239]
    ds_read_b64_tr_b16 v[172:173], v23 offset:57344
    ds_read_b64_tr_b16 v[174:175], v23 offset:61440
    s_waitcnt lgkmcnt(10)
    v_mfma_f32_16x16x32_bf16 v[240:243], v[184:187], v[80:83], v[240:243]
    v_mfma_f32_16x16x32_bf16 v[244:247], v[184:187], v[84:87], v[244:247]
    ds_read_b64_tr_b16 v[176:177], v24 offset:57344
    ds_read_b64_tr_b16 v[178:179], v24 offset:61440
    s_waitcnt lgkmcnt(10)
    v_mfma_f32_16x16x32_bf16 v[248:251], v[188:191], v[80:83], v[248:251]
    v_mfma_f32_16x16x32_bf16 v[252:255], v[188:191], v[84:87], v[252:255]
    ds_read_b64_tr_b16 v[180:181], v25 offset:57344
    ds_read_b64_tr_b16 v[182:183], v25 offset:61440
    s_waitcnt lgkmcnt(10)
    v_mfma_f32_16x16x32_bf16 v[192:195], v[160:163], v[88:91], v[192:195]
    v_mfma_f32_16x16x32_bf16 v[196:199], v[160:163], v[92:95], v[196:199]
    ds_read_b64_tr_b16 v[184:185], v26 offset:57344
    ds_read_b64_tr_b16 v[186:187], v26 offset:61440
    s_waitcnt lgkmcnt(10)
    v_mfma_f32_16x16x32_bf16 v[200:203], v[164:167], v[88:91], v[200:203]
    v_mfma_f32_16x16x32_bf16 v[204:207], v[164:167], v[92:95], v[204:207]
    ds_read_b64_tr_b16 v[188:189], v27 offset:57344
    ds_read_b64_tr_b16 v[190:191], v27 offset:61440
    s_waitcnt lgkmcnt(10)
    v_mfma_f32_16x16x32_bf16 v[208:211], v[168:171], v[88:91], v[208:211]
    v_mfma_f32_16x16x32_bf16 v[212:215], v[168:171], v[92:95], v[212:215]
    ds_read_b64_tr_b16 v[160:161], v20 offset:0
    ds_read_b64_tr_b16 v[162:163], v20 offset:4096
    s_waitcnt lgkmcnt(10)
    v_mfma_f32_16x16x32_bf16 v[216:219], v[172:175], v[88:91], v[216:219]
    v_mfma_f32_16x16x32_bf16 v[220:223], v[172:175], v[92:95], v[220:223]
    ds_read_b64_tr_b16 v[164:165], v21 offset:0
    ds_read_b64_tr_b16 v[166:167], v21 offset:4096
    s_waitcnt lgkmcnt(10)
    v_mfma_f32_16x16x32_bf16 v[224:227], v[176:179], v[88:91], v[224:227]
    v_mfma_f32_16x16x32_bf16 v[228:231], v[176:179], v[92:95], v[228:231]
    ds_read_b64_tr_b16 v[168:169], v22 offset:0
    ds_read_b64_tr_b16 v[170:171], v22 offset:4096
    s_waitcnt lgkmcnt(10)
    v_mfma_f32_16x16x32_bf16 v[232:235], v[180:183], v[88:91], v[232:235]
    v_mfma_f32_16x16x32_bf16 v[236:239], v[180:183], v[92:95], v[236:239]
    ds_read_b64_tr_b16 v[172:173], v23 offset:0
    ds_read_b64_tr_b16 v[174:175], v23 offset:4096
    s_waitcnt lgkmcnt(10)
    v_mfma_f32_16x16x32_bf16 v[240:243], v[184:187], v[88:91], v[240:243]
    v_mfma_f32_16x16x32_bf16 v[244:247], v[184:187], v[92:95], v[244:247]
    ds_read_b64_tr_b16 v[176:177], v24 offset:0
    ds_read_b64_tr_b16 v[178:179], v24 offset:4096
    s_waitcnt lgkmcnt(10)
    v_mfma_f32_16x16x32_bf16 v[248:251], v[188:191], v[88:91], v[248:251]
    v_mfma_f32_16x16x32_bf16 v[252:255], v[188:191], v[92:95], v[252:255]
    ds_read_b64_tr_b16 v[180:181], v25 offset:0
    ds_read_b64_tr_b16 v[182:183], v25 offset:4096
    s_waitcnt lgkmcnt(10)
    v_mfma_f32_16x16x32_bf16 v[192:195], v[160:163], v[96:99], v[192:195]
    v_mfma_f32_16x16x32_bf16 v[196:199], v[160:163], v[100:103], v[196:199]
    ds_read_b64_tr_b16 v[184:185], v26 offset:0
    ds_read_b64_tr_b16 v[186:187], v26 offset:4096
    s_waitcnt lgkmcnt(10)
    v_mfma_f32_16x16x32_bf16 v[200:203], v[164:167], v[96:99], v[200:203]
    v_mfma_f32_16x16x32_bf16 v[204:207], v[164:167], v[100:103], v[204:207]
    ds_read_b64_tr_b16 v[188:189], v27 offset:0
    ds_read_b64_tr_b16 v[190:191], v27 offset:4096
    s_waitcnt lgkmcnt(10)
    v_mfma_f32_16x16x32_bf16 v[208:211], v[168:171], v[96:99], v[208:211]
    v_mfma_f32_16x16x32_bf16 v[212:215], v[168:171], v[100:103], v[212:215]
    ds_read_b64_tr_b16 v[160:161], v20 offset:8192
    ds_read_b64_tr_b16 v[162:163], v20 offset:12288
    s_waitcnt lgkmcnt(10)
    v_mfma_f32_16x16x32_bf16 v[216:219], v[172:175], v[96:99], v[216:219]
    v_mfma_f32_16x16x32_bf16 v[220:223], v[172:175], v[100:103], v[220:223]
    ds_read_b64_tr_b16 v[164:165], v21 offset:8192
    ds_read_b64_tr_b16 v[166:167], v21 offset:12288
    s_waitcnt vmcnt(6)
    s_barrier
    s_add_u32 s48, s46, 147456
    s_mov_b32 m0, s48
    s_mov_b32 s49, 3670016
    buffer_load_dwordx4 v13, s[16:19], s49 offen lds
    buffer_load_dwordx4 v14, s[16:19], s49 offen offset:1024 lds
    s_mov_b32 s51, 28672
    buffer_load_dwordx4 v[144:147], v15, s[20:23], s51 offen offset:0
    buffer_load_dwordx4 v[148:151], v15, s[20:23], s51 offen offset:1024
    buffer_load_dwordx4 v[152:155], v15, s[20:23], s51 offen offset:2048
    buffer_load_dwordx4 v[156:159], v15, s[20:23], s51 offen offset:3072
    s_waitcnt lgkmcnt(10)
    v_mfma_f32_16x16x32_bf16 v[224:227], v[176:179], v[96:99], v[224:227]
    v_mfma_f32_16x16x32_bf16 v[228:231], v[176:179], v[100:103], v[228:231]
    ds_read_b64_tr_b16 v[168:169], v22 offset:8192
    ds_read_b64_tr_b16 v[170:171], v22 offset:12288
    s_waitcnt lgkmcnt(10)
    v_mfma_f32_16x16x32_bf16 v[232:235], v[180:183], v[96:99], v[232:235]
    v_mfma_f32_16x16x32_bf16 v[236:239], v[180:183], v[100:103], v[236:239]
    ds_read_b64_tr_b16 v[172:173], v23 offset:8192
    ds_read_b64_tr_b16 v[174:175], v23 offset:12288
    s_waitcnt lgkmcnt(10)
    v_mfma_f32_16x16x32_bf16 v[240:243], v[184:187], v[96:99], v[240:243]
    v_mfma_f32_16x16x32_bf16 v[244:247], v[184:187], v[100:103], v[244:247]
    ds_read_b64_tr_b16 v[176:177], v24 offset:8192
    ds_read_b64_tr_b16 v[178:179], v24 offset:12288
    s_waitcnt lgkmcnt(10)
    v_mfma_f32_16x16x32_bf16 v[248:251], v[188:191], v[96:99], v[248:251]
    v_mfma_f32_16x16x32_bf16 v[252:255], v[188:191], v[100:103], v[252:255]
    ds_read_b64_tr_b16 v[180:181], v25 offset:8192
    ds_read_b64_tr_b16 v[182:183], v25 offset:12288
    s_waitcnt lgkmcnt(10)
    v_mfma_f32_16x16x32_bf16 v[192:195], v[160:163], v[104:107], v[192:195]
    v_mfma_f32_16x16x32_bf16 v[196:199], v[160:163], v[108:111], v[196:199]
    ds_read_b64_tr_b16 v[184:185], v26 offset:8192
    ds_read_b64_tr_b16 v[186:187], v26 offset:12288
    s_waitcnt lgkmcnt(10)
    v_mfma_f32_16x16x32_bf16 v[200:203], v[164:167], v[104:107], v[200:203]
    v_mfma_f32_16x16x32_bf16 v[204:207], v[164:167], v[108:111], v[204:207]
    ds_read_b64_tr_b16 v[188:189], v27 offset:8192
    ds_read_b64_tr_b16 v[190:191], v27 offset:12288
    s_waitcnt lgkmcnt(10)
    v_mfma_f32_16x16x32_bf16 v[208:211], v[168:171], v[104:107], v[208:211]
    v_mfma_f32_16x16x32_bf16 v[212:215], v[168:171], v[108:111], v[212:215]
    ds_read_b64_tr_b16 v[160:161], v20 offset:16384
    ds_read_b64_tr_b16 v[162:163], v20 offset:20480
    s_waitcnt lgkmcnt(10)
    v_mfma_f32_16x16x32_bf16 v[216:219], v[172:175], v[104:107], v[216:219]
    v_mfma_f32_16x16x32_bf16 v[220:223], v[172:175], v[108:111], v[220:223]
    ds_read_b64_tr_b16 v[164:165], v21 offset:16384
    ds_read_b64_tr_b16 v[166:167], v21 offset:20480
    s_waitcnt lgkmcnt(10)
    v_mfma_f32_16x16x32_bf16 v[224:227], v[176:179], v[104:107], v[224:227]
    v_mfma_f32_16x16x32_bf16 v[228:231], v[176:179], v[108:111], v[228:231]
    ds_read_b64_tr_b16 v[168:169], v22 offset:16384
    ds_read_b64_tr_b16 v[170:171], v22 offset:20480
    s_waitcnt lgkmcnt(10)
    v_mfma_f32_16x16x32_bf16 v[232:235], v[180:183], v[104:107], v[232:235]
    v_mfma_f32_16x16x32_bf16 v[236:239], v[180:183], v[108:111], v[236:239]
    ds_read_b64_tr_b16 v[172:173], v23 offset:16384
    ds_read_b64_tr_b16 v[174:175], v23 offset:20480
    s_waitcnt lgkmcnt(10)
    v_mfma_f32_16x16x32_bf16 v[240:243], v[184:187], v[104:107], v[240:243]
    v_mfma_f32_16x16x32_bf16 v[244:247], v[184:187], v[108:111], v[244:247]
    ds_read_b64_tr_b16 v[176:177], v24 offset:16384
    ds_read_b64_tr_b16 v[178:179], v24 offset:20480
    s_waitcnt lgkmcnt(10)
    v_mfma_f32_16x16x32_bf16 v[248:251], v[188:191], v[104:107], v[248:251]
    v_mfma_f32_16x16x32_bf16 v[252:255], v[188:191], v[108:111], v[252:255]
    ds_read_b64_tr_b16 v[180:181], v25 offset:16384
    ds_read_b64_tr_b16 v[182:183], v25 offset:20480
    s_waitcnt lgkmcnt(10)
    v_mfma_f32_16x16x32_bf16 v[192:195], v[160:163], v[112:115], v[192:195]
    v_mfma_f32_16x16x32_bf16 v[196:199], v[160:163], v[116:119], v[196:199]
    ds_read_b64_tr_b16 v[184:185], v26 offset:16384
    ds_read_b64_tr_b16 v[186:187], v26 offset:20480
    s_waitcnt lgkmcnt(10)
    v_mfma_f32_16x16x32_bf16 v[200:203], v[164:167], v[112:115], v[200:203]
    v_mfma_f32_16x16x32_bf16 v[204:207], v[164:167], v[116:119], v[204:207]
    ds_read_b64_tr_b16 v[188:189], v27 offset:16384
    ds_read_b64_tr_b16 v[190:191], v27 offset:20480
    s_waitcnt lgkmcnt(10)
    v_mfma_f32_16x16x32_bf16 v[208:211], v[168:171], v[112:115], v[208:211]
    v_mfma_f32_16x16x32_bf16 v[212:215], v[168:171], v[116:119], v[212:215]
    ds_read_b64_tr_b16 v[160:161], v20 offset:24576
    ds_read_b64_tr_b16 v[162:163], v20 offset:28672
    s_waitcnt lgkmcnt(10)
    v_mfma_f32_16x16x32_bf16 v[216:219], v[172:175], v[112:115], v[216:219]
    v_mfma_f32_16x16x32_bf16 v[220:223], v[172:175], v[116:119], v[220:223]
    ds_read_b64_tr_b16 v[164:165], v21 offset:24576
    ds_read_b64_tr_b16 v[166:167], v21 offset:28672
    s_waitcnt vmcnt(6)
    s_barrier
    s_mov_b32 m0, s37
    s_nop 0
    buffer_load_dwordx4 v28, s[8:11], s35 offen lds
    buffer_load_dwordx4 v29, s[8:11], s35 offen offset:1024 lds
    s_add_u32 s35, s35, 16384
    s_mov_b32 m0, s38
    s_nop 0
    buffer_load_dwordx4 v28, s[8:11], s35 offen lds
    buffer_load_dwordx4 v29, s[8:11], s35 offen offset:1024 lds
    s_add_u32 s35, s35, 16384
    s_mov_b32 m0, s40
    s_nop 0
    buffer_load_dwordx4 v30, s[12:15], s36 offen lds
    buffer_load_dwordx4 v31, s[12:15], s36 offen offset:1024 lds
    s_add_u32 s36, s36, 16384
    s_waitcnt lgkmcnt(10)
    v_mfma_f32_16x16x32_bf16 v[224:227], v[176:179], v[112:115], v[224:227]
    v_mfma_f32_16x16x32_bf16 v[228:231], v[176:179], v[116:119], v[228:231]
    ds_read_b64_tr_b16 v[168:169], v22 offset:24576
    ds_read_b64_tr_b16 v[170:171], v22 offset:28672
    s_waitcnt lgkmcnt(10)
    v_mfma_f32_16x16x32_bf16 v[232:235], v[180:183], v[112:115], v[232:235]
    v_mfma_f32_16x16x32_bf16 v[236:239], v[180:183], v[116:119], v[236:239]
    ds_read_b64_tr_b16 v[172:173], v23 offset:24576
    ds_read_b64_tr_b16 v[174:175], v23 offset:28672
    s_waitcnt lgkmcnt(10)
    v_mfma_f32_16x16x32_bf16 v[240:243], v[184:187], v[112:115], v[240:243]
    v_mfma_f32_16x16x32_bf16 v[244:247], v[184:187], v[116:119], v[244:247]
    ds_read_b64_tr_b16 v[176:177], v24 offset:24576
    ds_read_b64_tr_b16 v[178:179], v24 offset:28672
    s_waitcnt lgkmcnt(10)
    v_mfma_f32_16x16x32_bf16 v[248:251], v[188:191], v[112:115], v[248:251]
    v_mfma_f32_16x16x32_bf16 v[252:255], v[188:191], v[116:119], v[252:255]
    ds_read_b64_tr_b16 v[180:181], v25 offset:24576
    ds_read_b64_tr_b16 v[182:183], v25 offset:28672
    s_waitcnt lgkmcnt(10)
    v_mfma_f32_16x16x32_bf16 v[192:195], v[160:163], v[120:123], v[192:195]
    v_mfma_f32_16x16x32_bf16 v[196:199], v[160:163], v[124:127], v[196:199]
    ds_read_b64_tr_b16 v[184:185], v26 offset:24576
    ds_read_b64_tr_b16 v[186:187], v26 offset:28672
    s_waitcnt lgkmcnt(10)
    v_mfma_f32_16x16x32_bf16 v[200:203], v[164:167], v[120:123], v[200:203]
    v_mfma_f32_16x16x32_bf16 v[204:207], v[164:167], v[124:127], v[204:207]
    ds_read_b64_tr_b16 v[188:189], v27 offset:24576
    ds_read_b64_tr_b16 v[190:191], v27 offset:28672
    s_waitcnt lgkmcnt(10)
    v_mfma_f32_16x16x32_bf16 v[208:211], v[168:171], v[120:123], v[208:211]
    v_mfma_f32_16x16x32_bf16 v[212:215], v[168:171], v[124:127], v[212:215]
    ds_read_b64_tr_b16 v[160:161], v20 offset:32768
    ds_read_b64_tr_b16 v[162:163], v20 offset:36864
    s_waitcnt lgkmcnt(10)
    v_mfma_f32_16x16x32_bf16 v[216:219], v[172:175], v[120:123], v[216:219]
    v_mfma_f32_16x16x32_bf16 v[220:223], v[172:175], v[124:127], v[220:223]
    ds_read_b64_tr_b16 v[164:165], v21 offset:32768
    ds_read_b64_tr_b16 v[166:167], v21 offset:36864
    s_waitcnt lgkmcnt(10)
    v_mfma_f32_16x16x32_bf16 v[224:227], v[176:179], v[120:123], v[224:227]
    v_mfma_f32_16x16x32_bf16 v[228:231], v[176:179], v[124:127], v[228:231]
    ds_read_b64_tr_b16 v[168:169], v22 offset:32768
    ds_read_b64_tr_b16 v[170:171], v22 offset:36864
    s_waitcnt lgkmcnt(10)
    v_mfma_f32_16x16x32_bf16 v[232:235], v[180:183], v[120:123], v[232:235]
    v_mfma_f32_16x16x32_bf16 v[236:239], v[180:183], v[124:127], v[236:239]
    ds_read_b64_tr_b16 v[172:173], v23 offset:32768
    ds_read_b64_tr_b16 v[174:175], v23 offset:36864
    s_waitcnt lgkmcnt(10)
    v_mfma_f32_16x16x32_bf16 v[240:243], v[184:187], v[120:123], v[240:243]
    v_mfma_f32_16x16x32_bf16 v[244:247], v[184:187], v[124:127], v[244:247]
    ds_read_b64_tr_b16 v[176:177], v24 offset:32768
    ds_read_b64_tr_b16 v[178:179], v24 offset:36864
    s_waitcnt lgkmcnt(10)
    v_mfma_f32_16x16x32_bf16 v[248:251], v[188:191], v[120:123], v[248:251]
    v_mfma_f32_16x16x32_bf16 v[252:255], v[188:191], v[124:127], v[252:255]
    ds_read_b64_tr_b16 v[180:181], v25 offset:32768
    ds_read_b64_tr_b16 v[182:183], v25 offset:36864
    s_waitcnt lgkmcnt(10)
    v_mfma_f32_16x16x32_bf16 v[192:195], v[160:163], v[128:131], v[192:195]
    v_mfma_f32_16x16x32_bf16 v[196:199], v[160:163], v[132:135], v[196:199]
    ds_read_b64_tr_b16 v[184:185], v26 offset:32768
    ds_read_b64_tr_b16 v[186:187], v26 offset:36864
    s_waitcnt lgkmcnt(10)
    v_mfma_f32_16x16x32_bf16 v[200:203], v[164:167], v[128:131], v[200:203]
    v_mfma_f32_16x16x32_bf16 v[204:207], v[164:167], v[132:135], v[204:207]
    ds_read_b64_tr_b16 v[188:189], v27 offset:32768
    ds_read_b64_tr_b16 v[190:191], v27 offset:36864
    s_waitcnt lgkmcnt(10)
    v_mfma_f32_16x16x32_bf16 v[208:211], v[168:171], v[128:131], v[208:211]
    v_mfma_f32_16x16x32_bf16 v[212:215], v[168:171], v[132:135], v[212:215]
    ds_read_b64_tr_b16 v[160:161], v20 offset:40960
    ds_read_b64_tr_b16 v[162:163], v20 offset:45056
    s_waitcnt lgkmcnt(10)
    v_mfma_f32_16x16x32_bf16 v[216:219], v[172:175], v[128:131], v[216:219]
    v_mfma_f32_16x16x32_bf16 v[220:223], v[172:175], v[132:135], v[220:223]
    ds_read_b64_tr_b16 v[164:165], v21 offset:40960
    ds_read_b64_tr_b16 v[166:167], v21 offset:45056
    s_waitcnt vmcnt(6)
    s_barrier
    s_mov_b32 m0, s39
    s_nop 0
    buffer_load_dwordx4 v28, s[8:11], s35 offen lds
    buffer_load_dwordx4 v29, s[8:11], s35 offen offset:1024 lds
    s_add_u32 s35, s35, 16384
    s_mov_b32 m0, s41
    s_nop 0
    buffer_load_dwordx4 v30, s[12:15], s36 offen lds
    buffer_load_dwordx4 v31, s[12:15], s36 offen offset:1024 lds
    s_add_u32 s36, s36, 16384
    s_lshl_b32 s47, s2, 3
    s_add_u32 s47, s47, s33
    s_lshl_b32 s47, s47, 6
    v_lshl_add_u32 v104, v7, 4, v5
    v_add_u32 v104, s47, v104
    s_mov_b32 s47, 19174016
    v_mul_hi_u32 v106, v104, s47
    s_mov_b32 s47, 224
    v_mul_lo_u32 v107, v106, s47
    v_sub_u32 v107, v104, v107
    v_lshrrev_b32 v105, 2, v107
    v_and_b32 v107, 3, v107
    v_lshlrev_b32 v105, 15, v105
    v_lshl_add_u32 v105, v106, 6, v105
    v_lshl_add_u32 v105, v107, 4, v105
    v_mov_b32 v107, 0x7fffffff
    v_cmp_gt_u32 vcc, 512, v106
    v_lshlrev_b32 v104, 4, v104
    v_cndmask_b32 v105, v107, v105, vcc
    s_mov_b32 s56, s84
    s_mov_b32 s57, s85
    s_mov_b32 s58, 1835008
    s_mov_b32 s59, 0x00020000
    buffer_load_dwordx4 v[96:99], v104, s[56:59], 0 offen
    s_mov_b32 s56, s86
    s_mov_b32 s57, s87
    s_mov_b32 s58, 1835008
    s_mov_b32 s59, 0x00020000
    buffer_load_dwordx4 v[100:103], v104, s[56:59], 0 offen
    s_waitcnt lgkmcnt(10)
    v_mfma_f32_16x16x32_bf16 v[224:227], v[176:179], v[128:131], v[224:227]
    v_mfma_f32_16x16x32_bf16 v[228:231], v[176:179], v[132:135], v[228:231]
    ds_read_b64_tr_b16 v[168:169], v22 offset:40960
    ds_read_b64_tr_b16 v[170:171], v22 offset:45056
    s_waitcnt lgkmcnt(10)
    v_mfma_f32_16x16x32_bf16 v[232:235], v[180:183], v[128:131], v[232:235]
    v_mfma_f32_16x16x32_bf16 v[236:239], v[180:183], v[132:135], v[236:239]
    ds_read_b64_tr_b16 v[172:173], v23 offset:40960
    ds_read_b64_tr_b16 v[174:175], v23 offset:45056
    s_waitcnt lgkmcnt(10)
    v_mfma_f32_16x16x32_bf16 v[240:243], v[184:187], v[128:131], v[240:243]
    v_mfma_f32_16x16x32_bf16 v[244:247], v[184:187], v[132:135], v[244:247]
    ds_read_b64_tr_b16 v[176:177], v24 offset:40960
    ds_read_b64_tr_b16 v[178:179], v24 offset:45056
    s_waitcnt lgkmcnt(10)
    v_mfma_f32_16x16x32_bf16 v[248:251], v[188:191], v[128:131], v[248:251]
    v_mfma_f32_16x16x32_bf16 v[252:255], v[188:191], v[132:135], v[252:255]
    ds_read_b64_tr_b16 v[180:181], v25 offset:40960
    ds_read_b64_tr_b16 v[182:183], v25 offset:45056
    s_waitcnt lgkmcnt(10)
    v_mfma_f32_16x16x32_bf16 v[192:195], v[160:163], v[136:139], v[192:195]
    v_mfma_f32_16x16x32_bf16 v[196:199], v[160:163], v[140:143], v[196:199]
    ds_read_b64_tr_b16 v[184:185], v26 offset:40960
    ds_read_b64_tr_b16 v[186:187], v26 offset:45056
    s_waitcnt lgkmcnt(10)
    v_mfma_f32_16x16x32_bf16 v[200:203], v[164:167], v[136:139], v[200:203]
    v_mfma_f32_16x16x32_bf16 v[204:207], v[164:167], v[140:143], v[204:207]
    ds_read_b64_tr_b16 v[188:189], v27 offset:40960
    ds_read_b64_tr_b16 v[190:191], v27 offset:45056
    s_waitcnt lgkmcnt(10)
    v_mfma_f32_16x16x32_bf16 v[208:211], v[168:171], v[136:139], v[208:211]
    v_mfma_f32_16x16x32_bf16 v[212:215], v[168:171], v[140:143], v[212:215]
    ds_read_b64_tr_b16 v[160:161], v20 offset:49152
    ds_read_b64_tr_b16 v[162:163], v20 offset:53248
    s_waitcnt lgkmcnt(10)
    v_mfma_f32_16x16x32_bf16 v[216:219], v[172:175], v[136:139], v[216:219]
    v_mfma_f32_16x16x32_bf16 v[220:223], v[172:175], v[140:143], v[220:223]
    ds_read_b64_tr_b16 v[164:165], v21 offset:49152
    ds_read_b64_tr_b16 v[166:167], v21 offset:53248
    s_waitcnt lgkmcnt(10)
    v_mfma_f32_16x16x32_bf16 v[224:227], v[176:179], v[136:139], v[224:227]
    v_mfma_f32_16x16x32_bf16 v[228:231], v[176:179], v[140:143], v[228:231]
    ds_read_b64_tr_b16 v[168:169], v22 offset:49152
    ds_read_b64_tr_b16 v[170:171], v22 offset:53248
    s_waitcnt lgkmcnt(10)
    v_mfma_f32_16x16x32_bf16 v[232:235], v[180:183], v[136:139], v[232:235]
    v_mfma_f32_16x16x32_bf16 v[236:239], v[180:183], v[140:143], v[236:239]
    ds_read_b64_tr_b16 v[172:173], v23 offset:49152
    ds_read_b64_tr_b16 v[174:175], v23 offset:53248
    s_waitcnt lgkmcnt(10)
    v_mfma_f32_16x16x32_bf16 v[240:243], v[184:187], v[136:139], v[240:243]
    v_mfma_f32_16x16x32_bf16 v[244:247], v[184:187], v[140:143], v[244:247]
    ds_read_b64_tr_b16 v[176:177], v24 offset:49152
    ds_read_b64_tr_b16 v[178:179], v24 offset:53248
    s_waitcnt lgkmcnt(10)
    v_mfma_f32_16x16x32_bf16 v[248:251], v[188:191], v[136:139], v[248:251]
    v_mfma_f32_16x16x32_bf16 v[252:255], v[188:191], v[140:143], v[252:255]
    ds_read_b64_tr_b16 v[180:181], v25 offset:49152
    ds_read_b64_tr_b16 v[182:183], v25 offset:53248
    s_waitcnt lgkmcnt(10)
    v_mfma_f32_16x16x32_bf16 v[192:195], v[160:163], v[144:147], v[192:195]
    v_mfma_f32_16x16x32_bf16 v[196:199], v[160:163], v[148:151], v[196:199]
    ds_read_b64_tr_b16 v[184:185], v26 offset:49152
    ds_read_b64_tr_b16 v[186:187], v26 offset:53248
    s_waitcnt lgkmcnt(10)
    v_mfma_f32_16x16x32_bf16 v[200:203], v[164:167], v[144:147], v[200:203]
    v_mfma_f32_16x16x32_bf16 v[204:207], v[164:167], v[148:151], v[204:207]
    ds_read_b64_tr_b16 v[188:189], v27 offset:49152
    ds_read_b64_tr_b16 v[190:191], v27 offset:53248
    s_waitcnt lgkmcnt(10)
    v_mfma_f32_16x16x32_bf16 v[208:211], v[168:171], v[144:147], v[208:211]
    v_mfma_f32_16x16x32_bf16 v[212:215], v[168:171], v[148:151], v[212:215]
    ds_read_b64_tr_b16 v[160:161], v20 offset:57344
    ds_read_b64_tr_b16 v[162:163], v20 offset:61440
    s_waitcnt lgkmcnt(10)
    v_mfma_f32_16x16x32_bf16 v[216:219], v[172:175], v[144:147], v[216:219]
    v_mfma_f32_16x16x32_bf16 v[220:223], v[172:175], v[148:151], v[220:223]
    ds_read_b64_tr_b16 v[164:165], v21 offset:57344
    ds_read_b64_tr_b16 v[166:167], v21 offset:61440
    s_waitcnt lgkmcnt(10)
    v_mfma_f32_16x16x32_bf16 v[224:227], v[176:179], v[144:147], v[224:227]
    v_mfma_f32_16x16x32_bf16 v[228:231], v[176:179], v[148:151], v[228:231]
    ds_read_b64_tr_b16 v[168:169], v22 offset:57344
    ds_read_b64_tr_b16 v[170:171], v22 offset:61440
    s_waitcnt lgkmcnt(10)
    v_mfma_f32_16x16x32_bf16 v[232:235], v[180:183], v[144:147], v[232:235]
    v_mfma_f32_16x16x32_bf16 v[236:239], v[180:183], v[148:151], v[236:239]
    ds_read_b64_tr_b16 v[172:173], v23 offset:57344
    ds_read_b64_tr_b16 v[174:175], v23 offset:61440
    s_waitcnt lgkmcnt(10)
    v_mfma_f32_16x16x32_bf16 v[240:243], v[184:187], v[144:147], v[240:243]
    v_mfma_f32_16x16x32_bf16 v[244:247], v[184:187], v[148:151], v[244:247]
    ds_read_b64_tr_b16 v[176:177], v24 offset:57344
    ds_read_b64_tr_b16 v[178:179], v24 offset:61440
    s_waitcnt lgkmcnt(10)
    v_mfma_f32_16x16x32_bf16 v[248:251], v[188:191], v[144:147], v[248:251]
    v_mfma_f32_16x16x32_bf16 v[252:255], v[188:191], v[148:151], v[252:255]
    ds_read_b64_tr_b16 v[180:181], v25 offset:57344
    ds_read_b64_tr_b16 v[182:183], v25 offset:61440
    s_waitcnt lgkmcnt(10)
    v_mfma_f32_16x16x32_bf16 v[192:195], v[160:163], v[152:155], v[192:195]
    v_mfma_f32_16x16x32_bf16 v[196:199], v[160:163], v[156:159], v[196:199]
    ds_read_b64_tr_b16 v[184:185], v26 offset:57344
    ds_read_b64_tr_b16 v[186:187], v26 offset:61440
    s_waitcnt lgkmcnt(10)
    v_mfma_f32_16x16x32_bf16 v[200:203], v[164:167], v[152:155], v[200:203]
    v_mfma_f32_16x16x32_bf16 v[204:207], v[164:167], v[156:159], v[204:207]
    ds_read_b64_tr_b16 v[188:189], v27 offset:57344
    ds_read_b64_tr_b16 v[190:191], v27 offset:61440
    s_waitcnt lgkmcnt(10)
    v_mfma_f32_16x16x32_bf16 v[208:211], v[168:171], v[152:155], v[208:211]
    v_mfma_f32_16x16x32_bf16 v[212:215], v[168:171], v[156:159], v[212:215]
    s_waitcnt lgkmcnt(8)
    v_mfma_f32_16x16x32_bf16 v[216:219], v[172:175], v[152:155], v[216:219]
    v_mfma_f32_16x16x32_bf16 v[220:223], v[172:175], v[156:159], v[220:223]
    s_waitcnt lgkmcnt(6)
    v_mfma_f32_16x16x32_bf16 v[224:227], v[176:179], v[152:155], v[224:227]
    v_mfma_f32_16x16x32_bf16 v[228:231], v[176:179], v[156:159], v[228:231]
    s_waitcnt lgkmcnt(4)
    v_mfma_f32_16x16x32_bf16 v[232:235], v[180:183], v[152:155], v[232:235]
    v_mfma_f32_16x16x32_bf16 v[236:239], v[180:183], v[156:159], v[236:239]
    s_waitcnt lgkmcnt(2)
    v_mfma_f32_16x16x32_bf16 v[240:243], v[184:187], v[152:155], v[240:243]
    v_mfma_f32_16x16x32_bf16 v[244:247], v[184:187], v[156:159], v[244:247]
    s_waitcnt lgkmcnt(0)
    v_mfma_f32_16x16x32_bf16 v[248:251], v[188:191], v[152:155], v[248:251]
    v_mfma_f32_16x16x32_bf16 v[252:255], v[188:191], v[156:159], v[252:255]
    s_nop 15
    s_barrier
    v_add_u32 v20, -49152, v20
    v_add_u32 v21, -49152, v21
    v_add_u32 v22, -49152, v22
    v_add_u32 v23, -49152, v23
    v_add_u32 v24, -49152, v24
    v_add_u32 v25, -49152, v25
    v_add_u32 v26, -49152, v26
    v_add_u32 v27, -49152, v27
    v_mov_b32 v40, v6
    v_mov_b32 v41, v7
    v_mov_b32 v42, v5
    v_xor_b32 v8, 0, v6
    v_cvt_pk_bf16_f32 v48, v192, v193
    v_cvt_pk_bf16_f32 v49, v194, v195
    ds_write_b64 v8, v[48:49] offset:0
    v_cvt_pk_bf16_f32 v50, v196, v197
    v_cvt_pk_bf16_f32 v51, v198, v199
    ds_write_b64 v8, v[50:51] offset:4096
    v_xor_b32 v8, 32, v6
    v_cvt_pk_bf16_f32 v52, v200, v201
    v_cvt_pk_bf16_f32 v53, v202, v203
    ds_write_b64 v8, v[52:53] offset:0
    v_cvt_pk_bf16_f32 v54, v204, v205
    v_cvt_pk_bf16_f32 v55, v206, v207
    ds_write_b64 v8, v[54:55] offset:4096
    v_xor_b32 v8, 64, v6
    v_cvt_pk_bf16_f32 v56, v208, v209
    v_cvt_pk_bf16_f32 v57, v210, v211
    ds_write_b64 v8, v[56:57] offset:0
    v_cvt_pk_bf16_f32 v58, v212, v213
    v_cvt_pk_bf16_f32 v59, v214, v215
    ds_write_b64 v8, v[58:59] offset:4096
    v_xor_b32 v8, 96, v6
    v_cvt_pk_bf16_f32 v60, v216, v217
    v_cvt_pk_bf16_f32 v61, v218, v219
    ds_write_b64 v8, v[60:61] offset:0
    v_cvt_pk_bf16_f32 v62, v220, v221
    v_cvt_pk_bf16_f32 v63, v222, v223
    ds_write_b64 v8, v[62:63] offset:4096
    v_xor_b32 v8, 128, v6
    v_cvt_pk_bf16_f32 v64, v224, v225
    v_cvt_pk_bf16_f32 v65, v226, v227
    ds_write_b64 v8, v[64:65] offset:0
    v_cvt_pk_bf16_f32 v66, v228, v229
    v_cvt_pk_bf16_f32 v67, v230, v231
    ds_write_b64 v8, v[66:67] offset:4096
    v_xor_b32 v8, 160, v6
    v_cvt_pk_bf16_f32 v68, v232, v233
    v_cvt_pk_bf16_f32 v69, v234, v235
    ds_write_b64 v8, v[68:69] offset:0
    v_cvt_pk_bf16_f32 v70, v236, v237
    v_cvt_pk_bf16_f32 v71, v238, v239
    ds_write_b64 v8, v[70:71] offset:4096
    v_xor_b32 v8, 192, v6
    v_cvt_pk_bf16_f32 v72, v240, v241
    v_cvt_pk_bf16_f32 v73, v242, v243
    ds_write_b64 v8, v[72:73] offset:0
    v_cvt_pk_bf16_f32 v74, v244, v245
    v_cvt_pk_bf16_f32 v75, v246, v247
    ds_write_b64 v8, v[74:75] offset:4096
    v_xor_b32 v8, 224, v6
    v_cvt_pk_bf16_f32 v76, v248, v249
    v_cvt_pk_bf16_f32 v77, v250, v251
    ds_write_b64 v8, v[76:77] offset:0
    v_cvt_pk_bf16_f32 v78, v252, v253
    v_cvt_pk_bf16_f32 v79, v254, v255
    ds_write_b64 v8, v[78:79] offset:4096
    v_add_u32 v8, s55, v16
    v_add_u32 v9, s55, v17
    v_add_u32 v10, s55, v18
    v_add_u32 v11, s55, v19
    s_waitcnt lgkmcnt(0)
    ds_read_b128 v[160:163], v8 offset:0
    ds_read_b128 v[164:167], v9 offset:0
    ds_read_b128 v[168:171], v10 offset:0
    ds_read_b128 v[172:175], v11 offset:0
    ds_read_b128 v[176:179], v8 offset:4096
    ds_read_b128 v[180:183], v9 offset:4096
    ds_read_b128 v[184:187], v10 offset:4096
    ds_read_b128 v[188:191], v11 offset:4096
    v_mov_b32 v12, 0x3f803f80
    v_mov_b32 v13, 0x3f803f80
    v_mov_b32 v14, 0x3f803f80
    v_mov_b32 v15, 0x3f803f80
    v_mov_b32 v192, 0
    v_mov_b32 v193, 0
    v_mov_b32 v194, 0
    v_mov_b32 v195, 0
    v_mov_b32 v196, 0
    v_mov_b32 v197, 0
    v_mov_b32 v198, 0
    v_mov_b32 v199, 0
    v_mov_b32 v200, 0
    v_mov_b32 v201, 0
    v_mov_b32 v202, 0
    v_mov_b32 v203, 0
    v_mov_b32 v204, 0
    v_mov_b32 v205, 0
    v_mov_b32 v206, 0
    v_mov_b32 v207, 0
    v_mov_b32 v208, 0
    v_mov_b32 v209, 0
    v_mov_b32 v210, 0
    v_mov_b32 v211, 0
    v_mov_b32 v212, 0
    v_mov_b32 v213, 0
    v_mov_b32 v214, 0
    v_mov_b32 v215, 0
    v_mov_b32 v216, 0
    v_mov_b32 v217, 0
    v_mov_b32 v218, 0
    v_mov_b32 v219, 0
    v_mov_b32 v220, 0
    v_mov_b32 v221, 0
    v_mov_b32 v222, 0
    v_mov_b32 v223, 0
    v_mov_b32 v224, 0
    v_mov_b32 v225, 0
    v_mov_b32 v226, 0
    v_mov_b32 v227, 0
    v_mov_b32 v228, 0
    v_mov_b32 v229, 0
    v_mov_b32 v230, 0
    v_mov_b32 v231, 0
    v_mov_b32 v232, 0
    v_mov_b32 v233, 0
    v_mov_b32 v234, 0
    v_mov_b32 v235, 0
    v_mov_b32 v236, 0
    v_mov_b32 v237, 0
    v_mov_b32 v238, 0
    v_mov_b32 v239, 0
    v_mov_b32 v240, 0
    v_mov_b32 v241, 0
    v_mov_b32 v242, 0
    v_mov_b32 v243, 0
    v_mov_b32 v244, 0
    v_mov_b32 v245, 0
    v_mov_b32 v246, 0
    v_mov_b32 v247, 0
    v_mov_b32 v248, 0
    v_mov_b32 v249, 0
    v_mov_b32 v250, 0
    v_mov_b32 v251, 0
    v_mov_b32 v252, 0
    v_mov_b32 v253, 0
    v_mov_b32 v254, 0
    v_mov_b32 v255, 0
    v_mov_b32 v1, 0xff800000
    v_mov_b32 v2, 0xff800000
    v_mov_b32 v3, 0xff800000
    v_mov_b32 v32, 0
    v_mov_b32 v33, 0
    v_mov_b32 v34, 0
    v_mov_b32 v35, 0
    v_mov_b32 v36, 0
    v_mov_b32 v37, 0
    v_mov_b32 v38, 0
    v_mov_b32 v39, 0
    v_mov_b32 v10, s34
    v_mov_b32 v11, s32
    s_waitcnt vmcnt(0) lgkmcnt(0)
    s_barrier
    s_add_u32 s56, s30, 0x2a00000
    s_addc_u32 s57, s31, 0
    s_mov_b32 s58, 1835008
    s_mov_b32 s59, 0x00020000
    buffer_store_dwordx4 v[96:99], v105, s[56:59], 0 offen
    s_add_u32 s56, s30, 0x2c00000
    s_addc_u32 s57, s31, 0
    s_mov_b32 s58, 1835008
    s_mov_b32 s59, 0x00020000
    buffer_store_dwordx4 v[100:103], v105, s[56:59], 0 offen
    ds_read_b128 v[48:51], v16 offset:0
    ds_read_b128 v[52:55], v17 offset:0
    ds_read_b128 v[56:59], v18 offset:0
    ds_read_b128 v[60:63], v19 offset:0
    ds_read_b128 v[64:67], v16 offset:4096
    ds_read_b128 v[68:71], v17 offset:4096
    s_waitcnt lgkmcnt(5)
    v_mfma_f32_16x16x32_bf16 v[96:99], v[48:51], v[160:163], 0
    v_mfma_f32_16x16x32_bf16 v[100:103], v[48:51], v[176:179], 0
    ds_read_b128 v[72:75], v18 offset:4096
    s_waitcnt lgkmcnt(5)
    v_mfma_f32_16x16x32_bf16 v[96:99], v[52:55], v[164:167], v[96:99]
    v_mfma_f32_16x16x32_bf16 v[100:103], v[52:55], v[180:183], v[100:103]
    ds_read_b128 v[76:79], v19 offset:4096
    s_waitcnt lgkmcnt(5)
    v_mfma_f32_16x16x32_bf16 v[96:99], v[56:59], v[168:171], v[96:99]
    v_mfma_f32_16x16x32_bf16 v[100:103], v[56:59], v[184:187], v[100:103]
    ds_read_b128 v[48:51], v16 offset:8192
    s_waitcnt lgkmcnt(5)
    v_mfma_f32_16x16x32_bf16 v[96:99], v[60:63], v[172:175], v[96:99]
    v_mfma_f32_16x16x32_bf16 v[100:103], v[60:63], v[188:191], v[100:103]
    ds_read_b128 v[52:55], v17 offset:8192
    s_waitcnt lgkmcnt(5)
    v_mfma_f32_16x16x32_bf16 v[104:107], v[64:67], v[160:163], 0
    v_mfma_f32_16x16x32_bf16 v[108:111], v[64:67], v[176:179], 0
    ds_read_b128 v[56:59], v18 offset:8192
    s_waitcnt lgkmcnt(5)
    v_mfma_f32_16x16x32_bf16 v[104:107], v[68:71], v[164:167], v[104:107]
    v_mfma_f32_16x16x32_bf16 v[108:111], v[68:71], v[180:183], v[108:111]
    ds_read_b128 v[60:63], v19 offset:8192
    s_waitcnt lgkmcnt(5)
    v_mfma_f32_16x16x32_bf16 v[104:107], v[72:75], v[168:171], v[104:107]
    v_mfma_f32_16x16x32_bf16 v[108:111], v[72:75], v[184:187], v[108:111]
    ds_read_b128 v[64:67], v16 offset:12288
    s_waitcnt lgkmcnt(5)
    v_mfma_f32_16x16x32_bf16 v[104:107], v[76:79], v[172:175], v[104:107]
    v_mfma_f32_16x16x32_bf16 v[108:111], v[76:79], v[188:191], v[108:111]
    ds_read_b128 v[68:71], v17 offset:12288
    s_waitcnt lgkmcnt(5)
    v_mfma_f32_16x16x32_bf16 v[112:115], v[48:51], v[160:163], 0
    v_mfma_f32_16x16x32_bf16 v[116:119], v[48:51], v[176:179], 0
    ds_read_b128 v[72:75], v18 offset:12288
    s_waitcnt lgkmcnt(5)
    v_mfma_f32_16x16x32_bf16 v[112:115], v[52:55], v[164:167], v[112:115]
    v_mfma_f32_16x16x32_bf16 v[116:119], v[52:55], v[180:183], v[116:119]
    ds_read_b128 v[76:79], v19 offset:12288
    s_waitcnt lgkmcnt(5)
    v_mfma_f32_16x16x32_bf16 v[112:115], v[56:59], v[168:171], v[112:115]
    v_mfma_f32_16x16x32_bf16 v[116:119], v[56:59], v[184:187], v[116:119]
    ds_read_b128 v[48:51], v16 offset:16384
    s_waitcnt lgkmcnt(5)
    v_mfma_f32_16x16x32_bf16 v[112:115], v[60:63], v[172:175], v[112:115]
    v_mfma_f32_16x16x32_bf16 v[116:119], v[60:63], v[188:191], v[116:119]
    ds_read_b128 v[52:55], v17 offset:16384
    s_waitcnt lgkmcnt(5)
    v_mfma_f32_16x16x32_bf16 v[120:123], v[64:67], v[160:163], 0
    v_mfma_f32_16x16x32_bf16 v[124:127], v[64:67], v[176:179], 0
    ds_read_b128 v[56:59], v18 offset:16384
    s_waitcnt lgkmcnt(5)
    v_mfma_f32_16x16x32_bf16 v[120:123], v[68:71], v[164:167], v[120:123]
    v_mfma_f32_16x16x32_bf16 v[124:127], v[68:71], v[180:183], v[124:127]
    ds_read_b128 v[60:63], v19 offset:16384
    s_waitcnt lgkmcnt(5)
    v_mfma_f32_16x16x32_bf16 v[120:123], v[72:75], v[168:171], v[120:123]
    v_mfma_f32_16x16x32_bf16 v[124:127], v[72:75], v[184:187], v[124:127]
    ds_read_b128 v[64:67], v16 offset:20480
    s_waitcnt lgkmcnt(5)
    v_mfma_f32_16x16x32_bf16 v[120:123], v[76:79], v[172:175], v[120:123]
    v_mfma_f32_16x16x32_bf16 v[124:127], v[76:79], v[188:191], v[124:127]
    ds_read_b128 v[68:71], v17 offset:20480
    s_nop 15
    v_max3_f32 v4, v96, v97, v98
    v_max3_f32 v5, v100, v101, v102
    v_max3_f32 v4, v4, v99, v104
    v_max3_f32 v5, v5, v103, v108
    v_max3_f32 v4, v4, v105, v106
    v_max3_f32 v5, v5, v109, v110
    v_max3_f32 v4, v4, v107, v112
    v_max3_f32 v5, v5, v111, v116
    v_max3_f32 v4, v4, v113, v114
    v_max3_f32 v5, v5, v117, v118
    v_max3_f32 v4, v4, v115, v120
    v_max3_f32 v5, v5, v119, v124
    v_max3_f32 v4, v4, v121, v122
    v_max3_f32 v5, v5, v125, v126
    v_max_f32 v4, v4, v123
    v_max_f32 v5, v5, v127
    s_nop 1
    v_permlane32_swap_b32 v4, v5
    v_max_f32 v4, v4, v5
    v_mov_b32 v6, v4
    v_add_f32 v5, 0x41000000, v1
    s_nop 0
    v_permlane16_swap_b32 v4, v6
    v_max_f32 v4, v4, v6
    v_cvt_pk_bf16_f32 v4, 0, v4
    v_mul_f32 v4, s34, v4
    v_cvt_pk_bf16_f32 v4, 0, v4
    v_mul_f32 v4, s32, v4
    v_cmp_gt_f32 vcc, v4, v5
    s_nop 1
    s_cbranch_vccz L_k3_skip1
    s_nop 15
    v_max_f32 v4, v4, v1
    v_sub_f32 v5, v1, v4
    v_exp_f32 v5, v5
    v_mov_b32 v1, v4
    v_mov_b32 v2, v4
    v_mov_b32 v3, v4
    v_mov_b32 v6, v5
    s_nop 1
    v_permlane32_swap_b32 v2, v3
    v_permlane32_swap_b32 v5, v6
    s_nop 1
    v_mul_f32 v32, v32, v5
    v_mul_f32 v36, v36, v6
    v_mul_f32 v192, v192, v5
    v_mul_f32 v193, v193, v5
    v_mul_f32 v194, v194, v5
    v_mul_f32 v195, v195, v5
    v_mul_f32 v196, v196, v6
    v_mul_f32 v197, v197, v6
    v_mul_f32 v198, v198, v6
    v_mul_f32 v199, v199, v6
    v_mul_f32 v200, v200, v5
    v_mul_f32 v201, v201, v5
    v_mul_f32 v202, v202, v5
    v_mul_f32 v203, v203, v5
    v_mul_f32 v204, v204, v6
    v_mul_f32 v205, v205, v6
    v_mul_f32 v206, v206, v6
    v_mul_f32 v207, v207, v6
    v_mul_f32 v208, v208, v5
    v_mul_f32 v209, v209, v5
    v_mul_f32 v210, v210, v5
    v_mul_f32 v211, v211, v5
    v_mul_f32 v212, v212, v6
    v_mul_f32 v213, v213, v6
    v_mul_f32 v214, v214, v6
    v_mul_f32 v215, v215, v6
    v_mul_f32 v216, v216, v5
    v_mul_f32 v217, v217, v5
    v_mul_f32 v218, v218, v5
    v_mul_f32 v219, v219, v5
    v_mul_f32 v220, v220, v6
    v_mul_f32 v221, v221, v6
    v_mul_f32 v222, v222, v6
    v_mul_f32 v223, v223, v6
    v_mul_f32 v224, v224, v5
    v_mul_f32 v225, v225, v5
    v_mul_f32 v226, v226, v5
    v_mul_f32 v227, v227, v5
    v_mul_f32 v228, v228, v6
    v_mul_f32 v229, v229, v6
    v_mul_f32 v230, v230, v6
    v_mul_f32 v231, v231, v6
    v_mul_f32 v232, v232, v5
    v_mul_f32 v233, v233, v5
    v_mul_f32 v234, v234, v5
    v_mul_f32 v235, v235, v5
    v_mul_f32 v236, v236, v6
    v_mul_f32 v237, v237, v6
    v_mul_f32 v238, v238, v6
    v_mul_f32 v239, v239, v6
    v_mul_f32 v240, v240, v5
    v_mul_f32 v241, v241, v5
    v_mul_f32 v242, v242, v5
    v_mul_f32 v243, v243, v5
    v_mul_f32 v244, v244, v6
    v_mul_f32 v245, v245, v6
    v_mul_f32 v246, v246, v6
    v_mul_f32 v247, v247, v6
    v_mul_f32 v248, v248, v5
    v_mul_f32 v249, v249, v5
    v_mul_f32 v250, v250, v5
    v_mul_f32 v251, v251, v5
    v_mul_f32 v252, v252, v6
    v_mul_f32 v253, v253, v6
    v_mul_f32 v254, v254, v6
    v_mul_f32 v255, v255, v6
    s_nop 1
L_k3_skip1:
    v_cvt_pk_bf16_f32 v96, 0, v96
    v_cvt_pk_bf16_f32 v97, 0, v97
    v_cvt_pk_bf16_f32 v98, 0, v98
    v_cvt_pk_bf16_f32 v99, 0, v99
    v_mul_f32 v96, s34, v96
    v_mul_f32 v97, s34, v97
    v_mul_f32 v98, s34, v98
    v_mul_f32 v99, s34, v99
    v_cvt_pk_bf16_f32 v96, 0, v96
    v_cvt_pk_bf16_f32 v97, 0, v97
    v_cvt_pk_bf16_f32 v98, 0, v98
    v_cvt_pk_bf16_f32 v99, 0, v99
    v_fma_f32 v96, v96, s32, -v2
    v_fma_f32 v97, v97, s32, -v2
    v_fma_f32 v98, v98, s32, -v2
    v_fma_f32 v99, v99, s32, -v2
    v_exp_f32 v96, v96
    v_exp_f32 v97, v97
    v_exp_f32 v98, v98
    v_exp_f32 v99, v99
    v_cvt_pk_bf16_f32 v80, v96, v97
    v_cvt_pk_bf16_f32 v81, v98, v99
    v_cvt_pk_bf16_f32 v100, 0, v100
    v_cvt_pk_bf16_f32 v101, 0, v101
    v_cvt_pk_bf16_f32 v102, 0, v102
    v_cvt_pk_bf16_f32 v103, 0, v103
    v_mul_f32 v100, s34, v100
    v_mul_f32 v101, s34, v101
    v_mul_f32 v102, s34, v102
    v_mul_f32 v103, s34, v103
    v_cvt_pk_bf16_f32 v100, 0, v100
    v_cvt_pk_bf16_f32 v101, 0, v101
    v_cvt_pk_bf16_f32 v102, 0, v102
    v_cvt_pk_bf16_f32 v103, 0, v103
    v_fma_f32 v100, v100, s32, -v3
    v_fma_f32 v101, v101, s32, -v3
    v_fma_f32 v102, v102, s32, -v3
    v_fma_f32 v103, v103, s32, -v3
    v_exp_f32 v100, v100
    v_exp_f32 v101, v101
    v_exp_f32 v102, v102
    v_exp_f32 v103, v103
    v_cvt_pk_bf16_f32 v84, v100, v101
    v_cvt_pk_bf16_f32 v85, v102, v103
    s_lshl_b32 s47, s2, 3
    s_add_u32 s47, s47, s33
    s_lshl_b32 s47, s47, 10
    v_lshl_add_u32 v43, v42, 4, s47
    v_lshl_add_u32 v43, v41, 8, v43
    s_mov_b32 s56, s80
    s_mov_b32 s57, s81
    s_mov_b32 s58, 4194304
    s_mov_b32 s59, 0x00020000
    buffer_load_dwordx4 v[44:47], v43, s[56:59], 0 offen
    s_mov_b32 s47, 2097152
    buffer_load_dwordx4 v[44:47], v43, s[56:59], s47 offen
    s_mov_b32 s56, s88
    s_mov_b32 s57, s89
    s_mov_b32 s58, 1835008
    s_mov_b32 s59, 0x00020000
    buffer_load_dwordx4 v[44:47], v43, s[56:59], 0 offen
    s_mov_b32 s43, 5
L_k3_loopf:
    s_waitcnt vmcnt(0)
    s_barrier
    s_waitcnt lgkmcnt(5)
    v_mfma_f32_16x16x32_bf16 v[128:131], v[48:51], v[160:163], 0
    s_setprio 3
    v_cvt_pk_bf16_f32 v104, 0, v104
    v_cvt_pk_bf16_f32 v105, 0, v105
    v_cvt_pk_bf16_f32 v106, 0, v106
    v_mfma_f32_16x16x32_bf16 v[132:135], v[48:51], v[176:179], 0
    ds_read_b128 v[72:75], v18 offset:20480
    v_cvt_pk_bf16_f32 v107, 0, v107
    v_mul_f32 v104, s34, v104
    v_mul_f32 v105, s34, v105
    s_waitcnt lgkmcnt(5)
    v_mfma_f32_16x16x32_bf16 v[128:131], v[52:55], v[164:167], v[128:131]
    v_mul_f32 v106, s34, v106
    v_mul_f32 v107, s34, v107
    s_mov_b32 m0, s37
    s_nop 0
    buffer_load_dwordx4 v28, s[8:11], s35 offen lds
    buffer_load_dwordx4 v29, s[8:11], s35 offen offset:1024 lds
    s_add_u32 s35, s35, 16384
    v_mfma_f32_16x16x32_bf16 v[132:135], v[52:55], v[180:183], v[132:135]
    ds_read_b128 v[76:79], v19 offset:20480
    v_cvt_pk_bf16_f32 v104, 0, v104
    v_cvt_pk_bf16_f32 v105, 0, v105
    v_cvt_pk_bf16_f32 v106, 0, v106
    s_waitcnt lgkmcnt(5)
    v_mfma_f32_16x16x32_bf16 v[128:131], v[56:59], v[168:171], v[128:131]
    v_cvt_pk_bf16_f32 v107, 0, v107
    v_fma_f32 v104, v104, s32, -v2
    v_fma_f32 v105, v105, s32, -v2
    v_mfma_f32_16x16x32_bf16 v[132:135], v[56:59], v[184:187], v[132:135]
    ds_read_b128 v[48:51], v16 offset:24576
    v_fma_f32 v106, v106, s32, -v2
    v_fma_f32 v107, v107, s32, -v2
    s_waitcnt lgkmcnt(5)
    v_mfma_f32_16x16x32_bf16 v[128:131], v[60:63], v[172:175], v[128:131]
    v_exp_f32 v104, v104
    v_exp_f32 v105, v105
    v_exp_f32 v106, v106
    s_mov_b32 m0, s42
    s_nop 0
    buffer_load_dwordx4 v30, s[12:15], s36 offen lds
    buffer_load_dwordx4 v31, s[12:15], s36 offen offset:1024 lds
    s_add_u32 s36, s36, 16384
    v_mfma_f32_16x16x32_bf16 v[132:135], v[60:63], v[188:191], v[132:135]
    ds_read_b128 v[52:55], v17 offset:24576
    v_exp_f32 v107, v107
    v_cvt_pk_bf16_f32 v82, v104, v105
    v_cvt_pk_bf16_f32 v83, v106, v107
    s_waitcnt lgkmcnt(5)
    v_mfma_f32_16x16x32_bf16 v[136:139], v[64:67], v[160:163], 0
    v_cvt_pk_bf16_f32 v108, 0, v108
    v_cvt_pk_bf16_f32 v109, 0, v109
    v_mfma_f32_16x16x32_bf16 v[140:143], v[64:67], v[176:179], 0
    ds_read_b128 v[56:59], v18 offset:24576
    v_cvt_pk_bf16_f32 v110, 0, v110
    v_cvt_pk_bf16_f32 v111, 0, v111
    v_mul_f32 v108, s34, v108
    s_waitcnt lgkmcnt(5)
    v_mfma_f32_16x16x32_bf16 v[136:139], v[68:71], v[164:167], v[136:139]
    v_mul_f32 v109, s34, v109
    v_mul_f32 v110, s34, v110
    v_mul_f32 v111, s34, v111
    v_mfma_f32_16x16x32_bf16 v[140:143], v[68:71], v[180:183], v[140:143]
    ds_read_b128 v[60:63], v19 offset:24576
    v_cvt_pk_bf16_f32 v108, 0, v108
    v_cvt_pk_bf16_f32 v109, 0, v109
    s_waitcnt lgkmcnt(5)
    v_mfma_f32_16x16x32_bf16 v[136:139], v[72:75], v[168:171], v[136:139]
    v_cvt_pk_bf16_f32 v110, 0, v110
    v_cvt_pk_bf16_f32 v111, 0, v111
    v_fma_f32 v108, v108, s32, -v3
    v_mfma_f32_16x16x32_bf16 v[140:143], v[72:75], v[184:187], v[140:143]
    ds_read_b128 v[64:67], v16 offset:28672
    v_fma_f32 v109, v109, s32, -v3
    v_fma_f32 v110, v110, s32, -v3
    s_waitcnt lgkmcnt(5)
    v_mfma_f32_16x16x32_bf16 v[136:139], v[76:79], v[172:175], v[136:139]
    v_fma_f32 v111, v111, s32, -v3
    v_exp_f32 v108, v108
    v_exp_f32 v109, v109
    v_mfma_f32_16x16x32_bf16 v[140:143], v[76:79], v[188:191], v[140:143]
    ds_read_b128 v[68:71], v17 offset:28672
    v_exp_f32 v110, v110
    v_exp_f32 v111, v111
    v_cvt_pk_bf16_f32 v86, v108, v109
    s_waitcnt lgkmcnt(5)
    v_mfma_f32_16x16x32_bf16 v[144:147], v[48:51], v[160:163], 0
    v_cvt_pk_bf16_f32 v87, v110, v111
    v_cvt_pk_bf16_f32 v112, 0, v112
    v_mfma_f32_16x16x32_bf16 v[148:151], v[48:51], v[176:179], 0
    ds_read_b128 v[72:75], v18 offset:28672
    s_setprio 2
    v_cvt_pk_bf16_f32 v113, 0, v113
    v_cvt_pk_bf16_f32 v114, 0, v114
    v_cvt_pk_bf16_f32 v115, 0, v115
    s_waitcnt lgkmcnt(5)
    v_mfma_f32_16x16x32_bf16 v[144:147], v[52:55], v[164:167], v[144:147]
    v_mul_f32 v112, s34, v112
    v_mul_f32 v113, s34, v113
    v_mul_f32 v114, s34, v114
    v_mfma_f32_16x16x32_bf16 v[148:151], v[52:55], v[180:183], v[148:151]
    ds_read_b128 v[76:79], v19 offset:28672
    v_mul_f32 v115, s34, v115
    v_cvt_pk_bf16_f32 v112, 0, v112
    s_waitcnt lgkmcnt(5)
    v_mfma_f32_16x16x32_bf16 v[144:147], v[56:59], v[168:171], v[144:147]
    v_cvt_pk_bf16_f32 v113, 0, v113
    v_cvt_pk_bf16_f32 v114, 0, v114
    v_cvt_pk_bf16_f32 v115, 0, v115
    v_mfma_f32_16x16x32_bf16 v[148:151], v[56:59], v[184:187], v[148:151]
    ds_read_b64_tr_b16 v[48:49], v20 offset:0
    ds_read_b64_tr_b16 v[50:51], v20 offset:4096
    v_fma_f32 v112, v112, s32, -v2
    v_fma_f32 v113, v113, s32, -v2
    v_fma_f32 v114, v114, s32, -v2
    s_waitcnt lgkmcnt(6)
    v_mfma_f32_16x16x32_bf16 v[144:147], v[60:63], v[172:175], v[144:147]
    v_fma_f32 v115, v115, s32, -v2
    v_exp_f32 v112, v112
    v_mfma_f32_16x16x32_bf16 v[148:151], v[60:63], v[188:191], v[148:151]
    ds_read_b64_tr_b16 v[52:53], v21 offset:0
    ds_read_b64_tr_b16 v[54:55], v21 offset:4096
    v_exp_f32 v113, v113
    v_exp_f32 v114, v114
    v_exp_f32 v115, v115
    s_waitcnt lgkmcnt(7)
    v_mfma_f32_16x16x32_bf16 v[152:155], v[64:67], v[160:163], 0
    v_cvt_pk_bf16_f32 v88, v112, v113
    v_cvt_pk_bf16_f32 v89, v114, v115
    v_mfma_f32_16x16x32_bf16 v[156:159], v[64:67], v[176:179], 0
    ds_read_b64_tr_b16 v[56:57], v22 offset:0
    ds_read_b64_tr_b16 v[58:59], v22 offset:4096
    v_cvt_pk_bf16_f32 v116, 0, v116
    v_cvt_pk_bf16_f32 v117, 0, v117
    v_cvt_pk_bf16_f32 v118, 0, v118
    s_waitcnt lgkmcnt(8)
    v_mfma_f32_16x16x32_bf16 v[152:155], v[68:71], v[164:167], v[152:155]
    v_cvt_pk_bf16_f32 v119, 0, v119
    v_mul_f32 v116, s34, v116
    v_mul_f32 v117, s34, v117
    v_mfma_f32_16x16x32_bf16 v[156:159], v[68:71], v[180:183], v[156:159]
    ds_read_b64_tr_b16 v[60:61], v23 offset:0
    ds_read_b64_tr_b16 v[62:63], v23 offset:4096
    v_mul_f32 v118, s34, v118
    v_mul_f32 v119, s34, v119
    s_waitcnt lgkmcnt(9)
    v_mfma_f32_16x16x32_bf16 v[152:155], v[72:75], v[168:171], v[152:155]
    v_cvt_pk_bf16_f32 v116, 0, v116
    v_cvt_pk_bf16_f32 v117, 0, v117
    v_cvt_pk_bf16_f32 v118, 0, v118
    v_mfma_f32_16x16x32_bf16 v[156:159], v[72:75], v[184:187], v[156:159]
    ds_read_b64_tr_b16 v[64:65], v24 offset:0
    ds_read_b64_tr_b16 v[66:67], v24 offset:4096
    v_cvt_pk_bf16_f32 v119, 0, v119
    v_fma_f32 v116, v116, s32, -v3
    v_fma_f32 v117, v117, s32, -v3
    s_waitcnt lgkmcnt(10)
    v_mfma_f32_16x16x32_bf16 v[152:155], v[76:79], v[172:175], v[152:155]
    v_fma_f32 v118, v118, s32, -v3
    v_fma_f32 v119, v119, s32, -v3
    v_mfma_f32_16x16x32_bf16 v[156:159], v[76:79], v[188:191], v[156:159]
    ds_read_b64_tr_b16 v[68:69], v25 offset:0
    ds_read_b64_tr_b16 v[70:71], v25 offset:4096
    v_exp_f32 v116, v116
    v_exp_f32 v117, v117
    v_exp_f32 v118, v118
    s_waitcnt lgkmcnt(10)
    v_mfma_f32_16x16x32_bf16 v[192:195], v[48:51], v[80:83], v[192:195]
    v_exp_f32 v119, v119
    v_cvt_pk_bf16_f32 v92, v116, v117
    v_cvt_pk_bf16_f32 v93, v118, v119
    s_nop 1
    v_mfma_f32_16x16x32_bf16 v[196:199], v[48:51], v[84:87], v[196:199]
    ds_read_b64_tr_b16 v[72:73], v26 offset:0
    ds_read_b64_tr_b16 v[74:75], v26 offset:4096
    v_cvt_pk_bf16_f32 v120, 0, v120
    v_cvt_pk_bf16_f32 v121, 0, v121
    s_waitcnt lgkmcnt(10)
    v_mfma_f32_16x16x32_bf16 v[200:203], v[52:55], v[80:83], v[200:203]
    s_setprio 1
    v_cvt_pk_bf16_f32 v122, 0, v122
    v_cvt_pk_bf16_f32 v123, 0, v123
    v_mul_f32 v120, s34, v120
    v_mfma_f32_16x16x32_bf16 v[204:207], v[52:55], v[84:87], v[204:207]
    ds_read_b64_tr_b16 v[76:77], v27 offset:0
    ds_read_b64_tr_b16 v[78:79], v27 offset:4096
    v_mul_f32 v121, s34, v121
    v_mul_f32 v122, s34, v122
    v_mul_f32 v123, s34, v123
    s_waitcnt lgkmcnt(10)
    v_mfma_f32_16x16x32_bf16 v[208:211], v[56:59], v[80:83], v[208:211]
    v_cvt_pk_bf16_f32 v120, 0, v120
    v_cvt_pk_bf16_f32 v121, 0, v121
    v_mfma_f32_16x16x32_bf16 v[212:215], v[56:59], v[84:87], v[212:215]
    ds_read_b64_tr_b16 v[48:49], v20 offset:8192
    ds_read_b64_tr_b16 v[50:51], v20 offset:12288
    v_cvt_pk_bf16_f32 v122, 0, v122
    v_cvt_pk_bf16_f32 v123, 0, v123
    v_fma_f32 v120, v120, s32, -v2
    s_waitcnt lgkmcnt(10)
    v_mfma_f32_16x16x32_bf16 v[216:219], v[60:63], v[80:83], v[216:219]
    v_fma_f32 v121, v121, s32, -v2
    v_fma_f32 v122, v122, s32, -v2
    v_mfma_f32_16x16x32_bf16 v[220:223], v[60:63], v[84:87], v[220:223]
    ds_read_b64_tr_b16 v[52:53], v21 offset:8192
    ds_read_b64_tr_b16 v[54:55], v21 offset:12288
    v_fma_f32 v123, v123, s32, -v2
    v_exp_f32 v120, v120
    v_exp_f32 v121, v121
    s_waitcnt lgkmcnt(10)
    v_mfma_f32_16x16x32_bf16 v[224:227], v[64:67], v[80:83], v[224:227]
    v_exp_f32 v122, v122
    v_exp_f32 v123, v123
    v_cvt_pk_bf16_f32 v90, v120, v121
    s_nop 1
    v_mfma_f32_16x16x32_bf16 v[228:231], v[64:67], v[84:87], v[228:231]
    ds_read_b64_tr_b16 v[56:57], v22 offset:8192
    ds_read_b64_tr_b16 v[58:59], v22 offset:12288
    v_cvt_pk_bf16_f32 v91, v122, v123
    v_cvt_pk_bf16_f32 v124, 0, v124
    s_waitcnt lgkmcnt(10)
    v_mfma_f32_16x16x32_bf16 v[232:235], v[68:71], v[80:83], v[232:235]
    v_cvt_pk_bf16_f32 v125, 0, v125
    v_cvt_pk_bf16_f32 v126, 0, v126
    v_cvt_pk_bf16_f32 v127, 0, v127
    v_mfma_f32_16x16x32_bf16 v[236:239], v[68:71], v[84:87], v[236:239]
    ds_read_b64_tr_b16 v[60:61], v23 offset:8192
    ds_read_b64_tr_b16 v[62:63], v23 offset:12288
    v_mul_f32 v124, s34, v124
    v_mul_f32 v125, s34, v125
    v_mul_f32 v126, s34, v126
    s_waitcnt lgkmcnt(10)
    v_mfma_f32_16x16x32_bf16 v[240:243], v[72:75], v[80:83], v[240:243]
    v_mul_f32 v127, s34, v127
    v_cvt_pk_bf16_f32 v124, 0, v124
    v_mfma_f32_16x16x32_bf16 v[244:247], v[72:75], v[84:87], v[244:247]
    ds_read_b64_tr_b16 v[64:65], v24 offset:8192
    ds_read_b64_tr_b16 v[66:67], v24 offset:12288
    v_cvt_pk_bf16_f32 v125, 0, v125
    v_cvt_pk_bf16_f32 v126, 0, v126
    v_cvt_pk_bf16_f32 v127, 0, v127
    s_waitcnt lgkmcnt(10)
    v_mfma_f32_16x16x32_bf16 v[248:251], v[76:79], v[80:83], v[248:251]
    v_fma_f32 v124, v124, s32, -v3
    v_fma_f32 v125, v125, s32, -v3
    v_fma_f32 v126, v126, s32, -v3
    v_mfma_f32_16x16x32_bf16 v[252:255], v[76:79], v[84:87], v[252:255]
    ds_read_b64_tr_b16 v[68:69], v25 offset:8192
    ds_read_b64_tr_b16 v[70:71], v25 offset:12288
    v_fma_f32 v127, v127, s32, -v3
    v_exp_f32 v124, v124
    v_mfma_f32_16x16x32_bf16 v[32:35], v[12:15], v[80:83], v[32:35]
    v_exp_f32 v125, v125
    v_exp_f32 v126, v126
    v_exp_f32 v127, v127
    v_mfma_f32_16x16x32_bf16 v[36:39], v[12:15], v[84:87], v[36:39]
    v_cvt_pk_bf16_f32 v94, v124, v125
    v_cvt_pk_bf16_f32 v95, v126, v127
    s_waitcnt lgkmcnt(10)
    s_nop 0
    v_mfma_f32_16x16x32_bf16 v[192:195], v[48:51], v[88:91], v[192:195]
    v_cvt_pk_bf16_f32 v128, 0, v128
    v_cvt_pk_bf16_f32 v129, 0, v129
    v_cvt_pk_bf16_f32 v130, 0, v130
    v_mfma_f32_16x16x32_bf16 v[196:199], v[48:51], v[92:95], v[196:199]
    ds_read_b64_tr_b16 v[72:73], v26 offset:8192
    ds_read_b64_tr_b16 v[74:75], v26 offset:12288
    s_setprio 0
    v_cvt_pk_bf16_f32 v131, 0, v131
    v_mul_f32 v128, s34, v128
    s_waitcnt lgkmcnt(10)
    v_mfma_f32_16x16x32_bf16 v[200:203], v[52:55], v[88:91], v[200:203]
    v_mul_f32 v129, s34, v129
    v_mul_f32 v130, s34, v130
    v_mul_f32 v131, s34, v131
    v_mfma_f32_16x16x32_bf16 v[204:207], v[52:55], v[92:95], v[204:207]
    ds_read_b64_tr_b16 v[76:77], v27 offset:8192
    ds_read_b64_tr_b16 v[78:79], v27 offset:12288
    v_cvt_pk_bf16_f32 v128, 0, v128
    v_cvt_pk_bf16_f32 v129, 0, v129
    s_waitcnt lgkmcnt(10)
    v_mfma_f32_16x16x32_bf16 v[208:211], v[56:59], v[88:91], v[208:211]
    v_cvt_pk_bf16_f32 v130, 0, v130
    v_cvt_pk_bf16_f32 v131, 0, v131
    v_fma_f32 v128, v128, s32, -v2
    v_mfma_f32_16x16x32_bf16 v[212:215], v[56:59], v[92:95], v[212:215]
    ds_read_b128 v[48:51], v16 offset:32768
    v_fma_f32 v129, v129, s32, -v2
    v_fma_f32 v130, v130, s32, -v2
    s_waitcnt lgkmcnt(9)
    v_mfma_f32_16x16x32_bf16 v[216:219], v[60:63], v[88:91], v[216:219]
    v_fma_f32 v131, v131, s32, -v2
    v_exp_f32 v128, v128
    v_exp_f32 v129, v129
    v_mfma_f32_16x16x32_bf16 v[220:223], v[60:63], v[92:95], v[220:223]
    ds_read_b128 v[52:55], v17 offset:32768
    v_exp_f32 v130, v130
    v_exp_f32 v131, v131
    s_waitcnt lgkmcnt(8)
    v_mfma_f32_16x16x32_bf16 v[224:227], v[64:67], v[88:91], v[224:227]
    v_cvt_pk_bf16_f32 v80, v128, v129
    v_cvt_pk_bf16_f32 v81, v130, v131
    s_nop 1
    v_mfma_f32_16x16x32_bf16 v[228:231], v[64:67], v[92:95], v[228:231]
    ds_read_b128 v[56:59], v18 offset:32768
    v_cvt_pk_bf16_f32 v132, 0, v132
    v_cvt_pk_bf16_f32 v133, 0, v133
    v_cvt_pk_bf16_f32 v134, 0, v134
    s_waitcnt lgkmcnt(7)
    v_mfma_f32_16x16x32_bf16 v[232:235], v[68:71], v[88:91], v[232:235]
    v_cvt_pk_bf16_f32 v135, 0, v135
    v_mul_f32 v132, s34, v132
    v_mfma_f32_16x16x32_bf16 v[236:239], v[68:71], v[92:95], v[236:239]
    ds_read_b128 v[60:63], v19 offset:32768
    v_mul_f32 v133, s34, v133
    v_mul_f32 v134, s34, v134
    v_mul_f32 v135, s34, v135
    s_waitcnt lgkmcnt(6)
    v_mfma_f32_16x16x32_bf16 v[240:243], v[72:75], v[88:91], v[240:243]
    v_cvt_pk_bf16_f32 v132, 0, v132
    v_cvt_pk_bf16_f32 v133, 0, v133
    v_mfma_f32_16x16x32_bf16 v[244:247], v[72:75], v[92:95], v[244:247]
    ds_read_b128 v[64:67], v16 offset:36864
    v_cvt_pk_bf16_f32 v134, 0, v134
    v_cvt_pk_bf16_f32 v135, 0, v135
    v_fma_f32 v132, v132, s32, -v3
    s_waitcnt lgkmcnt(5)
    v_mfma_f32_16x16x32_bf16 v[248:251], v[76:79], v[88:91], v[248:251]
    v_fma_f32 v133, v133, s32, -v3
    v_fma_f32 v134, v134, s32, -v3
    v_mfma_f32_16x16x32_bf16 v[252:255], v[76:79], v[92:95], v[252:255]
    ds_read_b128 v[68:71], v17 offset:36864
    v_fma_f32 v135, v135, s32, -v3
    v_exp_f32 v132, v132
    v_exp_f32 v133, v133
    v_mfma_f32_16x16x32_bf16 v[32:35], v[12:15], v[88:91], v[32:35]
    v_exp_f32 v134, v134
    v_exp_f32 v135, v135
    v_mfma_f32_16x16x32_bf16 v[36:39], v[12:15], v[92:95], v[36:39]
    v_cvt_pk_bf16_f32 v84, v132, v133
    v_cvt_pk_bf16_f32 v85, v134, v135
    s_waitcnt vmcnt(0)
    s_barrier
    s_waitcnt lgkmcnt(5)
    v_mfma_f32_16x16x32_bf16 v[96:99], v[48:51], v[160:163], 0
    s_setprio 3
    v_cvt_pk_bf16_f32 v136, 0, v136
    v_cvt_pk_bf16_f32 v137, 0, v137
    v_cvt_pk_bf16_f32 v138, 0, v138
    v_mfma_f32_16x16x32_bf16 v[100:103], v[48:51], v[176:179], 0
    ds_read_b128 v[72:75], v18 offset:36864
    v_cvt_pk_bf16_f32 v139, 0, v139
    v_mul_f32 v136, s34, v136
    v_mul_f32 v137, s34, v137
    s_waitcnt lgkmcnt(5)
    v_mfma_f32_16x16x32_bf16 v[96:99], v[52:55], v[164:167], v[96:99]
    v_mul_f32 v138, s34, v138
    v_mul_f32 v139, s34, v139
    s_mov_b32 m0, s38
    s_nop 0
    buffer_load_dwordx4 v28, s[8:11], s35 offen lds
    buffer_load_dwordx4 v29, s[8:11], s35 offen offset:1024 lds
    s_add_u32 s35, s35, 16384
    v_mfma_f32_16x16x32_bf16 v[100:103], v[52:55], v[180:183], v[100:103]
    ds_read_b128 v[76:79], v19 offset:36864
    v_cvt_pk_bf16_f32 v136, 0, v136
    v_cvt_pk_bf16_f32 v137, 0, v137
    v_cvt_pk_bf16_f32 v138, 0, v138
    s_waitcnt lgkmcnt(5)
    v_mfma_f32_16x16x32_bf16 v[96:99], v[56:59], v[168:171], v[96:99]
    v_cvt_pk_bf16_f32 v139, 0, v139
    v_fma_f32 v136, v136, s32, -v2
    v_fma_f32 v137, v137, s32, -v2
    v_mfma_f32_16x16x32_bf16 v[100:103], v[56:59], v[184:187], v[100:103]
    ds_read_b128 v[48:51], v16 offset:40960
    v_fma_f32 v138, v138, s32, -v2
    v_fma_f32 v139, v139, s32, -v2
    s_waitcnt lgkmcnt(5)
    v_mfma_f32_16x16x32_bf16 v[96:99], v[60:63], v[172:175], v[96:99]
    v_exp_f32 v136, v136
    v_exp_f32 v137, v137
    v_exp_f32 v138, v138
    s_mov_b32 m0, s40
    s_nop 0
    buffer_load_dwordx4 v30, s[12:15], s36 offen lds
    buffer_load_dwordx4 v31, s[12:15], s36 offen offset:1024 lds
    s_add_u32 s36, s36, 16384
    v_mfma_f32_16x16x32_bf16 v[100:103], v[60:63], v[188:191], v[100:103]
    ds_read_b128 v[52:55], v17 offset:40960
    v_exp_f32 v139, v139
    v_cvt_pk_bf16_f32 v82, v136, v137
    v_cvt_pk_bf16_f32 v83, v138, v139
    s_waitcnt lgkmcnt(5)
    v_mfma_f32_16x16x32_bf16 v[104:107], v[64:67], v[160:163], 0
    v_cvt_pk_bf16_f32 v140, 0, v140
    v_cvt_pk_bf16_f32 v141, 0, v141
    v_mfma_f32_16x16x32_bf16 v[108:111], v[64:67], v[176:179], 0
    ds_read_b128 v[56:59], v18 offset:40960
    v_cvt_pk_bf16_f32 v142, 0, v142
    v_cvt_pk_bf16_f32 v143, 0, v143
    v_mul_f32 v140, s34, v140
    s_waitcnt lgkmcnt(5)
    v_mfma_f32_16x16x32_bf16 v[104:107], v[68:71], v[164:167], v[104:107]
    v_mul_f32 v141, s34, v141
    v_mul_f32 v142, s34, v142
    v_mul_f32 v143, s34, v143
    v_mfma_f32_16x16x32_bf16 v[108:111], v[68:71], v[180:183], v[108:111]
    ds_read_b128 v[60:63], v19 offset:40960
    v_cvt_pk_bf16_f32 v140, 0, v140
    v_cvt_pk_bf16_f32 v141, 0, v141
    s_waitcnt lgkmcnt(5)
    v_mfma_f32_16x16x32_bf16 v[104:107], v[72:75], v[168:171], v[104:107]
    v_cvt_pk_bf16_f32 v142, 0, v142
    v_cvt_pk_bf16_f32 v143, 0, v143
    v_fma_f32 v140, v140, s32, -v3
    v_mfma_f32_16x16x32_bf16 v[108:111], v[72:75], v[184:187], v[108:111]
    ds_read_b128 v[64:67], v16 offset:45056
    v_fma_f32 v141, v141, s32, -v3
    v_fma_f32 v142, v142, s32, -v3
    s_waitcnt lgkmcnt(5)
    v_mfma_f32_16x16x32_bf16 v[104:107], v[76:79], v[172:175], v[104:107]
    v_fma_f32 v143, v143, s32, -v3
    v_exp_f32 v140, v140
    v_exp_f32 v141, v141
    v_mfma_f32_16x16x32_bf16 v[108:111], v[76:79], v[188:191], v[108:111]
    ds_read_b128 v[68:71], v17 offset:45056
    v_exp_f32 v142, v142
    v_exp_f32 v143, v143
    v_cvt_pk_bf16_f32 v86, v140, v141
    s_waitcnt lgkmcnt(5)
    v_mfma_f32_16x16x32_bf16 v[112:115], v[48:51], v[160:163], 0
    v_cvt_pk_bf16_f32 v87, v142, v143
    v_cvt_pk_bf16_f32 v144, 0, v144
    v_mfma_f32_16x16x32_bf16 v[116:119], v[48:51], v[176:179], 0
    ds_read_b128 v[72:75], v18 offset:45056
    s_setprio 2
    v_cvt_pk_bf16_f32 v145, 0, v145
    v_cvt_pk_bf16_f32 v146, 0, v146
    v_cvt_pk_bf16_f32 v147, 0, v147
    s_waitcnt lgkmcnt(5)
    v_mfma_f32_16x16x32_bf16 v[112:115], v[52:55], v[164:167], v[112:115]
    v_mul_f32 v144, s34, v144
    v_mul_f32 v145, s34, v145
    v_mul_f32 v146, s34, v146
    v_mfma_f32_16x16x32_bf16 v[116:119], v[52:55], v[180:183], v[116:119]
    ds_read_b128 v[76:79], v19 offset:45056
    v_mul_f32 v147, s34, v147
    v_cvt_pk_bf16_f32 v144, 0, v144
    s_waitcnt lgkmcnt(5)
    v_mfma_f32_16x16x32_bf16 v[112:115], v[56:59], v[168:171], v[112:115]
    v_cvt_pk_bf16_f32 v145, 0, v145
    v_cvt_pk_bf16_f32 v146, 0, v146
    v_cvt_pk_bf16_f32 v147, 0, v147
    v_mfma_f32_16x16x32_bf16 v[116:119], v[56:59], v[184:187], v[116:119]
    ds_read_b64_tr_b16 v[48:49], v20 offset:16384
    ds_read_b64_tr_b16 v[50:51], v20 offset:20480
    v_fma_f32 v144, v144, s32, -v2
    v_fma_f32 v145, v145, s32, -v2
    v_fma_f32 v146, v146, s32, -v2
    s_waitcnt lgkmcnt(6)
    v_mfma_f32_16x16x32_bf16 v[112:115], v[60:63], v[172:175], v[112:115]
    v_fma_f32 v147, v147, s32, -v2
    v_exp_f32 v144, v144
    v_mfma_f32_16x16x32_bf16 v[116:119], v[60:63], v[188:191], v[116:119]
    ds_read_b64_tr_b16 v[52:53], v21 offset:16384
    ds_read_b64_tr_b16 v[54:55], v21 offset:20480
    v_exp_f32 v145, v145
    v_exp_f32 v146, v146
    v_exp_f32 v147, v147
    s_waitcnt lgkmcnt(7)
    v_mfma_f32_16x16x32_bf16 v[120:123], v[64:67], v[160:163], 0
    v_cvt_pk_bf16_f32 v88, v144, v145
    v_cvt_pk_bf16_f32 v89, v146, v147
    v_mfma_f32_16x16x32_bf16 v[124:127], v[64:67], v[176:179], 0
    ds_read_b64_tr_b16 v[56:57], v22 offset:16384
    ds_read_b64_tr_b16 v[58:59], v22 offset:20480
    v_cvt_pk_bf16_f32 v148, 0, v148
    v_cvt_pk_bf16_f32 v149, 0, v149
    v_cvt_pk_bf16_f32 v150, 0, v150
    s_waitcnt lgkmcnt(8)
    v_mfma_f32_16x16x32_bf16 v[120:123], v[68:71], v[164:167], v[120:123]
    v_cvt_pk_bf16_f32 v151, 0, v151
    v_mul_f32 v148, s34, v148
    v_mul_f32 v149, s34, v149
    v_mfma_f32_16x16x32_bf16 v[124:127], v[68:71], v[180:183], v[124:127]
    ds_read_b64_tr_b16 v[60:61], v23 offset:16384
    ds_read_b64_tr_b16 v[62:63], v23 offset:20480
    v_mul_f32 v150, s34, v150
    v_mul_f32 v151, s34, v151
    s_waitcnt lgkmcnt(9)
    v_mfma_f32_16x16x32_bf16 v[120:123], v[72:75], v[168:171], v[120:123]
    v_cvt_pk_bf16_f32 v148, 0, v148
    v_cvt_pk_bf16_f32 v149, 0, v149
    v_cvt_pk_bf16_f32 v150, 0, v150
    v_mfma_f32_16x16x32_bf16 v[124:127], v[72:75], v[184:187], v[124:127]
    ds_read_b64_tr_b16 v[64:65], v24 offset:16384
    ds_read_b64_tr_b16 v[66:67], v24 offset:20480
    v_cvt_pk_bf16_f32 v151, 0, v151
    v_fma_f32 v148, v148, s32, -v3
    v_fma_f32 v149, v149, s32, -v3
    s_waitcnt lgkmcnt(10)
    v_mfma_f32_16x16x32_bf16 v[120:123], v[76:79], v[172:175], v[120:123]
    v_fma_f32 v150, v150, s32, -v3
    v_fma_f32 v151, v151, s32, -v3
    v_mfma_f32_16x16x32_bf16 v[124:127], v[76:79], v[188:191], v[124:127]
    ds_read_b64_tr_b16 v[68:69], v25 offset:16384
    ds_read_b64_tr_b16 v[70:71], v25 offset:20480
    v_exp_f32 v148, v148
    v_exp_f32 v149, v149
    v_exp_f32 v150, v150
    s_waitcnt lgkmcnt(10)
    v_mfma_f32_16x16x32_bf16 v[192:195], v[48:51], v[80:83], v[192:195]
    v_exp_f32 v151, v151
    v_cvt_pk_bf16_f32 v92, v148, v149
    v_cvt_pk_bf16_f32 v93, v150, v151
    s_nop 1
    v_mfma_f32_16x16x32_bf16 v[196:199], v[48:51], v[84:87], v[196:199]
    ds_read_b64_tr_b16 v[72:73], v26 offset:16384
    ds_read_b64_tr_b16 v[74:75], v26 offset:20480
    v_cvt_pk_bf16_f32 v152, 0, v152
    v_cvt_pk_bf16_f32 v153, 0, v153
    s_waitcnt lgkmcnt(10)
    v_mfma_f32_16x16x32_bf16 v[200:203], v[52:55], v[80:83], v[200:203]
    s_setprio 1
    v_cvt_pk_bf16_f32 v154, 0, v154
    v_cvt_pk_bf16_f32 v155, 0, v155
    v_mul_f32 v152, s34, v152
    v_mfma_f32_16x16x32_bf16 v[204:207], v[52:55], v[84:87], v[204:207]
    ds_read_b64_tr_b16 v[76:77], v27 offset:16384
    ds_read_b64_tr_b16 v[78:79], v27 offset:20480
    v_mul_f32 v153, s34, v153
    v_mul_f32 v154, s34, v154
    v_mul_f32 v155, s34, v155
    s_waitcnt lgkmcnt(10)
    v_mfma_f32_16x16x32_bf16 v[208:211], v[56:59], v[80:83], v[208:211]
    v_cvt_pk_bf16_f32 v152, 0, v152
    v_cvt_pk_bf16_f32 v153, 0, v153
    v_mfma_f32_16x16x32_bf16 v[212:215], v[56:59], v[84:87], v[212:215]
    ds_read_b64_tr_b16 v[48:49], v20 offset:24576
    ds_read_b64_tr_b16 v[50:51], v20 offset:28672
    v_cvt_pk_bf16_f32 v154, 0, v154
    v_cvt_pk_bf16_f32 v155, 0, v155
    v_fma_f32 v152, v152, s32, -v2
    s_waitcnt lgkmcnt(10)
    v_mfma_f32_16x16x32_bf16 v[216:219], v[60:63], v[80:83], v[216:219]
    v_fma_f32 v153, v153, s32, -v2
    v_fma_f32 v154, v154, s32, -v2
    v_mfma_f32_16x16x32_bf16 v[220:223], v[60:63], v[84:87], v[220:223]
    ds_read_b64_tr_b16 v[52:53], v21 offset:24576
    ds_read_b64_tr_b16 v[54:55], v21 offset:28672
    v_fma_f32 v155, v155, s32, -v2
    v_exp_f32 v152, v152
    v_exp_f32 v153, v153
    s_waitcnt lgkmcnt(10)
    v_mfma_f32_16x16x32_bf16 v[224:227], v[64:67], v[80:83], v[224:227]
    v_exp_f32 v154, v154
    v_exp_f32 v155, v155
    v_cvt_pk_bf16_f32 v90, v152, v153
    s_nop 1
    v_mfma_f32_16x16x32_bf16 v[228:231], v[64:67], v[84:87], v[228:231]
    ds_read_b64_tr_b16 v[56:57], v22 offset:24576
    ds_read_b64_tr_b16 v[58:59], v22 offset:28672
    v_cvt_pk_bf16_f32 v91, v154, v155
    v_cvt_pk_bf16_f32 v156, 0, v156
    s_waitcnt lgkmcnt(10)
    v_mfma_f32_16x16x32_bf16 v[232:235], v[68:71], v[80:83], v[232:235]
    v_cvt_pk_bf16_f32 v157, 0, v157
    v_cvt_pk_bf16_f32 v158, 0, v158
    v_cvt_pk_bf16_f32 v159, 0, v159
    v_mfma_f32_16x16x32_bf16 v[236:239], v[68:71], v[84:87], v[236:239]
    ds_read_b64_tr_b16 v[60:61], v23 offset:24576
    ds_read_b64_tr_b16 v[62:63], v23 offset:28672
    v_mul_f32 v156, s34, v156
    v_mul_f32 v157, s34, v157
    v_mul_f32 v158, s34, v158
    s_waitcnt lgkmcnt(10)
    v_mfma_f32_16x16x32_bf16 v[240:243], v[72:75], v[80:83], v[240:243]
    v_mul_f32 v159, s34, v159
    v_cvt_pk_bf16_f32 v156, 0, v156
    v_mfma_f32_16x16x32_bf16 v[244:247], v[72:75], v[84:87], v[244:247]
    ds_read_b64_tr_b16 v[64:65], v24 offset:24576
    ds_read_b64_tr_b16 v[66:67], v24 offset:28672
    v_cvt_pk_bf16_f32 v157, 0, v157
    v_cvt_pk_bf16_f32 v158, 0, v158
    v_cvt_pk_bf16_f32 v159, 0, v159
    s_waitcnt lgkmcnt(10)
    v_mfma_f32_16x16x32_bf16 v[248:251], v[76:79], v[80:83], v[248:251]
    v_fma_f32 v156, v156, s32, -v3
    v_fma_f32 v157, v157, s32, -v3
    v_fma_f32 v158, v158, s32, -v3
    v_mfma_f32_16x16x32_bf16 v[252:255], v[76:79], v[84:87], v[252:255]
    ds_read_b64_tr_b16 v[68:69], v25 offset:24576
    ds_read_b64_tr_b16 v[70:71], v25 offset:28672
    v_fma_f32 v159, v159, s32, -v3
    v_exp_f32 v156, v156
    v_mfma_f32_16x16x32_bf16 v[32:35], v[12:15], v[80:83], v[32:35]
    v_exp_f32 v157, v157
    v_exp_f32 v158, v158
    v_exp_f32 v159, v159
    v_mfma_f32_16x16x32_bf16 v[36:39], v[12:15], v[84:87], v[36:39]
    v_cvt_pk_bf16_f32 v94, v156, v157
    v_cvt_pk_bf16_f32 v95, v158, v159
    s_waitcnt lgkmcnt(10)
    s_nop 0
    v_mfma_f32_16x16x32_bf16 v[192:195], v[48:51], v[88:91], v[192:195]
    v_cvt_pk_bf16_f32 v96, 0, v96
    v_cvt_pk_bf16_f32 v97, 0, v97
    v_cvt_pk_bf16_f32 v98, 0, v98
    v_mfma_f32_16x16x32_bf16 v[196:199], v[48:51], v[92:95], v[196:199]
    ds_read_b64_tr_b16 v[72:73], v26 offset:24576
    ds_read_b64_tr_b16 v[74:75], v26 offset:28672
    s_setprio 0
    v_cvt_pk_bf16_f32 v99, 0, v99
    v_mul_f32 v96, s34, v96
    s_waitcnt lgkmcnt(10)
    v_mfma_f32_16x16x32_bf16 v[200:203], v[52:55], v[88:91], v[200:203]
    v_mul_f32 v97, s34, v97
    v_mul_f32 v98, s34, v98
    v_mul_f32 v99, s34, v99
    v_mfma_f32_16x16x32_bf16 v[204:207], v[52:55], v[92:95], v[204:207]
    ds_read_b64_tr_b16 v[76:77], v27 offset:24576
    ds_read_b64_tr_b16 v[78:79], v27 offset:28672
    v_cvt_pk_bf16_f32 v96, 0, v96
    v_cvt_pk_bf16_f32 v97, 0, v97
    s_waitcnt lgkmcnt(10)
    v_mfma_f32_16x16x32_bf16 v[208:211], v[56:59], v[88:91], v[208:211]
    v_cvt_pk_bf16_f32 v98, 0, v98
    v_cvt_pk_bf16_f32 v99, 0, v99
    v_fma_f32 v96, v96, s32, -v2
    v_mfma_f32_16x16x32_bf16 v[212:215], v[56:59], v[92:95], v[212:215]
    ds_read_b128 v[48:51], v16 offset:0
    v_fma_f32 v97, v97, s32, -v2
    v_fma_f32 v98, v98, s32, -v2
    s_waitcnt lgkmcnt(9)
    v_mfma_f32_16x16x32_bf16 v[216:219], v[60:63], v[88:91], v[216:219]
    v_fma_f32 v99, v99, s32, -v2
    v_exp_f32 v96, v96
    v_exp_f32 v97, v97
    v_mfma_f32_16x16x32_bf16 v[220:223], v[60:63], v[92:95], v[220:223]
    ds_read_b128 v[52:55], v17 offset:0
    v_exp_f32 v98, v98
    v_exp_f32 v99, v99
    s_waitcnt lgkmcnt(8)
    v_mfma_f32_16x16x32_bf16 v[224:227], v[64:67], v[88:91], v[224:227]
    v_cvt_pk_bf16_f32 v80, v96, v97
    v_cvt_pk_bf16_f32 v81, v98, v99
    s_nop 1
    v_mfma_f32_16x16x32_bf16 v[228:231], v[64:67], v[92:95], v[228:231]
    ds_read_b128 v[56:59], v18 offset:0
    v_cvt_pk_bf16_f32 v100, 0, v100
    v_cvt_pk_bf16_f32 v101, 0, v101
    v_cvt_pk_bf16_f32 v102, 0, v102
    s_waitcnt lgkmcnt(7)
    v_mfma_f32_16x16x32_bf16 v[232:235], v[68:71], v[88:91], v[232:235]
    v_cvt_pk_bf16_f32 v103, 0, v103
    v_mul_f32 v100, s34, v100
    v_mfma_f32_16x16x32_bf16 v[236:239], v[68:71], v[92:95], v[236:239]
    ds_read_b128 v[60:63], v19 offset:0
    v_mul_f32 v101, s34, v101
    v_mul_f32 v102, s34, v102
    v_mul_f32 v103, s34, v103
    s_waitcnt lgkmcnt(6)
    v_mfma_f32_16x16x32_bf16 v[240:243], v[72:75], v[88:91], v[240:243]
    v_cvt_pk_bf16_f32 v100, 0, v100
    v_cvt_pk_bf16_f32 v101, 0, v101
    v_mfma_f32_16x16x32_bf16 v[244:247], v[72:75], v[92:95], v[244:247]
    ds_read_b128 v[64:67], v16 offset:4096
    v_cvt_pk_bf16_f32 v102, 0, v102
    v_cvt_pk_bf16_f32 v103, 0, v103
    v_fma_f32 v100, v100, s32, -v3
    s_waitcnt lgkmcnt(5)
    v_mfma_f32_16x16x32_bf16 v[248:251], v[76:79], v[88:91], v[248:251]
    v_fma_f32 v101, v101, s32, -v3
    v_fma_f32 v102, v102, s32, -v3
    v_mfma_f32_16x16x32_bf16 v[252:255], v[76:79], v[92:95], v[252:255]
    ds_read_b128 v[68:71], v17 offset:4096
    v_fma_f32 v103, v103, s32, -v3
    v_exp_f32 v100, v100
    v_exp_f32 v101, v101
    v_mfma_f32_16x16x32_bf16 v[32:35], v[12:15], v[88:91], v[32:35]
    v_exp_f32 v102, v102
    v_exp_f32 v103, v103
    v_mfma_f32_16x16x32_bf16 v[36:39], v[12:15], v[92:95], v[36:39]
    v_cvt_pk_bf16_f32 v84, v100, v101
    v_cvt_pk_bf16_f32 v85, v102, v103
    s_waitcnt vmcnt(0)
    s_barrier
    s_waitcnt lgkmcnt(5)
    v_mfma_f32_16x16x32_bf16 v[128:131], v[48:51], v[160:163], 0
    s_setprio 3
    v_cvt_pk_bf16_f32 v104, 0, v104
    v_cvt_pk_bf16_f32 v105, 0, v105
    v_cvt_pk_bf16_f32 v106, 0, v106
    v_mfma_f32_16x16x32_bf16 v[132:135], v[48:51], v[176:179], 0
    ds_read_b128 v[72:75], v18 offset:4096
    v_cvt_pk_bf16_f32 v107, 0, v107
    v_mul_f32 v104, s34, v104
    v_mul_f32 v105, s34, v105
    s_waitcnt lgkmcnt(5)
    v_mfma_f32_16x16x32_bf16 v[128:131], v[52:55], v[164:167], v[128:131]
    v_mul_f32 v106, s34, v106
    v_mul_f32 v107, s34, v107
    s_mov_b32 m0, s39
    s_nop 0
    buffer_load_dwordx4 v28, s[8:11], s35 offen lds
    buffer_load_dwordx4 v29, s[8:11], s35 offen offset:1024 lds
    s_add_u32 s35, s35, 16384
    v_mfma_f32_16x16x32_bf16 v[132:135], v[52:55], v[180:183], v[132:135]
    ds_read_b128 v[76:79], v19 offset:4096
    v_cvt_pk_bf16_f32 v104, 0, v104
    v_cvt_pk_bf16_f32 v105, 0, v105
    v_cvt_pk_bf16_f32 v106, 0, v106
    s_waitcnt lgkmcnt(5)
    v_mfma_f32_16x16x32_bf16 v[128:131], v[56:59], v[168:171], v[128:131]
    v_cvt_pk_bf16_f32 v107, 0, v107
    v_fma_f32 v104, v104, s32, -v2
    v_fma_f32 v105, v105, s32, -v2
    v_mfma_f32_16x16x32_bf16 v[132:135], v[56:59], v[184:187], v[132:135]
    ds_read_b128 v[48:51], v16 offset:8192
    v_fma_f32 v106, v106, s32, -v2
    v_fma_f32 v107, v107, s32, -v2
    s_waitcnt lgkmcnt(5)
    v_mfma_f32_16x16x32_bf16 v[128:131], v[60:63], v[172:175], v[128:131]
    v_exp_f32 v104, v104
    v_exp_f32 v105, v105
    v_exp_f32 v106, v106
    s_mov_b32 m0, s41
    s_nop 0
    buffer_load_dwordx4 v30, s[12:15], s36 offen lds
    buffer_load_dwordx4 v31, s[12:15], s36 offen offset:1024 lds
    s_add_u32 s36, s36, 16384
    v_mfma_f32_16x16x32_bf16 v[132:135], v[60:63], v[188:191], v[132:135]
    ds_read_b128 v[52:55], v17 offset:8192
    v_exp_f32 v107, v107
    v_cvt_pk_bf16_f32 v82, v104, v105
    v_cvt_pk_bf16_f32 v83, v106, v107
    s_waitcnt lgkmcnt(5)
    v_mfma_f32_16x16x32_bf16 v[136:139], v[64:67], v[160:163], 0
    v_cvt_pk_bf16_f32 v108, 0, v108
    v_cvt_pk_bf16_f32 v109, 0, v109
    v_mfma_f32_16x16x32_bf16 v[140:143], v[64:67], v[176:179], 0
    ds_read_b128 v[56:59], v18 offset:8192
    v_cvt_pk_bf16_f32 v110, 0, v110
    v_cvt_pk_bf16_f32 v111, 0, v111
    v_mul_f32 v108, s34, v108
    s_waitcnt lgkmcnt(5)
    v_mfma_f32_16x16x32_bf16 v[136:139], v[68:71], v[164:167], v[136:139]
    v_mul_f32 v109, s34, v109
    v_mul_f32 v110, s34, v110
    v_mul_f32 v111, s34, v111
    v_mfma_f32_16x16x32_bf16 v[140:143], v[68:71], v[180:183], v[140:143]
    ds_read_b128 v[60:63], v19 offset:8192
    v_cvt_pk_bf16_f32 v108, 0, v108
    v_cvt_pk_bf16_f32 v109, 0, v109
    s_waitcnt lgkmcnt(5)
    v_mfma_f32_16x16x32_bf16 v[136:139], v[72:75], v[168:171], v[136:139]
    v_cvt_pk_bf16_f32 v110, 0, v110
    v_cvt_pk_bf16_f32 v111, 0, v111
    v_fma_f32 v108, v108, s32, -v3
    v_mfma_f32_16x16x32_bf16 v[140:143], v[72:75], v[184:187], v[140:143]
    ds_read_b128 v[64:67], v16 offset:12288
    v_fma_f32 v109, v109, s32, -v3
    v_fma_f32 v110, v110, s32, -v3
    s_waitcnt lgkmcnt(5)
    v_mfma_f32_16x16x32_bf16 v[136:139], v[76:79], v[172:175], v[136:139]
    v_fma_f32 v111, v111, s32, -v3
    v_exp_f32 v108, v108
    v_exp_f32 v109, v109
    v_mfma_f32_16x16x32_bf16 v[140:143], v[76:79], v[188:191], v[140:143]
    ds_read_b128 v[68:71], v17 offset:12288
    v_exp_f32 v110, v110
    v_exp_f32 v111, v111
    v_cvt_pk_bf16_f32 v86, v108, v109
    s_waitcnt lgkmcnt(5)
    v_mfma_f32_16x16x32_bf16 v[144:147], v[48:51], v[160:163], 0
    v_cvt_pk_bf16_f32 v87, v110, v111
    v_cvt_pk_bf16_f32 v112, 0, v112
    v_mfma_f32_16x16x32_bf16 v[148:151], v[48:51], v[176:179], 0
    ds_read_b128 v[72:75], v18 offset:12288
    s_setprio 2
    v_cvt_pk_bf16_f32 v113, 0, v113
    v_cvt_pk_bf16_f32 v114, 0, v114
    v_cvt_pk_bf16_f32 v115, 0, v115
    s_waitcnt lgkmcnt(5)
    v_mfma_f32_16x16x32_bf16 v[144:147], v[52:55], v[164:167], v[144:147]
    v_mul_f32 v112, s34, v112
    v_mul_f32 v113, s34, v113
    v_mul_f32 v114, s34, v114
    v_mfma_f32_16x16x32_bf16 v[148:151], v[52:55], v[180:183], v[148:151]
    ds_read_b128 v[76:79], v19 offset:12288
    v_mul_f32 v115, s34, v115
    v_cvt_pk_bf16_f32 v112, 0, v112
    s_waitcnt lgkmcnt(5)
    v_mfma_f32_16x16x32_bf16 v[144:147], v[56:59], v[168:171], v[144:147]
    v_cvt_pk_bf16_f32 v113, 0, v113
    v_cvt_pk_bf16_f32 v114, 0, v114
    v_cvt_pk_bf16_f32 v115, 0, v115
    v_mfma_f32_16x16x32_bf16 v[148:151], v[56:59], v[184:187], v[148:151]
    ds_read_b64_tr_b16 v[48:49], v20 offset:32768
    ds_read_b64_tr_b16 v[50:51], v20 offset:36864
    v_fma_f32 v112, v112, s32, -v2
    v_fma_f32 v113, v113, s32, -v2
    v_fma_f32 v114, v114, s32, -v2
    s_waitcnt lgkmcnt(6)
    v_mfma_f32_16x16x32_bf16 v[144:147], v[60:63], v[172:175], v[144:147]
    v_fma_f32 v115, v115, s32, -v2
    v_exp_f32 v112, v112
    v_mfma_f32_16x16x32_bf16 v[148:151], v[60:63], v[188:191], v[148:151]
    ds_read_b64_tr_b16 v[52:53], v21 offset:32768
    ds_read_b64_tr_b16 v[54:55], v21 offset:36864
    v_exp_f32 v113, v113
    v_exp_f32 v114, v114
    v_exp_f32 v115, v115
    s_waitcnt lgkmcnt(7)
    v_mfma_f32_16x16x32_bf16 v[152:155], v[64:67], v[160:163], 0
    v_cvt_pk_bf16_f32 v88, v112, v113
    v_cvt_pk_bf16_f32 v89, v114, v115
    v_mfma_f32_16x16x32_bf16 v[156:159], v[64:67], v[176:179], 0
    ds_read_b64_tr_b16 v[56:57], v22 offset:32768
    ds_read_b64_tr_b16 v[58:59], v22 offset:36864
    v_cvt_pk_bf16_f32 v116, 0, v116
    v_cvt_pk_bf16_f32 v117, 0, v117
    v_cvt_pk_bf16_f32 v118, 0, v118
    s_waitcnt lgkmcnt(8)
    v_mfma_f32_16x16x32_bf16 v[152:155], v[68:71], v[164:167], v[152:155]
    v_cvt_pk_bf16_f32 v119, 0, v119
    v_mul_f32 v116, s34, v116
    v_mul_f32 v117, s34, v117
    v_mfma_f32_16x16x32_bf16 v[156:159], v[68:71], v[180:183], v[156:159]
    ds_read_b64_tr_b16 v[60:61], v23 offset:32768
    ds_read_b64_tr_b16 v[62:63], v23 offset:36864
    v_mul_f32 v118, s34, v118
    v_mul_f32 v119, s34, v119
    s_waitcnt lgkmcnt(9)
    v_mfma_f32_16x16x32_bf16 v[152:155], v[72:75], v[168:171], v[152:155]
    v_cvt_pk_bf16_f32 v116, 0, v116
    v_cvt_pk_bf16_f32 v117, 0, v117
    v_cvt_pk_bf16_f32 v118, 0, v118
    v_mfma_f32_16x16x32_bf16 v[156:159], v[72:75], v[184:187], v[156:159]
    ds_read_b64_tr_b16 v[64:65], v24 offset:32768
    ds_read_b64_tr_b16 v[66:67], v24 offset:36864
    v_cvt_pk_bf16_f32 v119, 0, v119
    v_fma_f32 v116, v116, s32, -v3
    v_fma_f32 v117, v117, s32, -v3
    s_waitcnt lgkmcnt(10)
    v_mfma_f32_16x16x32_bf16 v[152:155], v[76:79], v[172:175], v[152:155]
    v_fma_f32 v118, v118, s32, -v3
    v_fma_f32 v119, v119, s32, -v3
    v_mfma_f32_16x16x32_bf16 v[156:159], v[76:79], v[188:191], v[156:159]
    ds_read_b64_tr_b16 v[68:69], v25 offset:32768
    ds_read_b64_tr_b16 v[70:71], v25 offset:36864
    v_exp_f32 v116, v116
    v_exp_f32 v117, v117
    v_exp_f32 v118, v118
    s_waitcnt lgkmcnt(10)
    v_mfma_f32_16x16x32_bf16 v[192:195], v[48:51], v[80:83], v[192:195]
    v_exp_f32 v119, v119
    v_cvt_pk_bf16_f32 v92, v116, v117
    v_cvt_pk_bf16_f32 v93, v118, v119
    s_nop 1
    v_mfma_f32_16x16x32_bf16 v[196:199], v[48:51], v[84:87], v[196:199]
    ds_read_b64_tr_b16 v[72:73], v26 offset:32768
    ds_read_b64_tr_b16 v[74:75], v26 offset:36864
    v_cvt_pk_bf16_f32 v120, 0, v120
    v_cvt_pk_bf16_f32 v121, 0, v121
    s_waitcnt lgkmcnt(10)
    v_mfma_f32_16x16x32_bf16 v[200:203], v[52:55], v[80:83], v[200:203]
    s_setprio 1
    v_cvt_pk_bf16_f32 v122, 0, v122
    v_cvt_pk_bf16_f32 v123, 0, v123
    v_mul_f32 v120, s34, v120
    v_mfma_f32_16x16x32_bf16 v[204:207], v[52:55], v[84:87], v[204:207]
    ds_read_b64_tr_b16 v[76:77], v27 offset:32768
    ds_read_b64_tr_b16 v[78:79], v27 offset:36864
    v_mul_f32 v121, s34, v121
    v_mul_f32 v122, s34, v122
    v_mul_f32 v123, s34, v123
    s_waitcnt lgkmcnt(10)
    v_mfma_f32_16x16x32_bf16 v[208:211], v[56:59], v[80:83], v[208:211]
    v_cvt_pk_bf16_f32 v120, 0, v120
    v_cvt_pk_bf16_f32 v121, 0, v121
    v_mfma_f32_16x16x32_bf16 v[212:215], v[56:59], v[84:87], v[212:215]
    ds_read_b64_tr_b16 v[48:49], v20 offset:40960
    ds_read_b64_tr_b16 v[50:51], v20 offset:45056
    v_cvt_pk_bf16_f32 v122, 0, v122
    v_cvt_pk_bf16_f32 v123, 0, v123
    v_fma_f32 v120, v120, s32, -v2
    s_waitcnt lgkmcnt(10)
    v_mfma_f32_16x16x32_bf16 v[216:219], v[60:63], v[80:83], v[216:219]
    v_fma_f32 v121, v121, s32, -v2
    v_fma_f32 v122, v122, s32, -v2
    v_mfma_f32_16x16x32_bf16 v[220:223], v[60:63], v[84:87], v[220:223]
    ds_read_b64_tr_b16 v[52:53], v21 offset:40960
    ds_read_b64_tr_b16 v[54:55], v21 offset:45056
    v_fma_f32 v123, v123, s32, -v2
    v_exp_f32 v120, v120
    v_exp_f32 v121, v121
    s_waitcnt lgkmcnt(10)
    v_mfma_f32_16x16x32_bf16 v[224:227], v[64:67], v[80:83], v[224:227]
    v_exp_f32 v122, v122
    v_exp_f32 v123, v123
    v_cvt_pk_bf16_f32 v90, v120, v121
    s_nop 1
    v_mfma_f32_16x16x32_bf16 v[228:231], v[64:67], v[84:87], v[228:231]
    ds_read_b64_tr_b16 v[56:57], v22 offset:40960
    ds_read_b64_tr_b16 v[58:59], v22 offset:45056
    v_cvt_pk_bf16_f32 v91, v122, v123
    v_cvt_pk_bf16_f32 v124, 0, v124
    s_waitcnt lgkmcnt(10)
    v_mfma_f32_16x16x32_bf16 v[232:235], v[68:71], v[80:83], v[232:235]
    v_cvt_pk_bf16_f32 v125, 0, v125
    v_cvt_pk_bf16_f32 v126, 0, v126
    v_cvt_pk_bf16_f32 v127, 0, v127
    v_mfma_f32_16x16x32_bf16 v[236:239], v[68:71], v[84:87], v[236:239]
    ds_read_b64_tr_b16 v[60:61], v23 offset:40960
    ds_read_b64_tr_b16 v[62:63], v23 offset:45056
    v_mul_f32 v124, s34, v124
    v_mul_f32 v125, s34, v125
    v_mul_f32 v126, s34, v126
    s_waitcnt lgkmcnt(10)
    v_mfma_f32_16x16x32_bf16 v[240:243], v[72:75], v[80:83], v[240:243]
    v_mul_f32 v127, s34, v127
    v_cvt_pk_bf16_f32 v124, 0, v124
    v_mfma_f32_16x16x32_bf16 v[244:247], v[72:75], v[84:87], v[244:247]
    ds_read_b64_tr_b16 v[64:65], v24 offset:40960
    ds_read_b64_tr_b16 v[66:67], v24 offset:45056
    v_cvt_pk_bf16_f32 v125, 0, v125
    v_cvt_pk_bf16_f32 v126, 0, v126
    v_cvt_pk_bf16_f32 v127, 0, v127
    s_waitcnt lgkmcnt(10)
    v_mfma_f32_16x16x32_bf16 v[248:251], v[76:79], v[80:83], v[248:251]
    v_fma_f32 v124, v124, s32, -v3
    v_fma_f32 v125, v125, s32, -v3
    v_fma_f32 v126, v126, s32, -v3
    v_mfma_f32_16x16x32_bf16 v[252:255], v[76:79], v[84:87], v[252:255]
    ds_read_b64_tr_b16 v[68:69], v25 offset:40960
    ds_read_b64_tr_b16 v[70:71], v25 offset:45056
    v_fma_f32 v127, v127, s32, -v3
    v_exp_f32 v124, v124
    v_mfma_f32_16x16x32_bf16 v[32:35], v[12:15], v[80:83], v[32:35]
    v_exp_f32 v125, v125
    v_exp_f32 v126, v126
    v_exp_f32 v127, v127
    v_mfma_f32_16x16x32_bf16 v[36:39], v[12:15], v[84:87], v[36:39]
    v_cvt_pk_bf16_f32 v94, v124, v125
    v_cvt_pk_bf16_f32 v95, v126, v127
    s_waitcnt lgkmcnt(10)
    s_nop 0
    v_mfma_f32_16x16x32_bf16 v[192:195], v[48:51], v[88:91], v[192:195]
    v_cvt_pk_bf16_f32 v128, 0, v128
    v_cvt_pk_bf16_f32 v129, 0, v129
    v_cvt_pk_bf16_f32 v130, 0, v130
    v_mfma_f32_16x16x32_bf16 v[196:199], v[48:51], v[92:95], v[196:199]
    ds_read_b64_tr_b16 v[72:73], v26 offset:40960
    ds_read_b64_tr_b16 v[74:75], v26 offset:45056
    s_setprio 0
    v_cvt_pk_bf16_f32 v131, 0, v131
    v_mul_f32 v128, s34, v128
    s_waitcnt lgkmcnt(10)
    v_mfma_f32_16x16x32_bf16 v[200:203], v[52:55], v[88:91], v[200:203]
    v_mul_f32 v129, s34, v129
    v_mul_f32 v130, s34, v130
    v_mul_f32 v131, s34, v131
    v_mfma_f32_16x16x32_bf16 v[204:207], v[52:55], v[92:95], v[204:207]
    ds_read_b64_tr_b16 v[76:77], v27 offset:40960
    ds_read_b64_tr_b16 v[78:79], v27 offset:45056
    v_cvt_pk_bf16_f32 v128, 0, v128
    v_cvt_pk_bf16_f32 v129, 0, v129
    s_waitcnt lgkmcnt(10)
    v_mfma_f32_16x16x32_bf16 v[208:211], v[56:59], v[88:91], v[208:211]
    v_cvt_pk_bf16_f32 v130, 0, v130
    v_cvt_pk_bf16_f32 v131, 0, v131
    v_fma_f32 v128, v128, s32, -v2
    v_mfma_f32_16x16x32_bf16 v[212:215], v[56:59], v[92:95], v[212:215]
    ds_read_b128 v[48:51], v16 offset:16384
    v_fma_f32 v129, v129, s32, -v2
    v_fma_f32 v130, v130, s32, -v2
    s_waitcnt lgkmcnt(9)
    v_mfma_f32_16x16x32_bf16 v[216:219], v[60:63], v[88:91], v[216:219]
    v_fma_f32 v131, v131, s32, -v2
    v_exp_f32 v128, v128
    v_exp_f32 v129, v129
    v_mfma_f32_16x16x32_bf16 v[220:223], v[60:63], v[92:95], v[220:223]
    ds_read_b128 v[52:55], v17 offset:16384
    v_exp_f32 v130, v130
    v_exp_f32 v131, v131
    s_waitcnt lgkmcnt(8)
    v_mfma_f32_16x16x32_bf16 v[224:227], v[64:67], v[88:91], v[224:227]
    v_cvt_pk_bf16_f32 v80, v128, v129
    v_cvt_pk_bf16_f32 v81, v130, v131
    s_nop 1
    v_mfma_f32_16x16x32_bf16 v[228:231], v[64:67], v[92:95], v[228:231]
    ds_read_b128 v[56:59], v18 offset:16384
    v_cvt_pk_bf16_f32 v132, 0, v132
    v_cvt_pk_bf16_f32 v133, 0, v133
    v_cvt_pk_bf16_f32 v134, 0, v134
    s_waitcnt lgkmcnt(7)
    v_mfma_f32_16x16x32_bf16 v[232:235], v[68:71], v[88:91], v[232:235]
    v_cvt_pk_bf16_f32 v135, 0, v135
    v_mul_f32 v132, s34, v132
    v_mfma_f32_16x16x32_bf16 v[236:239], v[68:71], v[92:95], v[236:239]
    ds_read_b128 v[60:63], v19 offset:16384
    v_mul_f32 v133, s34, v133
    v_mul_f32 v134, s34, v134
    v_mul_f32 v135, s34, v135
    s_waitcnt lgkmcnt(6)
    v_mfma_f32_16x16x32_bf16 v[240:243], v[72:75], v[88:91], v[240:243]
    v_cvt_pk_bf16_f32 v132, 0, v132
    v_cvt_pk_bf16_f32 v133, 0, v133
    v_mfma_f32_16x16x32_bf16 v[244:247], v[72:75], v[92:95], v[244:247]
    ds_read_b128 v[64:67], v16 offset:20480
    v_cvt_pk_bf16_f32 v134, 0, v134
    v_cvt_pk_bf16_f32 v135, 0, v135
    v_fma_f32 v132, v132, s32, -v3
    s_waitcnt lgkmcnt(5)
    v_mfma_f32_16x16x32_bf16 v[248:251], v[76:79], v[88:91], v[248:251]
    v_fma_f32 v133, v133, s32, -v3
    v_fma_f32 v134, v134, s32, -v3
    v_mfma_f32_16x16x32_bf16 v[252:255], v[76:79], v[92:95], v[252:255]
    ds_read_b128 v[68:71], v17 offset:20480
    v_fma_f32 v135, v135, s32, -v3
    v_exp_f32 v132, v132
    v_exp_f32 v133, v133
    v_mfma_f32_16x16x32_bf16 v[32:35], v[12:15], v[88:91], v[32:35]
    v_exp_f32 v134, v134
    v_exp_f32 v135, v135
    v_mfma_f32_16x16x32_bf16 v[36:39], v[12:15], v[92:95], v[36:39]
    v_cvt_pk_bf16_f32 v84, v132, v133
    v_cvt_pk_bf16_f32 v85, v134, v135
    s_waitcnt vmcnt(0)
    s_barrier
    s_waitcnt lgkmcnt(5)
    v_mfma_f32_16x16x32_bf16 v[96:99], v[48:51], v[160:163], 0
    s_setprio 3
    v_cvt_pk_bf16_f32 v136, 0, v136
    v_cvt_pk_bf16_f32 v137, 0, v137
    v_cvt_pk_bf16_f32 v138, 0, v138
    v_mfma_f32_16x16x32_bf16 v[100:103], v[48:51], v[176:179], 0
    ds_read_b128 v[72:75], v18 offset:20480
    v_cvt_pk_bf16_f32 v139, 0, v139
    v_mul_f32 v136, s34, v136
    v_mul_f32 v137, s34, v137
    s_waitcnt lgkmcnt(5)
    v_mfma_f32_16x16x32_bf16 v[96:99], v[52:55], v[164:167], v[96:99]
    v_mul_f32 v138, s34, v138
    v_mul_f32 v139, s34, v139
    s_mov_b32 m0, s37
    s_nop 0
    buffer_load_dwordx4 v28, s[8:11], s35 offen lds
    buffer_load_dwordx4 v29, s[8:11], s35 offen offset:1024 lds
    s_add_u32 s35, s35, 16384
    v_mfma_f32_16x16x32_bf16 v[100:103], v[52:55], v[180:183], v[100:103]
    ds_read_b128 v[76:79], v19 offset:20480
    v_cvt_pk_bf16_f32 v136, 0, v136
    v_cvt_pk_bf16_f32 v137, 0, v137
    v_cvt_pk_bf16_f32 v138, 0, v138
    s_waitcnt lgkmcnt(5)
    v_mfma_f32_16x16x32_bf16 v[96:99], v[56:59], v[168:171], v[96:99]
    v_cvt_pk_bf16_f32 v139, 0, v139
    v_fma_f32 v136, v136, s32, -v2
    v_fma_f32 v137, v137, s32, -v2
    v_mfma_f32_16x16x32_bf16 v[100:103], v[56:59], v[184:187], v[100:103]
    ds_read_b128 v[48:51], v16 offset:24576
    v_fma_f32 v138, v138, s32, -v2
    v_fma_f32 v139, v139, s32, -v2
    s_waitcnt lgkmcnt(5)
    v_mfma_f32_16x16x32_bf16 v[96:99], v[60:63], v[172:175], v[96:99]
    v_exp_f32 v136, v136
    v_exp_f32 v137, v137
    v_exp_f32 v138, v138
    s_mov_b32 m0, s42
    s_nop 0
    buffer_load_dwordx4 v30, s[12:15], s36 offen lds
    buffer_load_dwordx4 v31, s[12:15], s36 offen offset:1024 lds
    s_add_u32 s36, s36, 16384
    v_mfma_f32_16x16x32_bf16 v[100:103], v[60:63], v[188:191], v[100:103]
    ds_read_b128 v[52:55], v17 offset:24576
    v_exp_f32 v139, v139
    v_cvt_pk_bf16_f32 v82, v136, v137
    v_cvt_pk_bf16_f32 v83, v138, v139
    s_waitcnt lgkmcnt(5)
    v_mfma_f32_16x16x32_bf16 v[104:107], v[64:67], v[160:163], 0
    v_cvt_pk_bf16_f32 v140, 0, v140
    v_cvt_pk_bf16_f32 v141, 0, v141
    v_mfma_f32_16x16x32_bf16 v[108:111], v[64:67], v[176:179], 0
    ds_read_b128 v[56:59], v18 offset:24576
    v_cvt_pk_bf16_f32 v142, 0, v142
    v_cvt_pk_bf16_f32 v143, 0, v143
    v_mul_f32 v140, s34, v140
    s_waitcnt lgkmcnt(5)
    v_mfma_f32_16x16x32_bf16 v[104:107], v[68:71], v[164:167], v[104:107]
    v_mul_f32 v141, s34, v141
    v_mul_f32 v142, s34, v142
    v_mul_f32 v143, s34, v143
    v_mfma_f32_16x16x32_bf16 v[108:111], v[68:71], v[180:183], v[108:111]
    ds_read_b128 v[60:63], v19 offset:24576
    v_cvt_pk_bf16_f32 v140, 0, v140
    v_cvt_pk_bf16_f32 v141, 0, v141
    s_waitcnt lgkmcnt(5)
    v_mfma_f32_16x16x32_bf16 v[104:107], v[72:75], v[168:171], v[104:107]
    v_cvt_pk_bf16_f32 v142, 0, v142
    v_cvt_pk_bf16_f32 v143, 0, v143
    v_fma_f32 v140, v140, s32, -v3
    v_mfma_f32_16x16x32_bf16 v[108:111], v[72:75], v[184:187], v[108:111]
    ds_read_b128 v[64:67], v16 offset:28672
    v_fma_f32 v141, v141, s32, -v3
    v_fma_f32 v142, v142, s32, -v3
    s_waitcnt lgkmcnt(5)
    v_mfma_f32_16x16x32_bf16 v[104:107], v[76:79], v[172:175], v[104:107]
    v_fma_f32 v143, v143, s32, -v3
    v_exp_f32 v140, v140
    v_exp_f32 v141, v141
    v_mfma_f32_16x16x32_bf16 v[108:111], v[76:79], v[188:191], v[108:111]
    ds_read_b128 v[68:71], v17 offset:28672
    v_exp_f32 v142, v142
    v_exp_f32 v143, v143
    v_cvt_pk_bf16_f32 v86, v140, v141
    s_waitcnt lgkmcnt(5)
    v_mfma_f32_16x16x32_bf16 v[112:115], v[48:51], v[160:163], 0
    v_cvt_pk_bf16_f32 v87, v142, v143
    v_cvt_pk_bf16_f32 v144, 0, v144
    v_mfma_f32_16x16x32_bf16 v[116:119], v[48:51], v[176:179], 0
    ds_read_b128 v[72:75], v18 offset:28672
    s_setprio 2
    v_cvt_pk_bf16_f32 v145, 0, v145
    v_cvt_pk_bf16_f32 v146, 0, v146
    v_cvt_pk_bf16_f32 v147, 0, v147
    s_waitcnt lgkmcnt(5)
    v_mfma_f32_16x16x32_bf16 v[112:115], v[52:55], v[164:167], v[112:115]
    v_mul_f32 v144, s34, v144
    v_mul_f32 v145, s34, v145
    v_mul_f32 v146, s34, v146
    v_mfma_f32_16x16x32_bf16 v[116:119], v[52:55], v[180:183], v[116:119]
    ds_read_b128 v[76:79], v19 offset:28672
    v_mul_f32 v147, s34, v147
    v_cvt_pk_bf16_f32 v144, 0, v144
    s_waitcnt lgkmcnt(5)
    v_mfma_f32_16x16x32_bf16 v[112:115], v[56:59], v[168:171], v[112:115]
    v_cvt_pk_bf16_f32 v145, 0, v145
    v_cvt_pk_bf16_f32 v146, 0, v146
    v_cvt_pk_bf16_f32 v147, 0, v147
    v_mfma_f32_16x16x32_bf16 v[116:119], v[56:59], v[184:187], v[116:119]
    ds_read_b64_tr_b16 v[48:49], v20 offset:0
    ds_read_b64_tr_b16 v[50:51], v20 offset:4096
    v_fma_f32 v144, v144, s32, -v2
    v_fma_f32 v145, v145, s32, -v2
    v_fma_f32 v146, v146, s32, -v2
    s_waitcnt lgkmcnt(6)
    v_mfma_f32_16x16x32_bf16 v[112:115], v[60:63], v[172:175], v[112:115]
    v_fma_f32 v147, v147, s32, -v2
    v_exp_f32 v144, v144
    v_mfma_f32_16x16x32_bf16 v[116:119], v[60:63], v[188:191], v[116:119]
    ds_read_b64_tr_b16 v[52:53], v21 offset:0
    ds_read_b64_tr_b16 v[54:55], v21 offset:4096
    v_exp_f32 v145, v145
    v_exp_f32 v146, v146
    v_exp_f32 v147, v147
    s_waitcnt lgkmcnt(7)
    v_mfma_f32_16x16x32_bf16 v[120:123], v[64:67], v[160:163], 0
    v_cvt_pk_bf16_f32 v88, v144, v145
    v_cvt_pk_bf16_f32 v89, v146, v147
    v_mfma_f32_16x16x32_bf16 v[124:127], v[64:67], v[176:179], 0
    ds_read_b64_tr_b16 v[56:57], v22 offset:0
    ds_read_b64_tr_b16 v[58:59], v22 offset:4096
    v_cvt_pk_bf16_f32 v148, 0, v148
    v_cvt_pk_bf16_f32 v149, 0, v149
    v_cvt_pk_bf16_f32 v150, 0, v150
    s_waitcnt lgkmcnt(8)
    v_mfma_f32_16x16x32_bf16 v[120:123], v[68:71], v[164:167], v[120:123]
    v_cvt_pk_bf16_f32 v151, 0, v151
    v_mul_f32 v148, s34, v148
    v_mul_f32 v149, s34, v149
    v_mfma_f32_16x16x32_bf16 v[124:127], v[68:71], v[180:183], v[124:127]
    ds_read_b64_tr_b16 v[60:61], v23 offset:0
    ds_read_b64_tr_b16 v[62:63], v23 offset:4096
    v_mul_f32 v150, s34, v150
    v_mul_f32 v151, s34, v151
    s_waitcnt lgkmcnt(9)
    v_mfma_f32_16x16x32_bf16 v[120:123], v[72:75], v[168:171], v[120:123]
    v_cvt_pk_bf16_f32 v148, 0, v148
    v_cvt_pk_bf16_f32 v149, 0, v149
    v_cvt_pk_bf16_f32 v150, 0, v150
    v_mfma_f32_16x16x32_bf16 v[124:127], v[72:75], v[184:187], v[124:127]
    ds_read_b64_tr_b16 v[64:65], v24 offset:0
    ds_read_b64_tr_b16 v[66:67], v24 offset:4096
    v_cvt_pk_bf16_f32 v151, 0, v151
    v_fma_f32 v148, v148, s32, -v3
    v_fma_f32 v149, v149, s32, -v3
    s_waitcnt lgkmcnt(10)
    v_mfma_f32_16x16x32_bf16 v[120:123], v[76:79], v[172:175], v[120:123]
    v_fma_f32 v150, v150, s32, -v3
    v_fma_f32 v151, v151, s32, -v3
    v_mfma_f32_16x16x32_bf16 v[124:127], v[76:79], v[188:191], v[124:127]
    ds_read_b64_tr_b16 v[68:69], v25 offset:0
    ds_read_b64_tr_b16 v[70:71], v25 offset:4096
    v_exp_f32 v148, v148
    v_exp_f32 v149, v149
    v_exp_f32 v150, v150
    s_waitcnt lgkmcnt(10)
    v_mfma_f32_16x16x32_bf16 v[192:195], v[48:51], v[80:83], v[192:195]
    v_exp_f32 v151, v151
    v_cvt_pk_bf16_f32 v92, v148, v149
    v_cvt_pk_bf16_f32 v93, v150, v151
    s_nop 1
    v_mfma_f32_16x16x32_bf16 v[196:199], v[48:51], v[84:87], v[196:199]
    ds_read_b64_tr_b16 v[72:73], v26 offset:0
    ds_read_b64_tr_b16 v[74:75], v26 offset:4096
    v_cvt_pk_bf16_f32 v152, 0, v152
    v_cvt_pk_bf16_f32 v153, 0, v153
    s_waitcnt lgkmcnt(10)
    v_mfma_f32_16x16x32_bf16 v[200:203], v[52:55], v[80:83], v[200:203]
    s_setprio 1
    v_cvt_pk_bf16_f32 v154, 0, v154
    v_cvt_pk_bf16_f32 v155, 0, v155
    v_mul_f32 v152, s34, v152
    v_mfma_f32_16x16x32_bf16 v[204:207], v[52:55], v[84:87], v[204:207]
    ds_read_b64_tr_b16 v[76:77], v27 offset:0
    ds_read_b64_tr_b16 v[78:79], v27 offset:4096
    v_mul_f32 v153, s34, v153
    v_mul_f32 v154, s34, v154
    v_mul_f32 v155, s34, v155
    s_waitcnt lgkmcnt(10)
    v_mfma_f32_16x16x32_bf16 v[208:211], v[56:59], v[80:83], v[208:211]
    v_cvt_pk_bf16_f32 v152, 0, v152
    v_cvt_pk_bf16_f32 v153, 0, v153
    v_mfma_f32_16x16x32_bf16 v[212:215], v[56:59], v[84:87], v[212:215]
    ds_read_b64_tr_b16 v[48:49], v20 offset:8192
    ds_read_b64_tr_b16 v[50:51], v20 offset:12288
    v_cvt_pk_bf16_f32 v154, 0, v154
    v_cvt_pk_bf16_f32 v155, 0, v155
    v_fma_f32 v152, v152, s32, -v2
    s_waitcnt lgkmcnt(10)
    v_mfma_f32_16x16x32_bf16 v[216:219], v[60:63], v[80:83], v[216:219]
    v_fma_f32 v153, v153, s32, -v2
    v_fma_f32 v154, v154, s32, -v2
    v_mfma_f32_16x16x32_bf16 v[220:223], v[60:63], v[84:87], v[220:223]
    ds_read_b64_tr_b16 v[52:53], v21 offset:8192
    ds_read_b64_tr_b16 v[54:55], v21 offset:12288
    v_fma_f32 v155, v155, s32, -v2
    v_exp_f32 v152, v152
    v_exp_f32 v153, v153
    s_waitcnt lgkmcnt(10)
    v_mfma_f32_16x16x32_bf16 v[224:227], v[64:67], v[80:83], v[224:227]
    v_exp_f32 v154, v154
    v_exp_f32 v155, v155
    v_cvt_pk_bf16_f32 v90, v152, v153
    s_nop 1
    v_mfma_f32_16x16x32_bf16 v[228:231], v[64:67], v[84:87], v[228:231]
    ds_read_b64_tr_b16 v[56:57], v22 offset:8192
    ds_read_b64_tr_b16 v[58:59], v22 offset:12288
    v_cvt_pk_bf16_f32 v91, v154, v155
    v_cvt_pk_bf16_f32 v156, 0, v156
    s_waitcnt lgkmcnt(10)
    v_mfma_f32_16x16x32_bf16 v[232:235], v[68:71], v[80:83], v[232:235]
    v_cvt_pk_bf16_f32 v157, 0, v157
    v_cvt_pk_bf16_f32 v158, 0, v158
    v_cvt_pk_bf16_f32 v159, 0, v159
    v_mfma_f32_16x16x32_bf16 v[236:239], v[68:71], v[84:87], v[236:239]
    ds_read_b64_tr_b16 v[60:61], v23 offset:8192
    ds_read_b64_tr_b16 v[62:63], v23 offset:12288
    v_mul_f32 v156, s34, v156
    v_mul_f32 v157, s34, v157
    v_mul_f32 v158, s34, v158
    s_waitcnt lgkmcnt(10)
    v_mfma_f32_16x16x32_bf16 v[240:243], v[72:75], v[80:83], v[240:243]
    v_mul_f32 v159, s34, v159
    v_cvt_pk_bf16_f32 v156, 0, v156
    v_mfma_f32_16x16x32_bf16 v[244:247], v[72:75], v[84:87], v[244:247]
    ds_read_b64_tr_b16 v[64:65], v24 offset:8192
    ds_read_b64_tr_b16 v[66:67], v24 offset:12288
    v_cvt_pk_bf16_f32 v157, 0, v157
    v_cvt_pk_bf16_f32 v158, 0, v158
    v_cvt_pk_bf16_f32 v159, 0, v159
    s_waitcnt lgkmcnt(10)
    v_mfma_f32_16x16x32_bf16 v[248:251], v[76:79], v[80:83], v[248:251]
    v_fma_f32 v156, v156, s32, -v3
    v_fma_f32 v157, v157, s32, -v3
    v_fma_f32 v158, v158, s32, -v3
    v_mfma_f32_16x16x32_bf16 v[252:255], v[76:79], v[84:87], v[252:255]
    ds_read_b64_tr_b16 v[68:69], v25 offset:8192
    ds_read_b64_tr_b16 v[70:71], v25 offset:12288
    v_fma_f32 v159, v159, s32, -v3
    v_exp_f32 v156, v156
    v_mfma_f32_16x16x32_bf16 v[32:35], v[12:15], v[80:83], v[32:35]
    v_exp_f32 v157, v157
    v_exp_f32 v158, v158
    v_exp_f32 v159, v159
    v_mfma_f32_16x16x32_bf16 v[36:39], v[12:15], v[84:87], v[36:39]
    v_cvt_pk_bf16_f32 v94, v156, v157
    v_cvt_pk_bf16_f32 v95, v158, v159
    s_waitcnt lgkmcnt(10)
    s_nop 0
    v_mfma_f32_16x16x32_bf16 v[192:195], v[48:51], v[88:91], v[192:195]
    v_cvt_pk_bf16_f32 v96, 0, v96
    v_cvt_pk_bf16_f32 v97, 0, v97
    v_cvt_pk_bf16_f32 v98, 0, v98
    v_mfma_f32_16x16x32_bf16 v[196:199], v[48:51], v[92:95], v[196:199]
    ds_read_b64_tr_b16 v[72:73], v26 offset:8192
    ds_read_b64_tr_b16 v[74:75], v26 offset:12288
    s_setprio 0
    v_cvt_pk_bf16_f32 v99, 0, v99
    v_mul_f32 v96, s34, v96
    s_waitcnt lgkmcnt(10)
    v_mfma_f32_16x16x32_bf16 v[200:203], v[52:55], v[88:91], v[200:203]
    v_mul_f32 v97, s34, v97
    v_mul_f32 v98, s34, v98
    v_mul_f32 v99, s34, v99
    v_mfma_f32_16x16x32_bf16 v[204:207], v[52:55], v[92:95], v[204:207]
    ds_read_b64_tr_b16 v[76:77], v27 offset:8192
    ds_read_b64_tr_b16 v[78:79], v27 offset:12288
    v_cvt_pk_bf16_f32 v96, 0, v96
    v_cvt_pk_bf16_f32 v97, 0, v97
    s_waitcnt lgkmcnt(10)
    v_mfma_f32_16x16x32_bf16 v[208:211], v[56:59], v[88:91], v[208:211]
    v_cvt_pk_bf16_f32 v98, 0, v98
    v_cvt_pk_bf16_f32 v99, 0, v99
    v_fma_f32 v96, v96, s32, -v2
    v_mfma_f32_16x16x32_bf16 v[212:215], v[56:59], v[92:95], v[212:215]
    ds_read_b128 v[48:51], v16 offset:32768
    v_fma_f32 v97, v97, s32, -v2
    v_fma_f32 v98, v98, s32, -v2
    s_waitcnt lgkmcnt(9)
    v_mfma_f32_16x16x32_bf16 v[216:219], v[60:63], v[88:91], v[216:219]
    v_fma_f32 v99, v99, s32, -v2
    v_exp_f32 v96, v96
    v_exp_f32 v97, v97
    v_mfma_f32_16x16x32_bf16 v[220:223], v[60:63], v[92:95], v[220:223]
    ds_read_b128 v[52:55], v17 offset:32768
    v_exp_f32 v98, v98
    v_exp_f32 v99, v99
    s_waitcnt lgkmcnt(8)
    v_mfma_f32_16x16x32_bf16 v[224:227], v[64:67], v[88:91], v[224:227]
    v_cvt_pk_bf16_f32 v80, v96, v97
    v_cvt_pk_bf16_f32 v81, v98, v99
    s_nop 1
    v_mfma_f32_16x16x32_bf16 v[228:231], v[64:67], v[92:95], v[228:231]
    ds_read_b128 v[56:59], v18 offset:32768
    v_cvt_pk_bf16_f32 v100, 0, v100
    v_cvt_pk_bf16_f32 v101, 0, v101
    v_cvt_pk_bf16_f32 v102, 0, v102
    s_waitcnt lgkmcnt(7)
    v_mfma_f32_16x16x32_bf16 v[232:235], v[68:71], v[88:91], v[232:235]
    v_cvt_pk_bf16_f32 v103, 0, v103
    v_mul_f32 v100, s34, v100
    v_mfma_f32_16x16x32_bf16 v[236:239], v[68:71], v[92:95], v[236:239]
    ds_read_b128 v[60:63], v19 offset:32768
    v_mul_f32 v101, s34, v101
    v_mul_f32 v102, s34, v102
    v_mul_f32 v103, s34, v103
    s_waitcnt lgkmcnt(6)
    v_mfma_f32_16x16x32_bf16 v[240:243], v[72:75], v[88:91], v[240:243]
    v_cvt_pk_bf16_f32 v100, 0, v100
    v_cvt_pk_bf16_f32 v101, 0, v101
    v_mfma_f32_16x16x32_bf16 v[244:247], v[72:75], v[92:95], v[244:247]
    ds_read_b128 v[64:67], v16 offset:36864
    v_cvt_pk_bf16_f32 v102, 0, v102
    v_cvt_pk_bf16_f32 v103, 0, v103
    v_fma_f32 v100, v100, s32, -v3
    s_waitcnt lgkmcnt(5)
    v_mfma_f32_16x16x32_bf16 v[248:251], v[76:79], v[88:91], v[248:251]
    v_fma_f32 v101, v101, s32, -v3
    v_fma_f32 v102, v102, s32, -v3
    v_mfma_f32_16x16x32_bf16 v[252:255], v[76:79], v[92:95], v[252:255]
    ds_read_b128 v[68:71], v17 offset:36864
    v_fma_f32 v103, v103, s32, -v3
    v_exp_f32 v100, v100
    v_exp_f32 v101, v101
    v_mfma_f32_16x16x32_bf16 v[32:35], v[12:15], v[88:91], v[32:35]
    v_exp_f32 v102, v102
    v_exp_f32 v103, v103
    v_mfma_f32_16x16x32_bf16 v[36:39], v[12:15], v[92:95], v[36:39]
    v_cvt_pk_bf16_f32 v84, v100, v101
    v_cvt_pk_bf16_f32 v85, v102, v103
    s_waitcnt vmcnt(0)
    s_barrier
    s_waitcnt lgkmcnt(5)
    v_mfma_f32_16x16x32_bf16 v[128:131], v[48:51], v[160:163], 0
    s_setprio 3
    v_cvt_pk_bf16_f32 v104, 0, v104
    v_cvt_pk_bf16_f32 v105, 0, v105
    v_cvt_pk_bf16_f32 v106, 0, v106
    v_mfma_f32_16x16x32_bf16 v[132:135], v[48:51], v[176:179], 0
    ds_read_b128 v[72:75], v18 offset:36864
    v_cvt_pk_bf16_f32 v107, 0, v107
    v_mul_f32 v104, s34, v104
    v_mul_f32 v105, s34, v105
    s_waitcnt lgkmcnt(5)
    v_mfma_f32_16x16x32_bf16 v[128:131], v[52:55], v[164:167], v[128:131]
    v_mul_f32 v106, s34, v106
    v_mul_f32 v107, s34, v107
    s_mov_b32 m0, s38
    s_nop 0
    buffer_load_dwordx4 v28, s[8:11], s35 offen lds
    buffer_load_dwordx4 v29, s[8:11], s35 offen offset:1024 lds
    s_add_u32 s35, s35, 16384
    v_mfma_f32_16x16x32_bf16 v[132:135], v[52:55], v[180:183], v[132:135]
    ds_read_b128 v[76:79], v19 offset:36864
    v_cvt_pk_bf16_f32 v104, 0, v104
    v_cvt_pk_bf16_f32 v105, 0, v105
    v_cvt_pk_bf16_f32 v106, 0, v106
    s_waitcnt lgkmcnt(5)
    v_mfma_f32_16x16x32_bf16 v[128:131], v[56:59], v[168:171], v[128:131]
    v_cvt_pk_bf16_f32 v107, 0, v107
    v_fma_f32 v104, v104, s32, -v2
    v_fma_f32 v105, v105, s32, -v2
    v_mfma_f32_16x16x32_bf16 v[132:135], v[56:59], v[184:187], v[132:135]
    ds_read_b128 v[48:51], v16 offset:40960
    v_fma_f32 v106, v106, s32, -v2
    v_fma_f32 v107, v107, s32, -v2
    s_waitcnt lgkmcnt(5)
    v_mfma_f32_16x16x32_bf16 v[128:131], v[60:63], v[172:175], v[128:131]
    v_exp_f32 v104, v104
    v_exp_f32 v105, v105
    v_exp_f32 v106, v106
    s_mov_b32 m0, s40
    s_nop 0
    buffer_load_dwordx4 v30, s[12:15], s36 offen lds
    buffer_load_dwordx4 v31, s[12:15], s36 offen offset:1024 lds
    s_add_u32 s36, s36, 16384
    v_mfma_f32_16x16x32_bf16 v[132:135], v[60:63], v[188:191], v[132:135]
    ds_read_b128 v[52:55], v17 offset:40960
    v_exp_f32 v107, v107
    v_cvt_pk_bf16_f32 v82, v104, v105
    v_cvt_pk_bf16_f32 v83, v106, v107
    s_waitcnt lgkmcnt(5)
    v_mfma_f32_16x16x32_bf16 v[136:139], v[64:67], v[160:163], 0
    v_cvt_pk_bf16_f32 v108, 0, v108
    v_cvt_pk_bf16_f32 v109, 0, v109
    v_mfma_f32_16x16x32_bf16 v[140:143], v[64:67], v[176:179], 0
    ds_read_b128 v[56:59], v18 offset:40960
    v_cvt_pk_bf16_f32 v110, 0, v110
    v_cvt_pk_bf16_f32 v111, 0, v111
    v_mul_f32 v108, s34, v108
    s_waitcnt lgkmcnt(5)
    v_mfma_f32_16x16x32_bf16 v[136:139], v[68:71], v[164:167], v[136:139]
    v_mul_f32 v109, s34, v109
    v_mul_f32 v110, s34, v110
    v_mul_f32 v111, s34, v111
    v_mfma_f32_16x16x32_bf16 v[140:143], v[68:71], v[180:183], v[140:143]
    ds_read_b128 v[60:63], v19 offset:40960
    v_cvt_pk_bf16_f32 v108, 0, v108
    v_cvt_pk_bf16_f32 v109, 0, v109
    s_waitcnt lgkmcnt(5)
    v_mfma_f32_16x16x32_bf16 v[136:139], v[72:75], v[168:171], v[136:139]
    v_cvt_pk_bf16_f32 v110, 0, v110
    v_cvt_pk_bf16_f32 v111, 0, v111
    v_fma_f32 v108, v108, s32, -v3
    v_mfma_f32_16x16x32_bf16 v[140:143], v[72:75], v[184:187], v[140:143]
    ds_read_b128 v[64:67], v16 offset:45056
    v_fma_f32 v109, v109, s32, -v3
    v_fma_f32 v110, v110, s32, -v3
    s_waitcnt lgkmcnt(5)
    v_mfma_f32_16x16x32_bf16 v[136:139], v[76:79], v[172:175], v[136:139]
    v_fma_f32 v111, v111, s32, -v3
    v_exp_f32 v108, v108
    v_exp_f32 v109, v109
    v_mfma_f32_16x16x32_bf16 v[140:143], v[76:79], v[188:191], v[140:143]
    ds_read_b128 v[68:71], v17 offset:45056
    v_exp_f32 v110, v110
    v_exp_f32 v111, v111
    v_cvt_pk_bf16_f32 v86, v108, v109
    s_waitcnt lgkmcnt(5)
    v_mfma_f32_16x16x32_bf16 v[144:147], v[48:51], v[160:163], 0
    v_cvt_pk_bf16_f32 v87, v110, v111
    v_cvt_pk_bf16_f32 v112, 0, v112
    v_mfma_f32_16x16x32_bf16 v[148:151], v[48:51], v[176:179], 0
    ds_read_b128 v[72:75], v18 offset:45056
    s_setprio 2
    v_cvt_pk_bf16_f32 v113, 0, v113
    v_cvt_pk_bf16_f32 v114, 0, v114
    v_cvt_pk_bf16_f32 v115, 0, v115
    s_waitcnt lgkmcnt(5)
    v_mfma_f32_16x16x32_bf16 v[144:147], v[52:55], v[164:167], v[144:147]
    v_mul_f32 v112, s34, v112
    v_mul_f32 v113, s34, v113
    v_mul_f32 v114, s34, v114
    v_mfma_f32_16x16x32_bf16 v[148:151], v[52:55], v[180:183], v[148:151]
    ds_read_b128 v[76:79], v19 offset:45056
    v_mul_f32 v115, s34, v115
    v_cvt_pk_bf16_f32 v112, 0, v112
    s_waitcnt lgkmcnt(5)
    v_mfma_f32_16x16x32_bf16 v[144:147], v[56:59], v[168:171], v[144:147]
    v_cvt_pk_bf16_f32 v113, 0, v113
    v_cvt_pk_bf16_f32 v114, 0, v114
    v_cvt_pk_bf16_f32 v115, 0, v115
    v_mfma_f32_16x16x32_bf16 v[148:151], v[56:59], v[184:187], v[148:151]
    ds_read_b64_tr_b16 v[48:49], v20 offset:16384
    ds_read_b64_tr_b16 v[50:51], v20 offset:20480
    v_fma_f32 v112, v112, s32, -v2
    v_fma_f32 v113, v113, s32, -v2
    v_fma_f32 v114, v114, s32, -v2
    s_waitcnt lgkmcnt(6)
    v_mfma_f32_16x16x32_bf16 v[144:147], v[60:63], v[172:175], v[144:147]
    v_fma_f32 v115, v115, s32, -v2
    v_exp_f32 v112, v112
    v_mfma_f32_16x16x32_bf16 v[148:151], v[60:63], v[188:191], v[148:151]
    ds_read_b64_tr_b16 v[52:53], v21 offset:16384
    ds_read_b64_tr_b16 v[54:55], v21 offset:20480
    v_exp_f32 v113, v113
    v_exp_f32 v114, v114
    v_exp_f32 v115, v115
    s_waitcnt lgkmcnt(7)
    v_mfma_f32_16x16x32_bf16 v[152:155], v[64:67], v[160:163], 0
    v_cvt_pk_bf16_f32 v88, v112, v113
    v_cvt_pk_bf16_f32 v89, v114, v115
    v_mfma_f32_16x16x32_bf16 v[156:159], v[64:67], v[176:179], 0
    ds_read_b64_tr_b16 v[56:57], v22 offset:16384
    ds_read_b64_tr_b16 v[58:59], v22 offset:20480
    v_cvt_pk_bf16_f32 v116, 0, v116
    v_cvt_pk_bf16_f32 v117, 0, v117
    v_cvt_pk_bf16_f32 v118, 0, v118
    s_waitcnt lgkmcnt(8)
    v_mfma_f32_16x16x32_bf16 v[152:155], v[68:71], v[164:167], v[152:155]
    v_cvt_pk_bf16_f32 v119, 0, v119
    v_mul_f32 v116, s34, v116
    v_mul_f32 v117, s34, v117
    v_mfma_f32_16x16x32_bf16 v[156:159], v[68:71], v[180:183], v[156:159]
    ds_read_b64_tr_b16 v[60:61], v23 offset:16384
    ds_read_b64_tr_b16 v[62:63], v23 offset:20480
    v_mul_f32 v118, s34, v118
    v_mul_f32 v119, s34, v119
    s_waitcnt lgkmcnt(9)
    v_mfma_f32_16x16x32_bf16 v[152:155], v[72:75], v[168:171], v[152:155]
    v_cvt_pk_bf16_f32 v116, 0, v116
    v_cvt_pk_bf16_f32 v117, 0, v117
    v_cvt_pk_bf16_f32 v118, 0, v118
    v_mfma_f32_16x16x32_bf16 v[156:159], v[72:75], v[184:187], v[156:159]
    ds_read_b64_tr_b16 v[64:65], v24 offset:16384
    ds_read_b64_tr_b16 v[66:67], v24 offset:20480
    v_cvt_pk_bf16_f32 v119, 0, v119
    v_fma_f32 v116, v116, s32, -v3
    v_fma_f32 v117, v117, s32, -v3
    s_waitcnt lgkmcnt(10)
    v_mfma_f32_16x16x32_bf16 v[152:155], v[76:79], v[172:175], v[152:155]
    v_fma_f32 v118, v118, s32, -v3
    v_fma_f32 v119, v119, s32, -v3
    v_mfma_f32_16x16x32_bf16 v[156:159], v[76:79], v[188:191], v[156:159]
    ds_read_b64_tr_b16 v[68:69], v25 offset:16384
    ds_read_b64_tr_b16 v[70:71], v25 offset:20480
    v_exp_f32 v116, v116
    v_exp_f32 v117, v117
    v_exp_f32 v118, v118
    s_waitcnt lgkmcnt(10)
    v_mfma_f32_16x16x32_bf16 v[192:195], v[48:51], v[80:83], v[192:195]
    v_exp_f32 v119, v119
    v_cvt_pk_bf16_f32 v92, v116, v117
    v_cvt_pk_bf16_f32 v93, v118, v119
    s_nop 1
    v_mfma_f32_16x16x32_bf16 v[196:199], v[48:51], v[84:87], v[196:199]
    ds_read_b64_tr_b16 v[72:73], v26 offset:16384
    ds_read_b64_tr_b16 v[74:75], v26 offset:20480
    v_cvt_pk_bf16_f32 v120, 0, v120
    v_cvt_pk_bf16_f32 v121, 0, v121
    s_waitcnt lgkmcnt(10)
    v_mfma_f32_16x16x32_bf16 v[200:203], v[52:55], v[80:83], v[200:203]
    s_setprio 1
    v_cvt_pk_bf16_f32 v122, 0, v122
    v_cvt_pk_bf16_f32 v123, 0, v123
    v_mul_f32 v120, s34, v120
    v_mfma_f32_16x16x32_bf16 v[204:207], v[52:55], v[84:87], v[204:207]
    ds_read_b64_tr_b16 v[76:77], v27 offset:16384
    ds_read_b64_tr_b16 v[78:79], v27 offset:20480
    v_mul_f32 v121, s34, v121
    v_mul_f32 v122, s34, v122
    v_mul_f32 v123, s34, v123
    s_waitcnt lgkmcnt(10)
    v_mfma_f32_16x16x32_bf16 v[208:211], v[56:59], v[80:83], v[208:211]
    v_cvt_pk_bf16_f32 v120, 0, v120
    v_cvt_pk_bf16_f32 v121, 0, v121
    v_mfma_f32_16x16x32_bf16 v[212:215], v[56:59], v[84:87], v[212:215]
    ds_read_b64_tr_b16 v[48:49], v20 offset:24576
    ds_read_b64_tr_b16 v[50:51], v20 offset:28672
    v_cvt_pk_bf16_f32 v122, 0, v122
    v_cvt_pk_bf16_f32 v123, 0, v123
    v_fma_f32 v120, v120, s32, -v2
    s_waitcnt lgkmcnt(10)
    v_mfma_f32_16x16x32_bf16 v[216:219], v[60:63], v[80:83], v[216:219]
    v_fma_f32 v121, v121, s32, -v2
    v_fma_f32 v122, v122, s32, -v2
    v_mfma_f32_16x16x32_bf16 v[220:223], v[60:63], v[84:87], v[220:223]
    ds_read_b64_tr_b16 v[52:53], v21 offset:24576
    ds_read_b64_tr_b16 v[54:55], v21 offset:28672
    v_fma_f32 v123, v123, s32, -v2
    v_exp_f32 v120, v120
    v_exp_f32 v121, v121
    s_waitcnt lgkmcnt(10)
    v_mfma_f32_16x16x32_bf16 v[224:227], v[64:67], v[80:83], v[224:227]
    v_exp_f32 v122, v122
    v_exp_f32 v123, v123
    v_cvt_pk_bf16_f32 v90, v120, v121
    s_nop 1
    v_mfma_f32_16x16x32_bf16 v[228:231], v[64:67], v[84:87], v[228:231]
    ds_read_b64_tr_b16 v[56:57], v22 offset:24576
    ds_read_b64_tr_b16 v[58:59], v22 offset:28672
    v_cvt_pk_bf16_f32 v91, v122, v123
    v_cvt_pk_bf16_f32 v124, 0, v124
    s_waitcnt lgkmcnt(10)
    v_mfma_f32_16x16x32_bf16 v[232:235], v[68:71], v[80:83], v[232:235]
    v_cvt_pk_bf16_f32 v125, 0, v125
    v_cvt_pk_bf16_f32 v126, 0, v126
    v_cvt_pk_bf16_f32 v127, 0, v127
    v_mfma_f32_16x16x32_bf16 v[236:239], v[68:71], v[84:87], v[236:239]
    ds_read_b64_tr_b16 v[60:61], v23 offset:24576
    ds_read_b64_tr_b16 v[62:63], v23 offset:28672
    v_mul_f32 v124, s34, v124
    v_mul_f32 v125, s34, v125
    v_mul_f32 v126, s34, v126
    s_waitcnt lgkmcnt(10)
    v_mfma_f32_16x16x32_bf16 v[240:243], v[72:75], v[80:83], v[240:243]
    v_mul_f32 v127, s34, v127
    v_cvt_pk_bf16_f32 v124, 0, v124
    v_mfma_f32_16x16x32_bf16 v[244:247], v[72:75], v[84:87], v[244:247]
    ds_read_b64_tr_b16 v[64:65], v24 offset:24576
    ds_read_b64_tr_b16 v[66:67], v24 offset:28672
    v_cvt_pk_bf16_f32 v125, 0, v125
    v_cvt_pk_bf16_f32 v126, 0, v126
    v_cvt_pk_bf16_f32 v127, 0, v127
    s_waitcnt lgkmcnt(10)
    v_mfma_f32_16x16x32_bf16 v[248:251], v[76:79], v[80:83], v[248:251]
    v_fma_f32 v124, v124, s32, -v3
    v_fma_f32 v125, v125, s32, -v3
    v_fma_f32 v126, v126, s32, -v3
    v_mfma_f32_16x16x32_bf16 v[252:255], v[76:79], v[84:87], v[252:255]
    ds_read_b64_tr_b16 v[68:69], v25 offset:24576
    ds_read_b64_tr_b16 v[70:71], v25 offset:28672
    v_fma_f32 v127, v127, s32, -v3
    v_exp_f32 v124, v124
    v_mfma_f32_16x16x32_bf16 v[32:35], v[12:15], v[80:83], v[32:35]
    v_exp_f32 v125, v125
    v_exp_f32 v126, v126
    v_exp_f32 v127, v127
    v_mfma_f32_16x16x32_bf16 v[36:39], v[12:15], v[84:87], v[36:39]
    v_cvt_pk_bf16_f32 v94, v124, v125
    v_cvt_pk_bf16_f32 v95, v126, v127
    s_waitcnt lgkmcnt(10)
    s_nop 0
    v_mfma_f32_16x16x32_bf16 v[192:195], v[48:51], v[88:91], v[192:195]
    v_cvt_pk_bf16_f32 v128, 0, v128
    v_cvt_pk_bf16_f32 v129, 0, v129
    v_cvt_pk_bf16_f32 v130, 0, v130
    v_mfma_f32_16x16x32_bf16 v[196:199], v[48:51], v[92:95], v[196:199]
    ds_read_b64_tr_b16 v[72:73], v26 offset:24576
    ds_read_b64_tr_b16 v[74:75], v26 offset:28672
    s_setprio 0
    v_cvt_pk_bf16_f32 v131, 0, v131
    v_mul_f32 v128, s34, v128
    s_waitcnt lgkmcnt(10)
    v_mfma_f32_16x16x32_bf16 v[200:203], v[52:55], v[88:91], v[200:203]
    v_mul_f32 v129, s34, v129
    v_mul_f32 v130, s34, v130
    v_mul_f32 v131, s34, v131
    v_mfma_f32_16x16x32_bf16 v[204:207], v[52:55], v[92:95], v[204:207]
    ds_read_b64_tr_b16 v[76:77], v27 offset:24576
    ds_read_b64_tr_b16 v[78:79], v27 offset:28672
    v_cvt_pk_bf16_f32 v128, 0, v128
    v_cvt_pk_bf16_f32 v129, 0, v129
    s_waitcnt lgkmcnt(10)
    v_mfma_f32_16x16x32_bf16 v[208:211], v[56:59], v[88:91], v[208:211]
    v_cvt_pk_bf16_f32 v130, 0, v130
    v_cvt_pk_bf16_f32 v131, 0, v131
    v_fma_f32 v128, v128, s32, -v2
    v_mfma_f32_16x16x32_bf16 v[212:215], v[56:59], v[92:95], v[212:215]
    ds_read_b128 v[48:51], v16 offset:0
    v_fma_f32 v129, v129, s32, -v2
    v_fma_f32 v130, v130, s32, -v2
    s_waitcnt lgkmcnt(9)
    v_mfma_f32_16x16x32_bf16 v[216:219], v[60:63], v[88:91], v[216:219]
    v_fma_f32 v131, v131, s32, -v2
    v_exp_f32 v128, v128
    v_exp_f32 v129, v129
    v_mfma_f32_16x16x32_bf16 v[220:223], v[60:63], v[92:95], v[220:223]
    ds_read_b128 v[52:55], v17 offset:0
    v_exp_f32 v130, v130
    v_exp_f32 v131, v131
    s_waitcnt lgkmcnt(8)
    v_mfma_f32_16x16x32_bf16 v[224:227], v[64:67], v[88:91], v[224:227]
    v_cvt_pk_bf16_f32 v80, v128, v129
    v_cvt_pk_bf16_f32 v81, v130, v131
    s_nop 1
    v_mfma_f32_16x16x32_bf16 v[228:231], v[64:67], v[92:95], v[228:231]
    ds_read_b128 v[56:59], v18 offset:0
    v_cvt_pk_bf16_f32 v132, 0, v132
    v_cvt_pk_bf16_f32 v133, 0, v133
    v_cvt_pk_bf16_f32 v134, 0, v134
    s_waitcnt lgkmcnt(7)
    v_mfma_f32_16x16x32_bf16 v[232:235], v[68:71], v[88:91], v[232:235]
    v_cvt_pk_bf16_f32 v135, 0, v135
    v_mul_f32 v132, s34, v132
    v_mfma_f32_16x16x32_bf16 v[236:239], v[68:71], v[92:95], v[236:239]
    ds_read_b128 v[60:63], v19 offset:0
    v_mul_f32 v133, s34, v133
    v_mul_f32 v134, s34, v134
    v_mul_f32 v135, s34, v135
    s_waitcnt lgkmcnt(6)
    v_mfma_f32_16x16x32_bf16 v[240:243], v[72:75], v[88:91], v[240:243]
    v_cvt_pk_bf16_f32 v132, 0, v132
    v_cvt_pk_bf16_f32 v133, 0, v133
    v_mfma_f32_16x16x32_bf16 v[244:247], v[72:75], v[92:95], v[244:247]
    ds_read_b128 v[64:67], v16 offset:4096
    v_cvt_pk_bf16_f32 v134, 0, v134
    v_cvt_pk_bf16_f32 v135, 0, v135
    v_fma_f32 v132, v132, s32, -v3
    s_waitcnt lgkmcnt(5)
    v_mfma_f32_16x16x32_bf16 v[248:251], v[76:79], v[88:91], v[248:251]
    v_fma_f32 v133, v133, s32, -v3
    v_fma_f32 v134, v134, s32, -v3
    v_mfma_f32_16x16x32_bf16 v[252:255], v[76:79], v[92:95], v[252:255]
    ds_read_b128 v[68:71], v17 offset:4096
    v_fma_f32 v135, v135, s32, -v3
    v_exp_f32 v132, v132
    v_exp_f32 v133, v133
    v_mfma_f32_16x16x32_bf16 v[32:35], v[12:15], v[88:91], v[32:35]
    v_exp_f32 v134, v134
    v_exp_f32 v135, v135
    v_mfma_f32_16x16x32_bf16 v[36:39], v[12:15], v[92:95], v[36:39]
    v_cvt_pk_bf16_f32 v84, v132, v133
    v_cvt_pk_bf16_f32 v85, v134, v135
    s_waitcnt vmcnt(0)
    s_barrier
    s_waitcnt lgkmcnt(5)
    v_mfma_f32_16x16x32_bf16 v[96:99], v[48:51], v[160:163], 0
    s_setprio 3
    v_cvt_pk_bf16_f32 v136, 0, v136
    v_cvt_pk_bf16_f32 v137, 0, v137
    v_cvt_pk_bf16_f32 v138, 0, v138
    v_mfma_f32_16x16x32_bf16 v[100:103], v[48:51], v[176:179], 0
    ds_read_b128 v[72:75], v18 offset:4096
    v_cvt_pk_bf16_f32 v139, 0, v139
    v_mul_f32 v136, s34, v136
    v_mul_f32 v137, s34, v137
    s_waitcnt lgkmcnt(5)
    v_mfma_f32_16x16x32_bf16 v[96:99], v[52:55], v[164:167], v[96:99]
    v_mul_f32 v138, s34, v138
    v_mul_f32 v139, s34, v139
    s_mov_b32 m0, s39
    s_nop 0
    buffer_load_dwordx4 v28, s[8:11], s35 offen lds
    buffer_load_dwordx4 v29, s[8:11], s35 offen offset:1024 lds
    s_add_u32 s35, s35, 16384
    v_mfma_f32_16x16x32_bf16 v[100:103], v[52:55], v[180:183], v[100:103]
    ds_read_b128 v[76:79], v19 offset:4096
    v_cvt_pk_bf16_f32 v136, 0, v136
    v_cvt_pk_bf16_f32 v137, 0, v137
    v_cvt_pk_bf16_f32 v138, 0, v138
    s_waitcnt lgkmcnt(5)
    v_mfma_f32_16x16x32_bf16 v[96:99], v[56:59], v[168:171], v[96:99]
    v_cvt_pk_bf16_f32 v139, 0, v139
    v_fma_f32 v136, v136, s32, -v2
    v_fma_f32 v137, v137, s32, -v2
    v_mfma_f32_16x16x32_bf16 v[100:103], v[56:59], v[184:187], v[100:103]
    ds_read_b128 v[48:51], v16 offset:8192
    v_fma_f32 v138, v138, s32, -v2
    v_fma_f32 v139, v139, s32, -v2
    s_waitcnt lgkmcnt(5)
    v_mfma_f32_16x16x32_bf16 v[96:99], v[60:63], v[172:175], v[96:99]
    v_exp_f32 v136, v136
    v_exp_f32 v137, v137
    v_exp_f32 v138, v138
    s_mov_b32 m0, s41
    s_nop 0
    buffer_load_dwordx4 v30, s[12:15], s36 offen lds
    buffer_load_dwordx4 v31, s[12:15], s36 offen offset:1024 lds
    s_add_u32 s36, s36, 16384
    v_mfma_f32_16x16x32_bf16 v[100:103], v[60:63], v[188:191], v[100:103]
    ds_read_b128 v[52:55], v17 offset:8192
    v_exp_f32 v139, v139
    v_cvt_pk_bf16_f32 v82, v136, v137
    v_cvt_pk_bf16_f32 v83, v138, v139
    s_waitcnt lgkmcnt(5)
    v_mfma_f32_16x16x32_bf16 v[104:107], v[64:67], v[160:163], 0
    v_cvt_pk_bf16_f32 v140, 0, v140
    v_cvt_pk_bf16_f32 v141, 0, v141
    v_mfma_f32_16x16x32_bf16 v[108:111], v[64:67], v[176:179], 0
    ds_read_b128 v[56:59], v18 offset:8192
    v_cvt_pk_bf16_f32 v142, 0, v142
    v_cvt_pk_bf16_f32 v143, 0, v143
    v_mul_f32 v140, s34, v140
    s_waitcnt lgkmcnt(5)
    v_mfma_f32_16x16x32_bf16 v[104:107], v[68:71], v[164:167], v[104:107]
    v_mul_f32 v141, s34, v141
    v_mul_f32 v142, s34, v142
    v_mul_f32 v143, s34, v143
    v_mfma_f32_16x16x32_bf16 v[108:111], v[68:71], v[180:183], v[108:111]
    ds_read_b128 v[60:63], v19 offset:8192
    v_cvt_pk_bf16_f32 v140, 0, v140
    v_cvt_pk_bf16_f32 v141, 0, v141
    s_waitcnt lgkmcnt(5)
    v_mfma_f32_16x16x32_bf16 v[104:107], v[72:75], v[168:171], v[104:107]
    v_cvt_pk_bf16_f32 v142, 0, v142
    v_cvt_pk_bf16_f32 v143, 0, v143
    v_fma_f32 v140, v140, s32, -v3
    v_mfma_f32_16x16x32_bf16 v[108:111], v[72:75], v[184:187], v[108:111]
    ds_read_b128 v[64:67], v16 offset:12288
    v_fma_f32 v141, v141, s32, -v3
    v_fma_f32 v142, v142, s32, -v3
    s_waitcnt lgkmcnt(5)
    v_mfma_f32_16x16x32_bf16 v[104:107], v[76:79], v[172:175], v[104:107]
    v_fma_f32 v143, v143, s32, -v3
    v_exp_f32 v140, v140
    v_exp_f32 v141, v141
    v_mfma_f32_16x16x32_bf16 v[108:111], v[76:79], v[188:191], v[108:111]
    ds_read_b128 v[68:71], v17 offset:12288
    v_exp_f32 v142, v142
    v_exp_f32 v143, v143
    v_cvt_pk_bf16_f32 v86, v140, v141
    s_waitcnt lgkmcnt(5)
    v_mfma_f32_16x16x32_bf16 v[112:115], v[48:51], v[160:163], 0
    v_cvt_pk_bf16_f32 v87, v142, v143
    v_cvt_pk_bf16_f32 v144, 0, v144
    v_mfma_f32_16x16x32_bf16 v[116:119], v[48:51], v[176:179], 0
    ds_read_b128 v[72:75], v18 offset:12288
    s_setprio 2
    v_cvt_pk_bf16_f32 v145, 0, v145
    v_cvt_pk_bf16_f32 v146, 0, v146
    v_cvt_pk_bf16_f32 v147, 0, v147
    s_waitcnt lgkmcnt(5)
    v_mfma_f32_16x16x32_bf16 v[112:115], v[52:55], v[164:167], v[112:115]
    v_mul_f32 v144, s34, v144
    v_mul_f32 v145, s34, v145
    v_mul_f32 v146, s34, v146
    v_mfma_f32_16x16x32_bf16 v[116:119], v[52:55], v[180:183], v[116:119]
    ds_read_b128 v[76:79], v19 offset:12288
    v_mul_f32 v147, s34, v147
    v_cvt_pk_bf16_f32 v144, 0, v144
    s_waitcnt lgkmcnt(5)
    v_mfma_f32_16x16x32_bf16 v[112:115], v[56:59], v[168:171], v[112:115]
    v_cvt_pk_bf16_f32 v145, 0, v145
    v_cvt_pk_bf16_f32 v146, 0, v146
    v_cvt_pk_bf16_f32 v147, 0, v147
    v_mfma_f32_16x16x32_bf16 v[116:119], v[56:59], v[184:187], v[116:119]
    ds_read_b64_tr_b16 v[48:49], v20 offset:32768
    ds_read_b64_tr_b16 v[50:51], v20 offset:36864
    v_fma_f32 v144, v144, s32, -v2
    v_fma_f32 v145, v145, s32, -v2
    v_fma_f32 v146, v146, s32, -v2
    s_waitcnt lgkmcnt(6)
    v_mfma_f32_16x16x32_bf16 v[112:115], v[60:63], v[172:175], v[112:115]
    v_fma_f32 v147, v147, s32, -v2
    v_exp_f32 v144, v144
    v_mfma_f32_16x16x32_bf16 v[116:119], v[60:63], v[188:191], v[116:119]
    ds_read_b64_tr_b16 v[52:53], v21 offset:32768
    ds_read_b64_tr_b16 v[54:55], v21 offset:36864
    v_exp_f32 v145, v145
    v_exp_f32 v146, v146
    v_exp_f32 v147, v147
    s_waitcnt lgkmcnt(7)
    v_mfma_f32_16x16x32_bf16 v[120:123], v[64:67], v[160:163], 0
    v_cvt_pk_bf16_f32 v88, v144, v145
    v_cvt_pk_bf16_f32 v89, v146, v147
    v_mfma_f32_16x16x32_bf16 v[124:127], v[64:67], v[176:179], 0
    ds_read_b64_tr_b16 v[56:57], v22 offset:32768
    ds_read_b64_tr_b16 v[58:59], v22 offset:36864
    v_cvt_pk_bf16_f32 v148, 0, v148
    v_cvt_pk_bf16_f32 v149, 0, v149
    v_cvt_pk_bf16_f32 v150, 0, v150
    s_waitcnt lgkmcnt(8)
    v_mfma_f32_16x16x32_bf16 v[120:123], v[68:71], v[164:167], v[120:123]
    v_cvt_pk_bf16_f32 v151, 0, v151
    v_mul_f32 v148, s34, v148
    v_mul_f32 v149, s34, v149
    v_mfma_f32_16x16x32_bf16 v[124:127], v[68:71], v[180:183], v[124:127]
    ds_read_b64_tr_b16 v[60:61], v23 offset:32768
    ds_read_b64_tr_b16 v[62:63], v23 offset:36864
    v_mul_f32 v150, s34, v150
    v_mul_f32 v151, s34, v151
    s_waitcnt lgkmcnt(9)
    v_mfma_f32_16x16x32_bf16 v[120:123], v[72:75], v[168:171], v[120:123]
    v_cvt_pk_bf16_f32 v148, 0, v148
    v_cvt_pk_bf16_f32 v149, 0, v149
    v_cvt_pk_bf16_f32 v150, 0, v150
    v_mfma_f32_16x16x32_bf16 v[124:127], v[72:75], v[184:187], v[124:127]
    ds_read_b64_tr_b16 v[64:65], v24 offset:32768
    ds_read_b64_tr_b16 v[66:67], v24 offset:36864
    v_cvt_pk_bf16_f32 v151, 0, v151
    v_fma_f32 v148, v148, s32, -v3
    v_fma_f32 v149, v149, s32, -v3
    s_waitcnt lgkmcnt(10)
    v_mfma_f32_16x16x32_bf16 v[120:123], v[76:79], v[172:175], v[120:123]
    v_fma_f32 v150, v150, s32, -v3
    v_fma_f32 v151, v151, s32, -v3
    v_mfma_f32_16x16x32_bf16 v[124:127], v[76:79], v[188:191], v[124:127]
    ds_read_b64_tr_b16 v[68:69], v25 offset:32768
    ds_read_b64_tr_b16 v[70:71], v25 offset:36864
    v_exp_f32 v148, v148
    v_exp_f32 v149, v149
    v_exp_f32 v150, v150
    s_waitcnt lgkmcnt(10)
    v_mfma_f32_16x16x32_bf16 v[192:195], v[48:51], v[80:83], v[192:195]
    v_exp_f32 v151, v151
    v_cvt_pk_bf16_f32 v92, v148, v149
    v_cvt_pk_bf16_f32 v93, v150, v151
    s_nop 1
    v_mfma_f32_16x16x32_bf16 v[196:199], v[48:51], v[84:87], v[196:199]
    ds_read_b64_tr_b16 v[72:73], v26 offset:32768
    ds_read_b64_tr_b16 v[74:75], v26 offset:36864
    v_cvt_pk_bf16_f32 v152, 0, v152
    v_cvt_pk_bf16_f32 v153, 0, v153
    s_waitcnt lgkmcnt(10)
    v_mfma_f32_16x16x32_bf16 v[200:203], v[52:55], v[80:83], v[200:203]
    s_setprio 1
    v_cvt_pk_bf16_f32 v154, 0, v154
    v_cvt_pk_bf16_f32 v155, 0, v155
    v_mul_f32 v152, s34, v152
    v_mfma_f32_16x16x32_bf16 v[204:207], v[52:55], v[84:87], v[204:207]
    ds_read_b64_tr_b16 v[76:77], v27 offset:32768
    ds_read_b64_tr_b16 v[78:79], v27 offset:36864
    v_mul_f32 v153, s34, v153
    v_mul_f32 v154, s34, v154
    v_mul_f32 v155, s34, v155
    s_waitcnt lgkmcnt(10)
    v_mfma_f32_16x16x32_bf16 v[208:211], v[56:59], v[80:83], v[208:211]
    v_cvt_pk_bf16_f32 v152, 0, v152
    v_cvt_pk_bf16_f32 v153, 0, v153
    v_mfma_f32_16x16x32_bf16 v[212:215], v[56:59], v[84:87], v[212:215]
    ds_read_b64_tr_b16 v[48:49], v20 offset:40960
    ds_read_b64_tr_b16 v[50:51], v20 offset:45056
    v_cvt_pk_bf16_f32 v154, 0, v154
    v_cvt_pk_bf16_f32 v155, 0, v155
    v_fma_f32 v152, v152, s32, -v2
    s_waitcnt lgkmcnt(10)
    v_mfma_f32_16x16x32_bf16 v[216:219], v[60:63], v[80:83], v[216:219]
    v_fma_f32 v153, v153, s32, -v2
    v_fma_f32 v154, v154, s32, -v2
    v_mfma_f32_16x16x32_bf16 v[220:223], v[60:63], v[84:87], v[220:223]
    ds_read_b64_tr_b16 v[52:53], v21 offset:40960
    ds_read_b64_tr_b16 v[54:55], v21 offset:45056
    v_fma_f32 v155, v155, s32, -v2
    v_exp_f32 v152, v152
    v_exp_f32 v153, v153
    s_waitcnt lgkmcnt(10)
    v_mfma_f32_16x16x32_bf16 v[224:227], v[64:67], v[80:83], v[224:227]
    v_exp_f32 v154, v154
    v_exp_f32 v155, v155
    v_cvt_pk_bf16_f32 v90, v152, v153
    s_nop 1
    v_mfma_f32_16x16x32_bf16 v[228:231], v[64:67], v[84:87], v[228:231]
    ds_read_b64_tr_b16 v[56:57], v22 offset:40960
    ds_read_b64_tr_b16 v[58:59], v22 offset:45056
    v_cvt_pk_bf16_f32 v91, v154, v155
    v_cvt_pk_bf16_f32 v156, 0, v156
    s_waitcnt lgkmcnt(10)
    v_mfma_f32_16x16x32_bf16 v[232:235], v[68:71], v[80:83], v[232:235]
    v_cvt_pk_bf16_f32 v157, 0, v157
    v_cvt_pk_bf16_f32 v158, 0, v158
    v_cvt_pk_bf16_f32 v159, 0, v159
    v_mfma_f32_16x16x32_bf16 v[236:239], v[68:71], v[84:87], v[236:239]
    ds_read_b64_tr_b16 v[60:61], v23 offset:40960
    ds_read_b64_tr_b16 v[62:63], v23 offset:45056
    v_mul_f32 v156, s34, v156
    v_mul_f32 v157, s34, v157
    v_mul_f32 v158, s34, v158
    s_waitcnt lgkmcnt(10)
    v_mfma_f32_16x16x32_bf16 v[240:243], v[72:75], v[80:83], v[240:243]
    v_mul_f32 v159, s34, v159
    v_cvt_pk_bf16_f32 v156, 0, v156
    v_mfma_f32_16x16x32_bf16 v[244:247], v[72:75], v[84:87], v[244:247]
    ds_read_b64_tr_b16 v[64:65], v24 offset:40960
    ds_read_b64_tr_b16 v[66:67], v24 offset:45056
    v_cvt_pk_bf16_f32 v157, 0, v157
    v_cvt_pk_bf16_f32 v158, 0, v158
    v_cvt_pk_bf16_f32 v159, 0, v159
    s_waitcnt lgkmcnt(10)
    v_mfma_f32_16x16x32_bf16 v[248:251], v[76:79], v[80:83], v[248:251]
    v_fma_f32 v156, v156, s32, -v3
    v_fma_f32 v157, v157, s32, -v3
    v_fma_f32 v158, v158, s32, -v3
    v_mfma_f32_16x16x32_bf16 v[252:255], v[76:79], v[84:87], v[252:255]
    ds_read_b64_tr_b16 v[68:69], v25 offset:40960
    ds_read_b64_tr_b16 v[70:71], v25 offset:45056
    v_fma_f32 v159, v159, s32, -v3
    v_exp_f32 v156, v156
    v_mfma_f32_16x16x32_bf16 v[32:35], v[12:15], v[80:83], v[32:35]
    v_exp_f32 v157, v157
    v_exp_f32 v158, v158
    v_exp_f32 v159, v159
    v_mfma_f32_16x16x32_bf16 v[36:39], v[12:15], v[84:87], v[36:39]
    v_cvt_pk_bf16_f32 v94, v156, v157
    v_cvt_pk_bf16_f32 v95, v158, v159
    s_waitcnt lgkmcnt(10)
    s_nop 0
    v_mfma_f32_16x16x32_bf16 v[192:195], v[48:51], v[88:91], v[192:195]
    v_cvt_pk_bf16_f32 v96, 0, v96
    v_cvt_pk_bf16_f32 v97, 0, v97
    v_cvt_pk_bf16_f32 v98, 0, v98
    v_mfma_f32_16x16x32_bf16 v[196:199], v[48:51], v[92:95], v[196:199]
    ds_read_b64_tr_b16 v[72:73], v26 offset:40960
    ds_read_b64_tr_b16 v[74:75], v26 offset:45056
    s_setprio 0
    v_cvt_pk_bf16_f32 v99, 0, v99
    v_mul_f32 v96, s34, v96
    s_waitcnt lgkmcnt(10)
    v_mfma_f32_16x16x32_bf16 v[200:203], v[52:55], v[88:91], v[200:203]
    v_mul_f32 v97, s34, v97
    v_mul_f32 v98, s34, v98
    v_mul_f32 v99, s34, v99
    v_mfma_f32_16x16x32_bf16 v[204:207], v[52:55], v[92:95], v[204:207]
    ds_read_b64_tr_b16 v[76:77], v27 offset:40960
    ds_read_b64_tr_b16 v[78:79], v27 offset:45056
    v_cvt_pk_bf16_f32 v96, 0, v96
    v_cvt_pk_bf16_f32 v97, 0, v97
    s_waitcnt lgkmcnt(10)
    v_mfma_f32_16x16x32_bf16 v[208:211], v[56:59], v[88:91], v[208:211]
    v_cvt_pk_bf16_f32 v98, 0, v98
    v_cvt_pk_bf16_f32 v99, 0, v99
    v_fma_f32 v96, v96, s32, -v2
    v_mfma_f32_16x16x32_bf16 v[212:215], v[56:59], v[92:95], v[212:215]
    ds_read_b128 v[48:51], v16 offset:16384
    v_fma_f32 v97, v97, s32, -v2
    v_fma_f32 v98, v98, s32, -v2
    s_waitcnt lgkmcnt(9)
    v_mfma_f32_16x16x32_bf16 v[216:219], v[60:63], v[88:91], v[216:219]
    v_fma_f32 v99, v99, s32, -v2
    v_exp_f32 v96, v96
    v_exp_f32 v97, v97
    v_mfma_f32_16x16x32_bf16 v[220:223], v[60:63], v[92:95], v[220:223]
    ds_read_b128 v[52:55], v17 offset:16384
    v_exp_f32 v98, v98
    v_exp_f32 v99, v99
    s_waitcnt lgkmcnt(8)
    v_mfma_f32_16x16x32_bf16 v[224:227], v[64:67], v[88:91], v[224:227]
    v_cvt_pk_bf16_f32 v80, v96, v97
    v_cvt_pk_bf16_f32 v81, v98, v99
    s_nop 1
    v_mfma_f32_16x16x32_bf16 v[228:231], v[64:67], v[92:95], v[228:231]
    ds_read_b128 v[56:59], v18 offset:16384
    v_cvt_pk_bf16_f32 v100, 0, v100
    v_cvt_pk_bf16_f32 v101, 0, v101
    v_cvt_pk_bf16_f32 v102, 0, v102
    s_waitcnt lgkmcnt(7)
    v_mfma_f32_16x16x32_bf16 v[232:235], v[68:71], v[88:91], v[232:235]
    v_cvt_pk_bf16_f32 v103, 0, v103
    v_mul_f32 v100, s34, v100
    v_mfma_f32_16x16x32_bf16 v[236:239], v[68:71], v[92:95], v[236:239]
    ds_read_b128 v[60:63], v19 offset:16384
    v_mul_f32 v101, s34, v101
    v_mul_f32 v102, s34, v102
    v_mul_f32 v103, s34, v103
    s_waitcnt lgkmcnt(6)
    v_mfma_f32_16x16x32_bf16 v[240:243], v[72:75], v[88:91], v[240:243]
    v_cvt_pk_bf16_f32 v100, 0, v100
    v_cvt_pk_bf16_f32 v101, 0, v101
    v_mfma_f32_16x16x32_bf16 v[244:247], v[72:75], v[92:95], v[244:247]
    ds_read_b128 v[64:67], v16 offset:20480
    v_cvt_pk_bf16_f32 v102, 0, v102
    v_cvt_pk_bf16_f32 v103, 0, v103
    v_fma_f32 v100, v100, s32, -v3
    s_waitcnt lgkmcnt(5)
    v_mfma_f32_16x16x32_bf16 v[248:251], v[76:79], v[88:91], v[248:251]
    v_fma_f32 v101, v101, s32, -v3
    v_fma_f32 v102, v102, s32, -v3
    v_mfma_f32_16x16x32_bf16 v[252:255], v[76:79], v[92:95], v[252:255]
    ds_read_b128 v[68:71], v17 offset:20480
    v_fma_f32 v103, v103, s32, -v3
    v_exp_f32 v100, v100
    v_exp_f32 v101, v101
    v_mfma_f32_16x16x32_bf16 v[32:35], v[12:15], v[88:91], v[32:35]
    v_exp_f32 v102, v102
    v_exp_f32 v103, v103
    v_mfma_f32_16x16x32_bf16 v[36:39], v[12:15], v[92:95], v[36:39]
    v_cvt_pk_bf16_f32 v84, v100, v101
    v_cvt_pk_bf16_f32 v85, v102, v103
    s_sub_u32 s43, s43, 1
    s_cmp_lg_u32 s43, 0
    s_cbranch_scc1 L_k3_loopf
    s_waitcnt vmcnt(0)
    s_barrier
    s_waitcnt lgkmcnt(5)
    v_mfma_f32_16x16x32_bf16 v[128:131], v[48:51], v[160:163], 0
    s_setprio 3
    v_cvt_pk_bf16_f32 v104, 0, v104
    v_cvt_pk_bf16_f32 v105, 0, v105
    v_cvt_pk_bf16_f32 v106, 0, v106
    v_mfma_f32_16x16x32_bf16 v[132:135], v[48:51], v[176:179], 0
    ds_read_b128 v[72:75], v18 offset:20480
    v_cvt_pk_bf16_f32 v107, 0, v107
    v_mul_f32 v104, s34, v104
    v_mul_f32 v105, s34, v105
    s_waitcnt lgkmcnt(5)
    v_mfma_f32_16x16x32_bf16 v[128:131], v[52:55], v[164:167], v[128:131]
    v_mul_f32 v106, s34, v106
    v_mul_f32 v107, s34, v107
    v_mfma_f32_16x16x32_bf16 v[132:135], v[52:55], v[180:183], v[132:135]
    ds_read_b128 v[76:79], v19 offset:20480
    v_cvt_pk_bf16_f32 v104, 0, v104
    v_cvt_pk_bf16_f32 v105, 0, v105
    v_cvt_pk_bf16_f32 v106, 0, v106
    s_waitcnt lgkmcnt(5)
    v_mfma_f32_16x16x32_bf16 v[128:131], v[56:59], v[168:171], v[128:131]
    v_cvt_pk_bf16_f32 v107, 0, v107
    v_fma_f32 v104, v104, s32, -v2
    v_fma_f32 v105, v105, s32, -v2
    v_mfma_f32_16x16x32_bf16 v[132:135], v[56:59], v[184:187], v[132:135]
    ds_read_b128 v[48:51], v16 offset:24576
    v_fma_f32 v106, v106, s32, -v2
    v_fma_f32 v107, v107, s32, -v2
    s_waitcnt lgkmcnt(5)
    v_mfma_f32_16x16x32_bf16 v[128:131], v[60:63], v[172:175], v[128:131]
    v_exp_f32 v104, v104
    v_exp_f32 v105, v105
    v_exp_f32 v106, v106
    v_mfma_f32_16x16x32_bf16 v[132:135], v[60:63], v[188:191], v[132:135]
    ds_read_b128 v[52:55], v17 offset:24576
    v_exp_f32 v107, v107
    v_cvt_pk_bf16_f32 v82, v104, v105
    v_cvt_pk_bf16_f32 v83, v106, v107
    s_waitcnt lgkmcnt(5)
    v_mfma_f32_16x16x32_bf16 v[136:139], v[64:67], v[160:163], 0
    v_cvt_pk_bf16_f32 v108, 0, v108
    v_cvt_pk_bf16_f32 v109, 0, v109
    v_mfma_f32_16x16x32_bf16 v[140:143], v[64:67], v[176:179], 0
    ds_read_b128 v[56:59], v18 offset:24576
    v_cvt_pk_bf16_f32 v110, 0, v110
    v_cvt_pk_bf16_f32 v111, 0, v111
    v_mul_f32 v108, s34, v108
    s_waitcnt lgkmcnt(5)
    v_mfma_f32_16x16x32_bf16 v[136:139], v[68:71], v[164:167], v[136:139]
    v_mul_f32 v109, s34, v109
    v_mul_f32 v110, s34, v110
    v_mul_f32 v111, s34, v111
    v_mfma_f32_16x16x32_bf16 v[140:143], v[68:71], v[180:183], v[140:143]
    ds_read_b128 v[60:63], v19 offset:24576
    v_cvt_pk_bf16_f32 v108, 0, v108
    v_cvt_pk_bf16_f32 v109, 0, v109
    s_waitcnt lgkmcnt(5)
    v_mfma_f32_16x16x32_bf16 v[136:139], v[72:75], v[168:171], v[136:139]
    v_cvt_pk_bf16_f32 v110, 0, v110
    v_cvt_pk_bf16_f32 v111, 0, v111
    v_fma_f32 v108, v108, s32, -v3
    v_mfma_f32_16x16x32_bf16 v[140:143], v[72:75], v[184:187], v[140:143]
    ds_read_b128 v[64:67], v16 offset:28672
    v_fma_f32 v109, v109, s32, -v3
    v_fma_f32 v110, v110, s32, -v3
    s_waitcnt lgkmcnt(5)
    v_mfma_f32_16x16x32_bf16 v[136:139], v[76:79], v[172:175], v[136:139]
    v_fma_f32 v111, v111, s32, -v3
    v_exp_f32 v108, v108
    v_exp_f32 v109, v109
    v_mfma_f32_16x16x32_bf16 v[140:143], v[76:79], v[188:191], v[140:143]
    ds_read_b128 v[68:71], v17 offset:28672
    v_exp_f32 v110, v110
    v_exp_f32 v111, v111
    v_cvt_pk_bf16_f32 v86, v108, v109
    s_waitcnt lgkmcnt(5)
    v_mfma_f32_16x16x32_bf16 v[144:147], v[48:51], v[160:163], 0
    v_cvt_pk_bf16_f32 v87, v110, v111
    v_cvt_pk_bf16_f32 v112, 0, v112
    v_mfma_f32_16x16x32_bf16 v[148:151], v[48:51], v[176:179], 0
    ds_read_b128 v[72:75], v18 offset:28672
    s_setprio 2
    v_cvt_pk_bf16_f32 v113, 0, v113
    v_cvt_pk_bf16_f32 v114, 0, v114
    v_cvt_pk_bf16_f32 v115, 0, v115
    s_waitcnt lgkmcnt(5)
    v_mfma_f32_16x16x32_bf16 v[144:147], v[52:55], v[164:167], v[144:147]
    v_mul_f32 v112, s34, v112
    v_mul_f32 v113, s34, v113
    v_mul_f32 v114, s34, v114
    v_mfma_f32_16x16x32_bf16 v[148:151], v[52:55], v[180:183], v[148:151]
    ds_read_b128 v[76:79], v19 offset:28672
    v_mul_f32 v115, s34, v115
    v_cvt_pk_bf16_f32 v112, 0, v112
    s_waitcnt lgkmcnt(5)
    v_mfma_f32_16x16x32_bf16 v[144:147], v[56:59], v[168:171], v[144:147]
    v_cvt_pk_bf16_f32 v113, 0, v113
    v_cvt_pk_bf16_f32 v114, 0, v114
    v_cvt_pk_bf16_f32 v115, 0, v115
    v_mfma_f32_16x16x32_bf16 v[148:151], v[56:59], v[184:187], v[148:151]
    ds_read_b64_tr_b16 v[48:49], v20 offset:0
    ds_read_b64_tr_b16 v[50:51], v20 offset:4096
    v_fma_f32 v112, v112, s32, -v2
    v_fma_f32 v113, v113, s32, -v2
    v_fma_f32 v114, v114, s32, -v2
    s_waitcnt lgkmcnt(6)
    v_mfma_f32_16x16x32_bf16 v[144:147], v[60:63], v[172:175], v[144:147]
    v_fma_f32 v115, v115, s32, -v2
    v_exp_f32 v112, v112
    v_mfma_f32_16x16x32_bf16 v[148:151], v[60:63], v[188:191], v[148:151]
    ds_read_b64_tr_b16 v[52:53], v21 offset:0
    ds_read_b64_tr_b16 v[54:55], v21 offset:4096
    v_exp_f32 v113, v113
    v_exp_f32 v114, v114
    v_exp_f32 v115, v115
    s_waitcnt lgkmcnt(7)
    v_mfma_f32_16x16x32_bf16 v[152:155], v[64:67], v[160:163], 0
    v_cvt_pk_bf16_f32 v88, v112, v113
    v_cvt_pk_bf16_f32 v89, v114, v115
    v_mfma_f32_16x16x32_bf16 v[156:159], v[64:67], v[176:179], 0
    ds_read_b64_tr_b16 v[56:57], v22 offset:0
    ds_read_b64_tr_b16 v[58:59], v22 offset:4096
    v_cvt_pk_bf16_f32 v116, 0, v116
    v_cvt_pk_bf16_f32 v117, 0, v117
    v_cvt_pk_bf16_f32 v118, 0, v118
    s_waitcnt lgkmcnt(8)
    v_mfma_f32_16x16x32_bf16 v[152:155], v[68:71], v[164:167], v[152:155]
    v_cvt_pk_bf16_f32 v119, 0, v119
    v_mul_f32 v116, s34, v116
    v_mul_f32 v117, s34, v117
    v_mfma_f32_16x16x32_bf16 v[156:159], v[68:71], v[180:183], v[156:159]
    ds_read_b64_tr_b16 v[60:61], v23 offset:0
    ds_read_b64_tr_b16 v[62:63], v23 offset:4096
    v_mul_f32 v118, s34, v118
    v_mul_f32 v119, s34, v119
    s_waitcnt lgkmcnt(9)
    v_mfma_f32_16x16x32_bf16 v[152:155], v[72:75], v[168:171], v[152:155]
    v_cvt_pk_bf16_f32 v116, 0, v116
    v_cvt_pk_bf16_f32 v117, 0, v117
    v_cvt_pk_bf16_f32 v118, 0, v118
    v_mfma_f32_16x16x32_bf16 v[156:159], v[72:75], v[184:187], v[156:159]
    ds_read_b64_tr_b16 v[64:65], v24 offset:0
    ds_read_b64_tr_b16 v[66:67], v24 offset:4096
    v_cvt_pk_bf16_f32 v119, 0, v119
    v_fma_f32 v116, v116, s32, -v3
    v_fma_f32 v117, v117, s32, -v3
    s_waitcnt lgkmcnt(10)
    v_mfma_f32_16x16x32_bf16 v[152:155], v[76:79], v[172:175], v[152:155]
    v_fma_f32 v118, v118, s32, -v3
    v_fma_f32 v119, v119, s32, -v3
    v_mfma_f32_16x16x32_bf16 v[156:159], v[76:79], v[188:191], v[156:159]
    ds_read_b64_tr_b16 v[68:69], v25 offset:0
    ds_read_b64_tr_b16 v[70:71], v25 offset:4096
    v_exp_f32 v116, v116
    v_exp_f32 v117, v117
    v_exp_f32 v118, v118
    s_waitcnt lgkmcnt(10)
    v_mfma_f32_16x16x32_bf16 v[192:195], v[48:51], v[80:83], v[192:195]
    v_exp_f32 v119, v119
    v_cvt_pk_bf16_f32 v92, v116, v117
    v_cvt_pk_bf16_f32 v93, v118, v119
    s_nop 1
    v_mfma_f32_16x16x32_bf16 v[196:199], v[48:51], v[84:87], v[196:199]
    ds_read_b64_tr_b16 v[72:73], v26 offset:0
    ds_read_b64_tr_b16 v[74:75], v26 offset:4096
    v_cvt_pk_bf16_f32 v120, 0, v120
    v_cvt_pk_bf16_f32 v121, 0, v121
    s_waitcnt lgkmcnt(10)
    v_mfma_f32_16x16x32_bf16 v[200:203], v[52:55], v[80:83], v[200:203]
    s_setprio 1
    v_cvt_pk_bf16_f32 v122, 0, v122
    v_cvt_pk_bf16_f32 v123, 0, v123
    v_mul_f32 v120, s34, v120
    v_mfma_f32_16x16x32_bf16 v[204:207], v[52:55], v[84:87], v[204:207]
    ds_read_b64_tr_b16 v[76:77], v27 offset:0
    ds_read_b64_tr_b16 v[78:79], v27 offset:4096
    v_mul_f32 v121, s34, v121
    v_mul_f32 v122, s34, v122
    v_mul_f32 v123, s34, v123
    s_waitcnt lgkmcnt(10)
    v_mfma_f32_16x16x32_bf16 v[208:211], v[56:59], v[80:83], v[208:211]
    v_cvt_pk_bf16_f32 v120, 0, v120
    v_cvt_pk_bf16_f32 v121, 0, v121
    v_mfma_f32_16x16x32_bf16 v[212:215], v[56:59], v[84:87], v[212:215]
    ds_read_b64_tr_b16 v[48:49], v20 offset:8192
    ds_read_b64_tr_b16 v[50:51], v20 offset:12288
    v_cvt_pk_bf16_f32 v122, 0, v122
    v_cvt_pk_bf16_f32 v123, 0, v123
    v_fma_f32 v120, v120, s32, -v2
    s_waitcnt lgkmcnt(10)
    v_mfma_f32_16x16x32_bf16 v[216:219], v[60:63], v[80:83], v[216:219]
    v_fma_f32 v121, v121, s32, -v2
    v_fma_f32 v122, v122, s32, -v2
    v_mfma_f32_16x16x32_bf16 v[220:223], v[60:63], v[84:87], v[220:223]
    ds_read_b64_tr_b16 v[52:53], v21 offset:8192
    ds_read_b64_tr_b16 v[54:55], v21 offset:12288
    v_fma_f32 v123, v123, s32, -v2
    v_exp_f32 v120, v120
    v_exp_f32 v121, v121
    s_waitcnt lgkmcnt(10)
    v_mfma_f32_16x16x32_bf16 v[224:227], v[64:67], v[80:83], v[224:227]
    v_exp_f32 v122, v122
    v_exp_f32 v123, v123
    v_cvt_pk_bf16_f32 v90, v120, v121
    s_nop 1
    v_mfma_f32_16x16x32_bf16 v[228:231], v[64:67], v[84:87], v[228:231]
    ds_read_b64_tr_b16 v[56:57], v22 offset:8192
    ds_read_b64_tr_b16 v[58:59], v22 offset:12288
    v_cvt_pk_bf16_f32 v91, v122, v123
    v_cvt_pk_bf16_f32 v124, 0, v124
    s_waitcnt lgkmcnt(10)
    v_mfma_f32_16x16x32_bf16 v[232:235], v[68:71], v[80:83], v[232:235]
    v_cvt_pk_bf16_f32 v125, 0, v125
    v_cvt_pk_bf16_f32 v126, 0, v126
    v_cvt_pk_bf16_f32 v127, 0, v127
    v_mfma_f32_16x16x32_bf16 v[236:239], v[68:71], v[84:87], v[236:239]
    ds_read_b64_tr_b16 v[60:61], v23 offset:8192
    ds_read_b64_tr_b16 v[62:63], v23 offset:12288
    v_mul_f32 v124, s34, v124
    v_mul_f32 v125, s34, v125
    v_mul_f32 v126, s34, v126
    s_waitcnt lgkmcnt(10)
    v_mfma_f32_16x16x32_bf16 v[240:243], v[72:75], v[80:83], v[240:243]
    v_mul_f32 v127, s34, v127
    v_cvt_pk_bf16_f32 v124, 0, v124
    v_mfma_f32_16x16x32_bf16 v[244:247], v[72:75], v[84:87], v[244:247]
    ds_read_b64_tr_b16 v[64:65], v24 offset:8192
    ds_read_b64_tr_b16 v[66:67], v24 offset:12288
    v_cvt_pk_bf16_f32 v125, 0, v125
    v_cvt_pk_bf16_f32 v126, 0, v126
    v_cvt_pk_bf16_f32 v127, 0, v127
    s_waitcnt lgkmcnt(10)
    v_mfma_f32_16x16x32_bf16 v[248:251], v[76:79], v[80:83], v[248:251]
    v_fma_f32 v124, v124, s32, -v3
    v_fma_f32 v125, v125, s32, -v3
    v_fma_f32 v126, v126, s32, -v3
    v_mfma_f32_16x16x32_bf16 v[252:255], v[76:79], v[84:87], v[252:255]
    ds_read_b64_tr_b16 v[68:69], v25 offset:8192
    ds_read_b64_tr_b16 v[70:71], v25 offset:12288
    v_fma_f32 v127, v127, s32, -v3
    v_exp_f32 v124, v124
    v_mfma_f32_16x16x32_bf16 v[32:35], v[12:15], v[80:83], v[32:35]
    v_exp_f32 v125, v125
    v_exp_f32 v126, v126
    v_exp_f32 v127, v127
    v_mfma_f32_16x16x32_bf16 v[36:39], v[12:15], v[84:87], v[36:39]
    v_cvt_pk_bf16_f32 v94, v124, v125
    v_cvt_pk_bf16_f32 v95, v126, v127
    s_waitcnt lgkmcnt(10)
    s_nop 0
    v_mfma_f32_16x16x32_bf16 v[192:195], v[48:51], v[88:91], v[192:195]
    v_cvt_pk_bf16_f32 v128, 0, v128
    v_cvt_pk_bf16_f32 v129, 0, v129
    v_cvt_pk_bf16_f32 v130, 0, v130
    v_mfma_f32_16x16x32_bf16 v[196:199], v[48:51], v[92:95], v[196:199]
    ds_read_b64_tr_b16 v[72:73], v26 offset:8192
    ds_read_b64_tr_b16 v[74:75], v26 offset:12288
    s_setprio 0
    v_cvt_pk_bf16_f32 v131, 0, v131
    v_mul_f32 v128, s34, v128
    s_waitcnt lgkmcnt(10)
    v_mfma_f32_16x16x32_bf16 v[200:203], v[52:55], v[88:91], v[200:203]
    v_mul_f32 v129, s34, v129
    v_mul_f32 v130, s34, v130
    v_mul_f32 v131, s34, v131
    v_mfma_f32_16x16x32_bf16 v[204:207], v[52:55], v[92:95], v[204:207]
    ds_read_b64_tr_b16 v[76:77], v27 offset:8192
    ds_read_b64_tr_b16 v[78:79], v27 offset:12288
    v_cvt_pk_bf16_f32 v128, 0, v128
    v_cvt_pk_bf16_f32 v129, 0, v129
    s_waitcnt lgkmcnt(10)
    v_mfma_f32_16x16x32_bf16 v[208:211], v[56:59], v[88:91], v[208:211]
    v_cvt_pk_bf16_f32 v130, 0, v130
    v_cvt_pk_bf16_f32 v131, 0, v131
    v_fma_f32 v128, v128, s32, -v2
    v_mfma_f32_16x16x32_bf16 v[212:215], v[56:59], v[92:95], v[212:215]
    ds_read_b64_tr_b16 v[48:49], v20 offset:16384
    ds_read_b64_tr_b16 v[50:51], v20 offset:20480
    v_fma_f32 v129, v129, s32, -v2
    v_fma_f32 v130, v130, s32, -v2
    s_waitcnt lgkmcnt(10)
    v_mfma_f32_16x16x32_bf16 v[216:219], v[60:63], v[88:91], v[216:219]
    v_fma_f32 v131, v131, s32, -v2
    v_exp_f32 v128, v128
    v_exp_f32 v129, v129
    v_mfma_f32_16x16x32_bf16 v[220:223], v[60:63], v[92:95], v[220:223]
    ds_read_b64_tr_b16 v[52:53], v21 offset:16384
    ds_read_b64_tr_b16 v[54:55], v21 offset:20480
    v_exp_f32 v130, v130
    v_exp_f32 v131, v131
    s_waitcnt lgkmcnt(10)
    v_mfma_f32_16x16x32_bf16 v[224:227], v[64:67], v[88:91], v[224:227]
    v_cvt_pk_bf16_f32 v80, v128, v129
    v_cvt_pk_bf16_f32 v81, v130, v131
    s_nop 1
    v_mfma_f32_16x16x32_bf16 v[228:231], v[64:67], v[92:95], v[228:231]
    ds_read_b64_tr_b16 v[56:57], v22 offset:16384
    ds_read_b64_tr_b16 v[58:59], v22 offset:20480
    v_cvt_pk_bf16_f32 v132, 0, v132
    v_cvt_pk_bf16_f32 v133, 0, v133
    v_cvt_pk_bf16_f32 v134, 0, v134
    s_waitcnt lgkmcnt(10)
    v_mfma_f32_16x16x32_bf16 v[232:235], v[68:71], v[88:91], v[232:235]
    v_cvt_pk_bf16_f32 v135, 0, v135
    v_mul_f32 v132, s34, v132
    v_mfma_f32_16x16x32_bf16 v[236:239], v[68:71], v[92:95], v[236:239]
    ds_read_b64_tr_b16 v[60:61], v23 offset:16384
    ds_read_b64_tr_b16 v[62:63], v23 offset:20480
    v_mul_f32 v133, s34, v133
    v_mul_f32 v134, s34, v134
    v_mul_f32 v135, s34, v135
    s_waitcnt lgkmcnt(10)
    v_mfma_f32_16x16x32_bf16 v[240:243], v[72:75], v[88:91], v[240:243]
    v_cvt_pk_bf16_f32 v132, 0, v132
    v_cvt_pk_bf16_f32 v133, 0, v133
    v_mfma_f32_16x16x32_bf16 v[244:247], v[72:75], v[92:95], v[244:247]
    ds_read_b64_tr_b16 v[64:65], v24 offset:16384
    ds_read_b64_tr_b16 v[66:67], v24 offset:20480
    v_cvt_pk_bf16_f32 v134, 0, v134
    v_cvt_pk_bf16_f32 v135, 0, v135
    v_fma_f32 v132, v132, s32, -v3
    s_waitcnt lgkmcnt(10)
    v_mfma_f32_16x16x32_bf16 v[248:251], v[76:79], v[88:91], v[248:251]
    v_fma_f32 v133, v133, s32, -v3
    v_fma_f32 v134, v134, s32, -v3
    v_mfma_f32_16x16x32_bf16 v[252:255], v[76:79], v[92:95], v[252:255]
    ds_read_b64_tr_b16 v[68:69], v25 offset:16384
    ds_read_b64_tr_b16 v[70:71], v25 offset:20480
    v_fma_f32 v135, v135, s32, -v3
    v_exp_f32 v132, v132
    v_exp_f32 v133, v133
    v_mfma_f32_16x16x32_bf16 v[32:35], v[12:15], v[88:91], v[32:35]
    v_exp_f32 v134, v134
    v_exp_f32 v135, v135
    v_mfma_f32_16x16x32_bf16 v[36:39], v[12:15], v[92:95], v[36:39]
    v_cvt_pk_bf16_f32 v84, v132, v133
    v_cvt_pk_bf16_f32 v85, v134, v135
    v_cvt_pk_bf16_f32 v136, 0, v136
    v_cvt_pk_bf16_f32 v137, 0, v137
    v_cvt_pk_bf16_f32 v138, 0, v138
    v_cvt_pk_bf16_f32 v139, 0, v139
    v_mul_f32 v136, s34, v136
    v_mul_f32 v137, s34, v137
    v_mul_f32 v138, s34, v138
    v_mul_f32 v139, s34, v139
    v_cvt_pk_bf16_f32 v136, 0, v136
    v_cvt_pk_bf16_f32 v137, 0, v137
    v_cvt_pk_bf16_f32 v138, 0, v138
    v_cvt_pk_bf16_f32 v139, 0, v139
    v_fma_f32 v136, v136, s32, -v2
    v_fma_f32 v137, v137, s32, -v2
    v_fma_f32 v138, v138, s32, -v2
    v_fma_f32 v139, v139, s32, -v2
    v_exp_f32 v136, v136
    v_exp_f32 v137, v137
    v_exp_f32 v138, v138
    v_exp_f32 v139, v139
    v_cvt_pk_bf16_f32 v82, v136, v137
    v_cvt_pk_bf16_f32 v83, v138, v139
    v_cvt_pk_bf16_f32 v140, 0, v140
    v_cvt_pk_bf16_f32 v141, 0, v141
    v_cvt_pk_bf16_f32 v142, 0, v142
    v_cvt_pk_bf16_f32 v143, 0, v143
    v_mul_f32 v140, s34, v140
    v_mul_f32 v141, s34, v141
    v_mul_f32 v142, s34, v142
    v_mul_f32 v143, s34, v143
    v_cvt_pk_bf16_f32 v140, 0, v140
    v_cvt_pk_bf16_f32 v141, 0, v141
    v_cvt_pk_bf16_f32 v142, 0, v142
    v_cvt_pk_bf16_f32 v143, 0, v143
    v_fma_f32 v140, v140, s32, -v3
    v_fma_f32 v141, v141, s32, -v3
    v_fma_f32 v142, v142, s32, -v3
    v_fma_f32 v143, v143, s32, -v3
    v_exp_f32 v140, v140
    v_exp_f32 v141, v141
    v_exp_f32 v142, v142
    v_exp_f32 v143, v143
    v_cvt_pk_bf16_f32 v86, v140, v141
    v_cvt_pk_bf16_f32 v87, v142, v143
    s_waitcnt lgkmcnt(10)
    s_nop 0
    v_mfma_f32_16x16x32_bf16 v[192:195], v[48:51], v[80:83], v[192:195]
    v_cvt_pk_bf16_f32 v144, 0, v144
    v_cvt_pk_bf16_f32 v145, 0, v145
    v_cvt_pk_bf16_f32 v146, 0, v146
    v_cvt_pk_bf16_f32 v147, 0, v147
    v_mul_f32 v144, s34, v144
    v_mul_f32 v145, s34, v145
    v_mfma_f32_16x16x32_bf16 v[196:199], v[48:51], v[84:87], v[196:199]
    ds_read_b64_tr_b16 v[72:73], v26 offset:16384
    ds_read_b64_tr_b16 v[74:75], v26 offset:20480
    v_mul_f32 v146, s34, v146
    v_mul_f32 v147, s34, v147
    v_cvt_pk_bf16_f32 v144, 0, v144
    v_cvt_pk_bf16_f32 v145, 0, v145
    v_cvt_pk_bf16_f32 v146, 0, v146
    s_waitcnt lgkmcnt(10)
    v_mfma_f32_16x16x32_bf16 v[200:203], v[52:55], v[80:83], v[200:203]
    v_cvt_pk_bf16_f32 v147, 0, v147
    v_fma_f32 v144, v144, s32, -v2
    v_fma_f32 v145, v145, s32, -v2
    v_fma_f32 v146, v146, s32, -v2
    v_fma_f32 v147, v147, s32, -v2
    v_mfma_f32_16x16x32_bf16 v[204:207], v[52:55], v[84:87], v[204:207]
    ds_read_b64_tr_b16 v[76:77], v27 offset:16384
    ds_read_b64_tr_b16 v[78:79], v27 offset:20480
    v_exp_f32 v144, v144
    v_exp_f32 v145, v145
    v_exp_f32 v146, v146
    v_exp_f32 v147, v147
    v_cvt_pk_bf16_f32 v88, v144, v145
    s_waitcnt lgkmcnt(10)
    s_nop 0
    v_mfma_f32_16x16x32_bf16 v[208:211], v[56:59], v[80:83], v[208:211]
    v_cvt_pk_bf16_f32 v89, v146, v147
    v_cvt_pk_bf16_f32 v148, 0, v148
    v_cvt_pk_bf16_f32 v149, 0, v149
    v_cvt_pk_bf16_f32 v150, 0, v150
    v_cvt_pk_bf16_f32 v151, 0, v151
    v_mfma_f32_16x16x32_bf16 v[212:215], v[56:59], v[84:87], v[212:215]
    ds_read_b64_tr_b16 v[48:49], v20 offset:24576
    ds_read_b64_tr_b16 v[50:51], v20 offset:28672
    v_mul_f32 v148, s34, v148
    v_mul_f32 v149, s34, v149
    v_mul_f32 v150, s34, v150
    v_mul_f32 v151, s34, v151
    v_cvt_pk_bf16_f32 v148, 0, v148
    v_cvt_pk_bf16_f32 v149, 0, v149
    s_waitcnt lgkmcnt(10)
    v_mfma_f32_16x16x32_bf16 v[216:219], v[60:63], v[80:83], v[216:219]
    v_cvt_pk_bf16_f32 v150, 0, v150
    v_cvt_pk_bf16_f32 v151, 0, v151
    v_fma_f32 v148, v148, s32, -v3
    v_fma_f32 v149, v149, s32, -v3
    v_fma_f32 v150, v150, s32, -v3
    v_mfma_f32_16x16x32_bf16 v[220:223], v[60:63], v[84:87], v[220:223]
    ds_read_b64_tr_b16 v[52:53], v21 offset:24576
    ds_read_b64_tr_b16 v[54:55], v21 offset:28672
    v_fma_f32 v151, v151, s32, -v3
    v_exp_f32 v148, v148
    v_exp_f32 v149, v149
    v_exp_f32 v150, v150
    v_exp_f32 v151, v151
    s_waitcnt lgkmcnt(10)
    v_mfma_f32_16x16x32_bf16 v[224:227], v[64:67], v[80:83], v[224:227]
    v_cvt_pk_bf16_f32 v92, v148, v149
    v_cvt_pk_bf16_f32 v93, v150, v151
    v_cvt_pk_bf16_f32 v152, 0, v152
    v_cvt_pk_bf16_f32 v153, 0, v153
    v_cvt_pk_bf16_f32 v154, 0, v154
    v_mfma_f32_16x16x32_bf16 v[228:231], v[64:67], v[84:87], v[228:231]
    ds_read_b64_tr_b16 v[56:57], v22 offset:24576
    ds_read_b64_tr_b16 v[58:59], v22 offset:28672
    v_cvt_pk_bf16_f32 v155, 0, v155
    v_mul_f32 v152, s34, v152
    v_mul_f32 v153, s34, v153
    v_mul_f32 v154, s34, v154
    v_mul_f32 v155, s34, v155
    s_waitcnt lgkmcnt(10)
    v_mfma_f32_16x16x32_bf16 v[232:235], v[68:71], v[80:83], v[232:235]
    v_cvt_pk_bf16_f32 v152, 0, v152
    v_cvt_pk_bf16_f32 v153, 0, v153
    v_cvt_pk_bf16_f32 v154, 0, v154
    v_cvt_pk_bf16_f32 v155, 0, v155
    v_fma_f32 v152, v152, s32, -v2
    v_mfma_f32_16x16x32_bf16 v[236:239], v[68:71], v[84:87], v[236:239]
    ds_read_b64_tr_b16 v[60:61], v23 offset:24576
    ds_read_b64_tr_b16 v[62:63], v23 offset:28672
    v_fma_f32 v153, v153, s32, -v2
    v_fma_f32 v154, v154, s32, -v2
    v_fma_f32 v155, v155, s32, -v2
    v_exp_f32 v152, v152
    v_exp_f32 v153, v153
    v_exp_f32 v154, v154
    s_waitcnt lgkmcnt(10)
    v_mfma_f32_16x16x32_bf16 v[240:243], v[72:75], v[80:83], v[240:243]
    v_exp_f32 v155, v155
    v_cvt_pk_bf16_f32 v90, v152, v153
    v_cvt_pk_bf16_f32 v91, v154, v155
    v_cvt_pk_bf16_f32 v156, 0, v156
    v_cvt_pk_bf16_f32 v157, 0, v157
    v_mfma_f32_16x16x32_bf16 v[244:247], v[72:75], v[84:87], v[244:247]
    ds_read_b64_tr_b16 v[64:65], v24 offset:24576
    ds_read_b64_tr_b16 v[66:67], v24 offset:28672
    v_cvt_pk_bf16_f32 v158, 0, v158
    v_cvt_pk_bf16_f32 v159, 0, v159
    v_mul_f32 v156, s34, v156
    v_mul_f32 v157, s34, v157
    v_mul_f32 v158, s34, v158
    s_waitcnt lgkmcnt(10)
    v_mfma_f32_16x16x32_bf16 v[248:251], v[76:79], v[80:83], v[248:251]
    v_mul_f32 v159, s34, v159
    v_cvt_pk_bf16_f32 v156, 0, v156
    v_cvt_pk_bf16_f32 v157, 0, v157
    v_cvt_pk_bf16_f32 v158, 0, v158
    v_cvt_pk_bf16_f32 v159, 0, v159
    v_mfma_f32_16x16x32_bf16 v[252:255], v[76:79], v[84:87], v[252:255]
    ds_read_b64_tr_b16 v[68:69], v25 offset:24576
    ds_read_b64_tr_b16 v[70:71], v25 offset:28672
    v_fma_f32 v156, v156, s32, -v3
    v_fma_f32 v157, v157, s32, -v3
    v_fma_f32 v158, v158, s32, -v3
    v_fma_f32 v159, v159, s32, -v3
    v_exp_f32 v156, v156
    v_mfma_f32_16x16x32_bf16 v[32:35], v[12:15], v[80:83], v[32:35]
    v_exp_f32 v157, v157
    v_exp_f32 v158, v158
    v_exp_f32 v159, v159
    v_cvt_pk_bf16_f32 v94, v156, v157
    v_cvt_pk_bf16_f32 v95, v158, v159
    s_nop 1
    v_mfma_f32_16x16x32_bf16 v[36:39], v[12:15], v[84:87], v[36:39]
    s_waitcnt lgkmcnt(10)
    v_mfma_f32_16x16x32_bf16 v[192:195], v[48:51], v[88:91], v[192:195]
    v_mfma_f32_16x16x32_bf16 v[196:199], v[48:51], v[92:95], v[196:199]
    ds_read_b64_tr_b16 v[72:73], v26 offset:24576
    ds_read_b64_tr_b16 v[74:75], v26 offset:28672
    s_waitcnt lgkmcnt(10)
    v_mfma_f32_16x16x32_bf16 v[200:203], v[52:55], v[88:91], v[200:203]
    v_mfma_f32_16x16x32_bf16 v[204:207], v[52:55], v[92:95], v[204:207]
    ds_read_b64_tr_b16 v[76:77], v27 offset:24576
    ds_read_b64_tr_b16 v[78:79], v27 offset:28672
    s_waitcnt lgkmcnt(10)
    v_mfma_f32_16x16x32_bf16 v[208:211], v[56:59], v[88:91], v[208:211]
    v_mfma_f32_16x16x32_bf16 v[212:215], v[56:59], v[92:95], v[212:215]
    s_waitcnt lgkmcnt(8)
    v_mfma_f32_16x16x32_bf16 v[216:219], v[60:63], v[88:91], v[216:219]
    v_mfma_f32_16x16x32_bf16 v[220:223], v[60:63], v[92:95], v[220:223]
    s_waitcnt lgkmcnt(6)
    v_mfma_f32_16x16x32_bf16 v[224:227], v[64:67], v[88:91], v[224:227]
    v_mfma_f32_16x16x32_bf16 v[228:231], v[64:67], v[92:95], v[228:231]
    s_waitcnt lgkmcnt(4)
    v_mfma_f32_16x16x32_bf16 v[232:235], v[68:71], v[88:91], v[232:235]
    v_mfma_f32_16x16x32_bf16 v[236:239], v[68:71], v[92:95], v[236:239]
    s_waitcnt lgkmcnt(2)
    v_mfma_f32_16x16x32_bf16 v[240:243], v[72:75], v[88:91], v[240:243]
    v_mfma_f32_16x16x32_bf16 v[244:247], v[72:75], v[92:95], v[244:247]
    s_waitcnt lgkmcnt(0)
    v_mfma_f32_16x16x32_bf16 v[248:251], v[76:79], v[88:91], v[248:251]
    v_mfma_f32_16x16x32_bf16 v[252:255], v[76:79], v[92:95], v[252:255]
    v_mfma_f32_16x16x32_bf16 v[32:35], v[12:15], v[88:91], v[32:35]
    v_mfma_f32_16x16x32_bf16 v[36:39], v[12:15], v[92:95], v[36:39]
    s_setprio 0
    s_nop 15
    v_max_f32 v4, v32, v36
    v_mov_b32 v5, 0x5f800000
    v_cmp_nlt_f32 vcc, v32, v5
    v_cmp_nlt_f32 s[48:49], v36, v5
    s_nop 1
    s_or_b64 s[48:49], s[48:49], vcc
    s_cmp_lg_u64 s[48:49], 0
    s_cselect_b32 s47, 1, 0
    v_mov_b32 v4, s47
    s_lshl_b32 s47, s33, 2
    v_mov_b32 v5, s47
    ds_write_b32 v5, v4 offset:32768
    s_waitcnt lgkmcnt(0)
    s_barrier
    v_mov_b32 v5, 0
    ds_read_b128 v[48:51], v5 offset:32768
    ds_read_b128 v[52:55], v5 offset:32784
    s_waitcnt lgkmcnt(0)
    v_or_b32 v48, v48, v49
    v_or_b32 v48, v48, v50
    v_or_b32 v48, v48, v51
    v_or_b32 v48, v48, v52
    v_or_b32 v48, v48, v53
    v_or_b32 v48, v48, v54
    v_or_b32 v48, v48, v55
    s_nop 0
    v_readfirstlane_b32 s47, v48
    s_cmp_eq_u32 s47, 0
    s_cbranch_scc1 L_k3_epi
    s_barrier
    s_mov_b32 s35, 0
    s_mov_b32 s36, 0
    s_mov_b32 m0, s37
    s_nop 0
    buffer_load_dwordx4 v28, s[8:11], s35 offen lds
    buffer_load_dwordx4 v29, s[8:11], s35 offen offset:1024 lds
    s_add_u32 s35, s35, 16384
    s_mov_b32 m0, s38
    s_nop 0
    buffer_load_dwordx4 v28, s[8:11], s35 offen lds
    buffer_load_dwordx4 v29, s[8:11], s35 offen offset:1024 lds
    s_add_u32 s35, s35, 16384
    s_mov_b32 m0, s40
    s_nop 0
    buffer_load_dwordx4 v30, s[12:15], s36 offen lds
    buffer_load_dwordx4 v31, s[12:15], s36 offen offset:1024 lds
    s_add_u32 s36, s36, 16384
    s_mov_b32 m0, s39
    s_nop 0
    buffer_load_dwordx4 v28, s[8:11], s35 offen lds
    buffer_load_dwordx4 v29, s[8:11], s35 offen offset:1024 lds
    s_add_u32 s35, s35, 16384
    s_mov_b32 m0, s41
    s_nop 0
    buffer_load_dwordx4 v30, s[12:15], s36 offen lds
    buffer_load_dwordx4 v31, s[12:15], s36 offen offset:1024 lds
    s_add_u32 s36, s36, 16384
    v_mov_b32 v192, 0
    v_mov_b32 v193, 0
    v_mov_b32 v194, 0
    v_mov_b32 v195, 0
    v_mov_b32 v196, 0
    v_mov_b32 v197, 0
    v_mov_b32 v198, 0
    v_mov_b32 v199, 0
    v_mov_b32 v200, 0
    v_mov_b32 v201, 0
    v_mov_b32 v202, 0
    v_mov_b32 v203, 0
    v_mov_b32 v204, 0
    v_mov_b32 v205, 0
    v_mov_b32 v206, 0
    v_mov_b32 v207, 0
    v_mov_b32 v208, 0
    v_mov_b32 v209, 0
    v_mov_b32 v210, 0
    v_mov_b32 v211, 0
    v_mov_b32 v212, 0
    v_mov_b32 v213, 0
    v_mov_b32 v214, 0
    v_mov_b32 v215, 0
    v_mov_b32 v216, 0
    v_mov_b32 v217, 0
    v_mov_b32 v218, 0
    v_mov_b32 v219, 0
    v_mov_b32 v220, 0
    v_mov_b32 v221, 0
    v_mov_b32 v222, 0
    v_mov_b32 v223, 0
    v_mov_b32 v224, 0
    v_mov_b32 v225, 0
    v_mov_b32 v226, 0
    v_mov_b32 v227, 0
    v_mov_b32 v228, 0
    v_mov_b32 v229, 0
    v_mov_b32 v230, 0
    v_mov_b32 v231, 0
    v_mov_b32 v232, 0
    v_mov_b32 v233, 0
    v_mov_b32 v234, 0
    v_mov_b32 v235, 0
    v_mov_b32 v236, 0
    v_mov_b32 v237, 0
    v_mov_b32 v238, 0
    v_mov_b32 v239, 0
    v_mov_b32 v240, 0
    v_mov_b32 v241, 0
    v_mov_b32 v242, 0
    v_mov_b32 v243, 0
    v_mov_b32 v244, 0
    v_mov_b32 v245, 0
    v_mov_b32 v246, 0
    v_mov_b32 v247, 0
    v_mov_b32 v248, 0
    v_mov_b32 v249, 0
    v_mov_b32 v250, 0
    v_mov_b32 v251, 0
    v_mov_b32 v252, 0
    v_mov_b32 v253, 0
    v_mov_b32 v254, 0
    v_mov_b32 v255, 0
    v_mov_b32 v1, 0xff800000
    v_mov_b32 v2, 0xff800000
    v_mov_b32 v3, 0xff800000
    v_mov_b32 v32, 0
    v_mov_b32 v33, 0
    v_mov_b32 v34, 0
    v_mov_b32 v35, 0
    v_mov_b32 v36, 0
    v_mov_b32 v37, 0
    v_mov_b32 v38, 0
    v_mov_b32 v39, 0
    v_mov_b32 v10, s34
    v_mov_b32 v11, s32
    s_waitcnt vmcnt(0) lgkmcnt(0)
    s_barrier
    ds_read_b128 v[48:51], v16 offset:0
    ds_read_b128 v[52:55], v17 offset:0
    ds_read_b128 v[56:59], v18 offset:0
    ds_read_b128 v[60:63], v19 offset:0
    ds_read_b128 v[64:67], v16 offset:4096
    ds_read_b128 v[68:71], v17 offset:4096
    s_waitcnt lgkmcnt(5)
    v_mfma_f32_16x16x32_bf16 v[96:99], v[48:51], v[160:163], 0
    v_mfma_f32_16x16x32_bf16 v[100:103], v[48:51], v[176:179], 0
    ds_read_b128 v[72:75], v18 offset:4096
    s_waitcnt lgkmcnt(5)
    v_mfma_f32_16x16x32_bf16 v[96:99], v[52:55], v[164:167], v[96:99]
    v_mfma_f32_16x16x32_bf16 v[100:103], v[52:55], v[180:183], v[100:103]
    ds_read_b128 v[76:79], v19 offset:4096
    s_waitcnt lgkmcnt(5)
    v_mfma_f32_16x16x32_bf16 v[96:99], v[56:59], v[168:171], v[96:99]
    v_mfma_f32_16x16x32_bf16 v[100:103], v[56:59], v[184:187], v[100:103]
    ds_read_b128 v[48:51], v16 offset:8192
    s_waitcnt lgkmcnt(5)
    v_mfma_f32_16x16x32_bf16 v[96:99], v[60:63], v[172:175], v[96:99]
    v_mfma_f32_16x16x32_bf16 v[100:103], v[60:63], v[188:191], v[100:103]
    ds_read_b128 v[52:55], v17 offset:8192
    s_waitcnt lgkmcnt(5)
    v_mfma_f32_16x16x32_bf16 v[104:107], v[64:67], v[160:163], 0
    v_mfma_f32_16x16x32_bf16 v[108:111], v[64:67], v[176:179], 0
    ds_read_b128 v[56:59], v18 offset:8192
    s_waitcnt lgkmcnt(5)
    v_mfma_f32_16x16x32_bf16 v[104:107], v[68:71], v[164:167], v[104:107]
    v_mfma_f32_16x16x32_bf16 v[108:111], v[68:71], v[180:183], v[108:111]
    ds_read_b128 v[60:63], v19 offset:8192
    s_waitcnt lgkmcnt(5)
    v_mfma_f32_16x16x32_bf16 v[104:107], v[72:75], v[168:171], v[104:107]
    v_mfma_f32_16x16x32_bf16 v[108:111], v[72:75], v[184:187], v[108:111]
    ds_read_b128 v[64:67], v16 offset:12288
    s_waitcnt lgkmcnt(5)
    v_mfma_f32_16x16x32_bf16 v[104:107], v[76:79], v[172:175], v[104:107]
    v_mfma_f32_16x16x32_bf16 v[108:111], v[76:79], v[188:191], v[108:111]
    ds_read_b128 v[68:71], v17 offset:12288
    s_waitcnt lgkmcnt(5)
    v_mfma_f32_16x16x32_bf16 v[112:115], v[48:51], v[160:163], 0
    v_mfma_f32_16x16x32_bf16 v[116:119], v[48:51], v[176:179], 0
    ds_read_b128 v[72:75], v18 offset:12288
    s_waitcnt lgkmcnt(5)
    v_mfma_f32_16x16x32_bf16 v[112:115], v[52:55], v[164:167], v[112:115]
    v_mfma_f32_16x16x32_bf16 v[116:119], v[52:55], v[180:183], v[116:119]
    ds_read_b128 v[76:79], v19 offset:12288
    s_waitcnt lgkmcnt(5)
    v_mfma_f32_16x16x32_bf16 v[112:115], v[56:59], v[168:171], v[112:115]
    v_mfma_f32_16x16x32_bf16 v[116:119], v[56:59], v[184:187], v[116:119]
    ds_read_b128 v[48:51], v16 offset:16384
    s_waitcnt lgkmcnt(5)
    v_mfma_f32_16x16x32_bf16 v[112:115], v[60:63], v[172:175], v[112:115]
    v_mfma_f32_16x16x32_bf16 v[116:119], v[60:63], v[188:191], v[116:119]
    ds_read_b128 v[52:55], v17 offset:16384
    s_waitcnt lgkmcnt(5)
    v_mfma_f32_16x16x32_bf16 v[120:123], v[64:67], v[160:163], 0
    v_mfma_f32_16x16x32_bf16 v[124:127], v[64:67], v[176:179], 0
    ds_read_b128 v[56:59], v18 offset:16384
    s_waitcnt lgkmcnt(5)
    v_mfma_f32_16x16x32_bf16 v[120:123], v[68:71], v[164:167], v[120:123]
    v_mfma_f32_16x16x32_bf16 v[124:127], v[68:71], v[180:183], v[124:127]
    ds_read_b128 v[60:63], v19 offset:16384
    s_waitcnt lgkmcnt(5)
    v_mfma_f32_16x16x32_bf16 v[120:123], v[72:75], v[168:171], v[120:123]
    v_mfma_f32_16x16x32_bf16 v[124:127], v[72:75], v[184:187], v[124:127]
    ds_read_b128 v[64:67], v16 offset:20480
    s_waitcnt lgkmcnt(5)
    v_mfma_f32_16x16x32_bf16 v[120:123], v[76:79], v[172:175], v[120:123]
    v_mfma_f32_16x16x32_bf16 v[124:127], v[76:79], v[188:191], v[124:127]
    ds_read_b128 v[68:71], v17 offset:20480
    s_nop 15
    v_max3_f32 v4, v96, v97, v98
    v_max3_f32 v5, v100, v101, v102
    v_max3_f32 v4, v4, v99, v104
    v_max3_f32 v5, v5, v103, v108
    v_max3_f32 v4, v4, v105, v106
    v_max3_f32 v5, v5, v109, v110
    v_max3_f32 v4, v4, v107, v112
    v_max3_f32 v5, v5, v111, v116
    v_max3_f32 v4, v4, v113, v114
    v_max3_f32 v5, v5, v117, v118
    v_max3_f32 v4, v4, v115, v120
    v_max3_f32 v5, v5, v119, v124
    v_max3_f32 v4, v4, v121, v122
    v_max3_f32 v5, v5, v125, v126
    v_max_f32 v4, v4, v123
    v_max_f32 v5, v5, v127
    s_nop 1
    v_permlane32_swap_b32 v4, v5
    v_max_f32 v4, v4, v5
    v_mov_b32 v6, v4
    v_add_f32 v5, 0x41000000, v1
    s_nop 0
    v_permlane16_swap_b32 v4, v6
    v_max_f32 v4, v4, v6
    v_cvt_pk_bf16_f32 v4, 0, v4
    v_mul_f32 v4, s34, v4
    v_cvt_pk_bf16_f32 v4, 0, v4
    v_mul_f32 v4, s32, v4
    v_cmp_gt_f32 vcc, v4, v5
    s_nop 1
    s_cbranch_vccz L_k3_skip8
    s_nop 15
    v_max_f32 v4, v4, v1
    v_sub_f32 v5, v1, v4
    v_exp_f32 v5, v5
    v_mov_b32 v1, v4
    v_mov_b32 v2, v4
    v_mov_b32 v3, v4
    v_mov_b32 v6, v5
    s_nop 1
    v_permlane32_swap_b32 v2, v3
    v_permlane32_swap_b32 v5, v6
    s_nop 1
    v_mul_f32 v32, v32, v5
    v_mul_f32 v36, v36, v6
    v_mul_f32 v192, v192, v5
    v_mul_f32 v193, v193, v5
    v_mul_f32 v194, v194, v5
    v_mul_f32 v195, v195, v5
    v_mul_f32 v196, v196, v6
    v_mul_f32 v197, v197, v6
    v_mul_f32 v198, v198, v6
    v_mul_f32 v199, v199, v6
    v_mul_f32 v200, v200, v5
    v_mul_f32 v201, v201, v5
    v_mul_f32 v202, v202, v5
    v_mul_f32 v203, v203, v5
    v_mul_f32 v204, v204, v6
    v_mul_f32 v205, v205, v6
    v_mul_f32 v206, v206, v6
    v_mul_f32 v207, v207, v6
    v_mul_f32 v208, v208, v5
    v_mul_f32 v209, v209, v5
    v_mul_f32 v210, v210, v5
    v_mul_f32 v211, v211, v5
    v_mul_f32 v212, v212, v6
    v_mul_f32 v213, v213, v6
    v_mul_f32 v214, v214, v6
    v_mul_f32 v215, v215, v6
    v_mul_f32 v216, v216, v5
    v_mul_f32 v217, v217, v5
    v_mul_f32 v218, v218, v5
    v_mul_f32 v219, v219, v5
    v_mul_f32 v220, v220, v6
    v_mul_f32 v221, v221, v6
    v_mul_f32 v222, v222, v6
    v_mul_f32 v223, v223, v6
    v_mul_f32 v224, v224, v5
    v_mul_f32 v225, v225, v5
    v_mul_f32 v226, v226, v5
    v_mul_f32 v227, v227, v5
    v_mul_f32 v228, v228, v6
    v_mul_f32 v229, v229, v6
    v_mul_f32 v230, v230, v6
    v_mul_f32 v231, v231, v6
    v_mul_f32 v232, v232, v5
    v_mul_f32 v233, v233, v5
    v_mul_f32 v234, v234, v5
    v_mul_f32 v235, v235, v5
    v_mul_f32 v236, v236, v6
    v_mul_f32 v237, v237, v6
    v_mul_f32 v238, v238, v6
    v_mul_f32 v239, v239, v6
    v_mul_f32 v240, v240, v5
    v_mul_f32 v241, v241, v5
    v_mul_f32 v242, v242, v5
    v_mul_f32 v243, v243, v5
    v_mul_f32 v244, v244, v6
    v_mul_f32 v245, v245, v6
    v_mul_f32 v246, v246, v6
    v_mul_f32 v247, v247, v6
    v_mul_f32 v248, v248, v5
    v_mul_f32 v249, v249, v5
    v_mul_f32 v250, v250, v5
    v_mul_f32 v251, v251, v5
    v_mul_f32 v252, v252, v6
    v_mul_f32 v253, v253, v6
    v_mul_f32 v254, v254, v6
    v_mul_f32 v255, v255, v6
    s_nop 1
L_k3_skip8:
    s_mov_b32 s43, 5
L_k3_loops:
    s_waitcnt vmcnt(0)
    s_barrier
    s_waitcnt lgkmcnt(5)
    v_mfma_f32_16x16x32_bf16 v[128:131], v[48:51], v[160:163], 0
    s_setprio 3
    v_cvt_pk_bf16_f32 v96, 0, v96
    v_cvt_pk_bf16_f32 v97, 0, v97
    v_cvt_pk_bf16_f32 v98, 0, v98
    v_cvt_pk_bf16_f32 v99, 0, v99
    v_mfma_f32_16x16x32_bf16 v[132:135], v[48:51], v[176:179], 0
    ds_read_b128 v[72:75], v18 offset:20480
    v_mul_f32 v96, s34, v96
    v_mul_f32 v97, s34, v97
    v_mul_f32 v98, s34, v98
    v_mul_f32 v99, s34, v99
    s_waitcnt lgkmcnt(5)
    v_mfma_f32_16x16x32_bf16 v[128:131], v[52:55], v[164:167], v[128:131]
    v_cvt_pk_bf16_f32 v96, 0, v96
    v_cvt_pk_bf16_f32 v97, 0, v97
    v_cvt_pk_bf16_f32 v98, 0, v98
    s_mov_b32 m0, s37
    s_nop 0
    buffer_load_dwordx4 v28, s[8:11], s35 offen lds
    buffer_load_dwordx4 v29, s[8:11], s35 offen offset:1024 lds
    s_add_u32 s35, s35, 16384
    v_mfma_f32_16x16x32_bf16 v[132:135], v[52:55], v[180:183], v[132:135]
    ds_read_b128 v[76:79], v19 offset:20480
    v_cvt_pk_bf16_f32 v99, 0, v99
    v_fma_f32 v96, v96, s32, -v2
    v_fma_f32 v97, v97, s32, -v2
    v_fma_f32 v98, v98, s32, -v2
    s_waitcnt lgkmcnt(5)
    v_mfma_f32_16x16x32_bf16 v[128:131], v[56:59], v[168:171], v[128:131]
    v_fma_f32 v99, v99, s32, -v2
    v_exp_f32 v96, v96
    v_exp_f32 v97, v97
    v_mfma_f32_16x16x32_bf16 v[132:135], v[56:59], v[184:187], v[132:135]
    ds_read_b128 v[48:51], v16 offset:24576
    v_exp_f32 v98, v98
    v_exp_f32 v99, v99
    v_cvt_pk_bf16_f32 v80, v96, v97
    v_cvt_pk_bf16_f32 v81, v98, v99
    s_waitcnt lgkmcnt(5)
    v_mfma_f32_16x16x32_bf16 v[128:131], v[60:63], v[172:175], v[128:131]
    v_cvt_pk_bf16_f32 v100, 0, v100
    v_cvt_pk_bf16_f32 v101, 0, v101
    v_cvt_pk_bf16_f32 v102, 0, v102
    v_cvt_pk_bf16_f32 v103, 0, v103
    s_mov_b32 m0, s42
    s_nop 0
    buffer_load_dwordx4 v30, s[12:15], s36 offen lds
    buffer_load_dwordx4 v31, s[12:15], s36 offen offset:1024 lds
    s_add_u32 s36, s36, 16384
    v_mfma_f32_16x16x32_bf16 v[132:135], v[60:63], v[188:191], v[132:135]
    ds_read_b128 v[52:55], v17 offset:24576
    v_mul_f32 v100, s34, v100
    v_mul_f32 v101, s34, v101
    v_mul_f32 v102, s34, v102
    s_waitcnt lgkmcnt(5)
    v_mfma_f32_16x16x32_bf16 v[136:139], v[64:67], v[160:163], 0
    v_mul_f32 v103, s34, v103
    v_cvt_pk_bf16_f32 v100, 0, v100
    v_cvt_pk_bf16_f32 v101, 0, v101
    v_cvt_pk_bf16_f32 v102, 0, v102
    v_mfma_f32_16x16x32_bf16 v[140:143], v[64:67], v[176:179], 0
    ds_read_b128 v[56:59], v18 offset:24576
    v_cvt_pk_bf16_f32 v103, 0, v103
    v_fma_f32 v100, v100, s32, -v3
    v_fma_f32 v101, v101, s32, -v3
    s_waitcnt lgkmcnt(5)
    v_mfma_f32_16x16x32_bf16 v[136:139], v[68:71], v[164:167], v[136:139]
    v_fma_f32 v102, v102, s32, -v3
    v_fma_f32 v103, v103, s32, -v3
    v_exp_f32 v100, v100
    v_exp_f32 v101, v101
    v_mfma_f32_16x16x32_bf16 v[140:143], v[68:71], v[180:183], v[140:143]
    ds_read_b128 v[60:63], v19 offset:24576
    v_exp_f32 v102, v102
    v_exp_f32 v103, v103
    v_cvt_pk_bf16_f32 v84, v100, v101
    v_cvt_pk_bf16_f32 v85, v102, v103
    s_waitcnt lgkmcnt(5)
    v_mfma_f32_16x16x32_bf16 v[136:139], v[72:75], v[168:171], v[136:139]
    v_cvt_pk_bf16_f32 v104, 0, v104
    v_cvt_pk_bf16_f32 v105, 0, v105
    v_cvt_pk_bf16_f32 v106, 0, v106
    v_mfma_f32_16x16x32_bf16 v[140:143], v[72:75], v[184:187], v[140:143]
    ds_read_b128 v[64:67], v16 offset:28672
    v_cvt_pk_bf16_f32 v107, 0, v107
    v_mul_f32 v104, s34, v104
    v_mul_f32 v105, s34, v105
    v_mul_f32 v106, s34, v106
    s_waitcnt lgkmcnt(5)
    v_mfma_f32_16x16x32_bf16 v[136:139], v[76:79], v[172:175], v[136:139]
    v_mul_f32 v107, s34, v107
    v_cvt_pk_bf16_f32 v104, 0, v104
    v_cvt_pk_bf16_f32 v105, 0, v105
    v_mfma_f32_16x16x32_bf16 v[140:143], v[76:79], v[188:191], v[140:143]
    ds_read_b128 v[68:71], v17 offset:28672
    v_cvt_pk_bf16_f32 v106, 0, v106
    v_cvt_pk_bf16_f32 v107, 0, v107
    v_fma_f32 v104, v104, s32, -v2
    v_fma_f32 v105, v105, s32, -v2
    s_waitcnt lgkmcnt(5)
    v_mfma_f32_16x16x32_bf16 v[144:147], v[48:51], v[160:163], 0
    v_fma_f32 v106, v106, s32, -v2
    v_fma_f32 v107, v107, s32, -v2
    v_exp_f32 v104, v104
    v_exp_f32 v105, v105
    v_mfma_f32_16x16x32_bf16 v[148:151], v[48:51], v[176:179], 0
    ds_read_b128 v[72:75], v18 offset:28672
    s_setprio 2
    v_exp_f32 v106, v106
    v_exp_f32 v107, v107
    v_cvt_pk_bf16_f32 v82, v104, v105
    s_waitcnt lgkmcnt(5)
    v_mfma_f32_16x16x32_bf16 v[144:147], v[52:55], v[164:167], v[144:147]
    v_cvt_pk_bf16_f32 v83, v106, v107
    v_cvt_pk_bf16_f32 v108, 0, v108
    v_cvt_pk_bf16_f32 v109, 0, v109
    v_cvt_pk_bf16_f32 v110, 0, v110
    v_mfma_f32_16x16x32_bf16 v[148:151], v[52:55], v[180:183], v[148:151]
    ds_read_b128 v[76:79], v19 offset:28672
    v_cvt_pk_bf16_f32 v111, 0, v111
    v_mul_f32 v108, s34, v108
    v_mul_f32 v109, s34, v109
    s_waitcnt lgkmcnt(5)
    v_mfma_f32_16x16x32_bf16 v[144:147], v[56:59], v[168:171], v[144:147]
    v_mul_f32 v110, s34, v110
    v_mul_f32 v111, s34, v111
    v_cvt_pk_bf16_f32 v108, 0, v108
    v_cvt_pk_bf16_f32 v109, 0, v109
    v_mfma_f32_16x16x32_bf16 v[148:151], v[56:59], v[184:187], v[148:151]
    ds_read_b64_tr_b16 v[48:49], v20 offset:0
    ds_read_b64_tr_b16 v[50:51], v20 offset:4096
    v_cvt_pk_bf16_f32 v110, 0, v110
    v_cvt_pk_bf16_f32 v111, 0, v111
    v_fma_f32 v108, v108, s32, -v3
    v_fma_f32 v109, v109, s32, -v3
    s_waitcnt lgkmcnt(6)
    v_mfma_f32_16x16x32_bf16 v[144:147], v[60:63], v[172:175], v[144:147]
    v_fma_f32 v110, v110, s32, -v3
    v_fma_f32 v111, v111, s32, -v3
    v_exp_f32 v108, v108
    v_mfma_f32_16x16x32_bf16 v[148:151], v[60:63], v[188:191], v[148:151]
    ds_read_b64_tr_b16 v[52:53], v21 offset:0
    ds_read_b64_tr_b16 v[54:55], v21 offset:4096
    v_exp_f32 v109, v109
    v_exp_f32 v110, v110
    v_exp_f32 v111, v111
    v_cvt_pk_bf16_f32 v86, v108, v109
    s_waitcnt lgkmcnt(7)
    v_mfma_f32_16x16x32_bf16 v[152:155], v[64:67], v[160:163], 0
    v_cvt_pk_bf16_f32 v87, v110, v111
    v_cvt_pk_bf16_f32 v112, 0, v112
    v_cvt_pk_bf16_f32 v113, 0, v113
    v_mfma_f32_16x16x32_bf16 v[156:159], v[64:67], v[176:179], 0
    ds_read_b64_tr_b16 v[56:57], v22 offset:0
    ds_read_b64_tr_b16 v[58:59], v22 offset:4096
    v_cvt_pk_bf16_f32 v114, 0, v114
    v_cvt_pk_bf16_f32 v115, 0, v115
    v_mul_f32 v112, s34, v112
    v_mul_f32 v113, s34, v113
    s_waitcnt lgkmcnt(8)
    v_mfma_f32_16x16x32_bf16 v[152:155], v[68:71], v[164:167], v[152:155]
    v_mul_f32 v114, s34, v114
    v_mul_f32 v115, s34, v115
    v_cvt_pk_bf16_f32 v112, 0, v112
    v_mfma_f32_16x16x32_bf16 v[156:159], v[68:71], v[180:183], v[156:159]
    ds_read_b64_tr_b16 v[60:61], v23 offset:0
    ds_read_b64_tr_b16 v[62:63], v23 offset:4096
    v_cvt_pk_bf16_f32 v113, 0, v113
    v_cvt_pk_bf16_f32 v114, 0, v114
    v_cvt_pk_bf16_f32 v115, 0, v115
    v_fma_f32 v112, v112, s32, -v2
    s_waitcnt lgkmcnt(9)
    v_mfma_f32_16x16x32_bf16 v[152:155], v[72:75], v[168:171], v[152:155]
    v_fma_f32 v113, v113, s32, -v2
    v_fma_f32 v114, v114, s32, -v2
    v_fma_f32 v115, v115, s32, -v2
    v_exp_f32 v112, v112
    v_mfma_f32_16x16x32_bf16 v[156:159], v[72:75], v[184:187], v[156:159]
    ds_read_b64_tr_b16 v[64:65], v24 offset:0
    ds_read_b64_tr_b16 v[66:67], v24 offset:4096
    v_exp_f32 v113, v113
    v_exp_f32 v114, v114
    v_exp_f32 v115, v115
    s_waitcnt lgkmcnt(10)
    v_mfma_f32_16x16x32_bf16 v[152:155], v[76:79], v[172:175], v[152:155]
    v_cvt_pk_bf16_f32 v88, v112, v113
    v_cvt_pk_bf16_f32 v89, v114, v115
    v_cvt_pk_bf16_f32 v116, 0, v116
    v_cvt_pk_bf16_f32 v117, 0, v117
    v_mfma_f32_16x16x32_bf16 v[156:159], v[76:79], v[188:191], v[156:159]
    ds_read_b64_tr_b16 v[68:69], v25 offset:0
    ds_read_b64_tr_b16 v[70:71], v25 offset:4096
    v_cvt_pk_bf16_f32 v118, 0, v118
    v_cvt_pk_bf16_f32 v119, 0, v119
    v_mul_f32 v116, s34, v116
    s_waitcnt lgkmcnt(10)
    v_mfma_f32_16x16x32_bf16 v[192:195], v[48:51], v[80:83], v[192:195]
    v_mul_f32 v117, s34, v117
    v_mul_f32 v118, s34, v118
    v_mul_f32 v119, s34, v119
    v_cvt_pk_bf16_f32 v116, 0, v116
    v_mfma_f32_16x16x32_bf16 v[196:199], v[48:51], v[84:87], v[196:199]
    ds_read_b64_tr_b16 v[72:73], v26 offset:0
    ds_read_b64_tr_b16 v[74:75], v26 offset:4096
    v_cvt_pk_bf16_f32 v117, 0, v117
    v_cvt_pk_bf16_f32 v118, 0, v118
    v_cvt_pk_bf16_f32 v119, 0, v119
    v_fma_f32 v116, v116, s32, -v3
    s_waitcnt lgkmcnt(10)
    v_mfma_f32_16x16x32_bf16 v[200:203], v[52:55], v[80:83], v[200:203]
    s_setprio 1
    v_fma_f32 v117, v117, s32, -v3
    v_fma_f32 v118, v118, s32, -v3
    v_fma_f32 v119, v119, s32, -v3
    v_mfma_f32_16x16x32_bf16 v[204:207], v[52:55], v[84:87], v[204:207]
    ds_read_b64_tr_b16 v[76:77], v27 offset:0
    ds_read_b64_tr_b16 v[78:79], v27 offset:4096
    v_exp_f32 v116, v116
    v_exp_f32 v117, v117
    v_exp_f32 v118, v118
    v_exp_f32 v119, v119
    s_waitcnt lgkmcnt(10)
    v_mfma_f32_16x16x32_bf16 v[208:211], v[56:59], v[80:83], v[208:211]
    v_cvt_pk_bf16_f32 v92, v116, v117
    v_cvt_pk_bf16_f32 v93, v118, v119
    v_cvt_pk_bf16_f32 v120, 0, v120
    s_nop 0
    v_mfma_f32_16x16x32_bf16 v[212:215], v[56:59], v[84:87], v[212:215]
    ds_read_b64_tr_b16 v[48:49], v20 offset:8192
    ds_read_b64_tr_b16 v[50:51], v20 offset:12288
    v_cvt_pk_bf16_f32 v121, 0, v121
    v_cvt_pk_bf16_f32 v122, 0, v122
    v_cvt_pk_bf16_f32 v123, 0, v123
    v_mul_f32 v120, s34, v120
    s_waitcnt lgkmcnt(10)
    v_mfma_f32_16x16x32_bf16 v[216:219], v[60:63], v[80:83], v[216:219]
    v_mul_f32 v121, s34, v121
    v_mul_f32 v122, s34, v122
    v_mul_f32 v123, s34, v123
    v_cvt_pk_bf16_f32 v120, 0, v120
    v_mfma_f32_16x16x32_bf16 v[220:223], v[60:63], v[84:87], v[220:223]
    ds_read_b64_tr_b16 v[52:53], v21 offset:8192
    ds_read_b64_tr_b16 v[54:55], v21 offset:12288
    v_cvt_pk_bf16_f32 v121, 0, v121
    v_cvt_pk_bf16_f32 v122, 0, v122
    v_cvt_pk_bf16_f32 v123, 0, v123
    s_waitcnt lgkmcnt(10)
    v_mfma_f32_16x16x32_bf16 v[224:227], v[64:67], v[80:83], v[224:227]
    v_fma_f32 v120, v120, s32, -v2
    v_fma_f32 v121, v121, s32, -v2
    v_fma_f32 v122, v122, s32, -v2
    v_fma_f32 v123, v123, s32, -v2
    v_mfma_f32_16x16x32_bf16 v[228:231], v[64:67], v[84:87], v[228:231]
    ds_read_b64_tr_b16 v[56:57], v22 offset:8192
    ds_read_b64_tr_b16 v[58:59], v22 offset:12288
    v_exp_f32 v120, v120
    v_exp_f32 v121, v121
    v_exp_f32 v122, v122
    s_waitcnt lgkmcnt(10)
    v_mfma_f32_16x16x32_bf16 v[232:235], v[68:71], v[80:83], v[232:235]
    v_exp_f32 v123, v123
    v_cvt_pk_bf16_f32 v90, v120, v121
    v_cvt_pk_bf16_f32 v91, v122, v123
    v_cvt_pk_bf16_f32 v124, 0, v124
    s_nop 0
    v_mfma_f32_16x16x32_bf16 v[236:239], v[68:71], v[84:87], v[236:239]
    ds_read_b64_tr_b16 v[60:61], v23 offset:8192
    ds_read_b64_tr_b16 v[62:63], v23 offset:12288
    v_cvt_pk_bf16_f32 v125, 0, v125
    v_cvt_pk_bf16_f32 v126, 0, v126
    v_cvt_pk_bf16_f32 v127, 0, v127
    v_mul_f32 v124, s34, v124
    s_waitcnt lgkmcnt(10)
    v_mfma_f32_16x16x32_bf16 v[240:243], v[72:75], v[80:83], v[240:243]
    v_mul_f32 v125, s34, v125
    v_mul_f32 v126, s34, v126
    v_mul_f32 v127, s34, v127
    v_mfma_f32_16x16x32_bf16 v[244:247], v[72:75], v[84:87], v[244:247]
    ds_read_b64_tr_b16 v[64:65], v24 offset:8192
    ds_read_b64_tr_b16 v[66:67], v24 offset:12288
    v_cvt_pk_bf16_f32 v124, 0, v124
    v_cvt_pk_bf16_f32 v125, 0, v125
    v_cvt_pk_bf16_f32 v126, 0, v126
    v_cvt_pk_bf16_f32 v127, 0, v127
    s_waitcnt lgkmcnt(10)
    v_mfma_f32_16x16x32_bf16 v[248:251], v[76:79], v[80:83], v[248:251]
    v_fma_f32 v124, v124, s32, -v3
    v_fma_f32 v125, v125, s32, -v3
    v_fma_f32 v126, v126, s32, -v3
    v_mfma_f32_16x16x32_bf16 v[252:255], v[76:79], v[84:87], v[252:255]
    ds_read_b64_tr_b16 v[68:69], v25 offset:8192
    ds_read_b64_tr_b16 v[70:71], v25 offset:12288
    v_fma_f32 v127, v127, s32, -v3
    v_exp_f32 v124, v124
    v_exp_f32 v125, v125
    v_exp_f32 v126, v126
    v_mfma_f32_16x16x32_bf16 v[32:35], v[12:15], v[80:83], v[32:35]
    v_exp_f32 v127, v127
    v_cvt_pk_bf16_f32 v94, v124, v125
    v_cvt_pk_bf16_f32 v95, v126, v127
    s_nop 1
    v_mfma_f32_16x16x32_bf16 v[36:39], v[12:15], v[84:87], v[36:39]
    s_waitcnt lgkmcnt(10)
    v_mfma_f32_16x16x32_bf16 v[192:195], v[48:51], v[88:91], v[192:195]
    v_mfma_f32_16x16x32_bf16 v[196:199], v[48:51], v[92:95], v[196:199]
    ds_read_b64_tr_b16 v[72:73], v26 offset:8192
    ds_read_b64_tr_b16 v[74:75], v26 offset:12288
    s_setprio 0
    s_waitcnt lgkmcnt(10)
    v_mfma_f32_16x16x32_bf16 v[200:203], v[52:55], v[88:91], v[200:203]
    v_max3_f32 v4, v128, v129, v130
    v_max3_f32 v5, v132, v133, v134
    v_mfma_f32_16x16x32_bf16 v[204:207], v[52:55], v[92:95], v[204:207]
    ds_read_b64_tr_b16 v[76:77], v27 offset:8192
    ds_read_b64_tr_b16 v[78:79], v27 offset:12288
    v_max3_f32 v4, v4, v131, v136
    v_max3_f32 v5, v5, v135, v140
    s_waitcnt lgkmcnt(10)
    v_mfma_f32_16x16x32_bf16 v[208:211], v[56:59], v[88:91], v[208:211]
    v_max3_f32 v4, v4, v137, v138
    v_max3_f32 v5, v5, v141, v142
    v_mfma_f32_16x16x32_bf16 v[212:215], v[56:59], v[92:95], v[212:215]
    ds_read_b128 v[48:51], v16 offset:32768
    v_max3_f32 v4, v4, v139, v144
    s_waitcnt lgkmcnt(9)
    v_mfma_f32_16x16x32_bf16 v[216:219], v[60:63], v[88:91], v[216:219]
    v_max3_f32 v5, v5, v143, v148
    v_max3_f32 v4, v4, v145, v146
    v_mfma_f32_16x16x32_bf16 v[220:223], v[60:63], v[92:95], v[220:223]
    ds_read_b128 v[52:55], v17 offset:32768
    v_max3_f32 v5, v5, v149, v150
    v_max3_f32 v4, v4, v147, v152
    s_waitcnt lgkmcnt(8)
    v_mfma_f32_16x16x32_bf16 v[224:227], v[64:67], v[88:91], v[224:227]
    v_max3_f32 v5, v5, v151, v156
    v_max3_f32 v4, v4, v153, v154
    v_mfma_f32_16x16x32_bf16 v[228:231], v[64:67], v[92:95], v[228:231]
    ds_read_b128 v[56:59], v18 offset:32768
    v_max3_f32 v5, v5, v157, v158
    s_waitcnt lgkmcnt(7)
    v_mfma_f32_16x16x32_bf16 v[232:235], v[68:71], v[88:91], v[232:235]
    v_max_f32 v4, v4, v155
    v_max_f32 v5, v5, v159
    v_mfma_f32_16x16x32_bf16 v[236:239], v[68:71], v[92:95], v[236:239]
    ds_read_b128 v[60:63], v19 offset:32768
    s_nop 1
    v_permlane32_swap_b32 v4, v5
    s_waitcnt lgkmcnt(6)
    v_mfma_f32_16x16x32_bf16 v[240:243], v[72:75], v[88:91], v[240:243]
    v_max_f32 v4, v4, v5
    v_mov_b32 v6, v4
    v_mfma_f32_16x16x32_bf16 v[244:247], v[72:75], v[92:95], v[244:247]
    ds_read_b128 v[64:67], v16 offset:36864
    v_add_f32 v5, 0x41000000, v1
    s_waitcnt lgkmcnt(5)
    v_mfma_f32_16x16x32_bf16 v[248:251], v[76:79], v[88:91], v[248:251]
    s_nop 0
    v_permlane16_swap_b32 v4, v6
    v_mfma_f32_16x16x32_bf16 v[252:255], v[76:79], v[92:95], v[252:255]
    ds_read_b128 v[68:71], v17 offset:36864
    v_max_f32 v4, v4, v6
    v_cvt_pk_bf16_f32 v4, 0, v4
    v_mfma_f32_16x16x32_bf16 v[32:35], v[12:15], v[88:91], v[32:35]
    v_mul_f32 v4, s34, v4
    v_cvt_pk_bf16_f32 v4, 0, v4
    v_mfma_f32_16x16x32_bf16 v[36:39], v[12:15], v[92:95], v[36:39]
    v_mul_f32 v4, s32, v4
    v_cmp_gt_f32 vcc, v4, v5
    s_nop 1
    s_cbranch_vccz L_k3_skip2
    s_nop 15
    v_max_f32 v4, v4, v1
    v_sub_f32 v5, v1, v4
    v_exp_f32 v5, v5
    v_mov_b32 v1, v4
    v_mov_b32 v2, v4
    v_mov_b32 v3, v4
    v_mov_b32 v6, v5
    s_nop 1
    v_permlane32_swap_b32 v2, v3
    v_permlane32_swap_b32 v5, v6
    s_nop 1
    v_mul_f32 v32, v32, v5
    v_mul_f32 v36, v36, v6
    v_mul_f32 v192, v192, v5
    v_mul_f32 v193, v193, v5
    v_mul_f32 v194, v194, v5
    v_mul_f32 v195, v195, v5
    v_mul_f32 v196, v196, v6
    v_mul_f32 v197, v197, v6
    v_mul_f32 v198, v198, v6
    v_mul_f32 v199, v199, v6
    v_mul_f32 v200, v200, v5
    v_mul_f32 v201, v201, v5
    v_mul_f32 v202, v202, v5
    v_mul_f32 v203, v203, v5
    v_mul_f32 v204, v204, v6
    v_mul_f32 v205, v205, v6
    v_mul_f32 v206, v206, v6
    v_mul_f32 v207, v207, v6
    v_mul_f32 v208, v208, v5
    v_mul_f32 v209, v209, v5
    v_mul_f32 v210, v210, v5
    v_mul_f32 v211, v211, v5
    v_mul_f32 v212, v212, v6
    v_mul_f32 v213, v213, v6
    v_mul_f32 v214, v214, v6
    v_mul_f32 v215, v215, v6
    v_mul_f32 v216, v216, v5
    v_mul_f32 v217, v217, v5
    v_mul_f32 v218, v218, v5
    v_mul_f32 v219, v219, v5
    v_mul_f32 v220, v220, v6
    v_mul_f32 v221, v221, v6
    v_mul_f32 v222, v222, v6
    v_mul_f32 v223, v223, v6
    v_mul_f32 v224, v224, v5
    v_mul_f32 v225, v225, v5
    v_mul_f32 v226, v226, v5
    v_mul_f32 v227, v227, v5
    v_mul_f32 v228, v228, v6
    v_mul_f32 v229, v229, v6
    v_mul_f32 v230, v230, v6
    v_mul_f32 v231, v231, v6
    v_mul_f32 v232, v232, v5
    v_mul_f32 v233, v233, v5
    v_mul_f32 v234, v234, v5
    v_mul_f32 v235, v235, v5
    v_mul_f32 v236, v236, v6
    v_mul_f32 v237, v237, v6
    v_mul_f32 v238, v238, v6
    v_mul_f32 v239, v239, v6
    v_mul_f32 v240, v240, v5
    v_mul_f32 v241, v241, v5
    v_mul_f32 v242, v242, v5
    v_mul_f32 v243, v243, v5
    v_mul_f32 v244, v244, v6
    v_mul_f32 v245, v245, v6
    v_mul_f32 v246, v246, v6
    v_mul_f32 v247, v247, v6
    v_mul_f32 v248, v248, v5
    v_mul_f32 v249, v249, v5
    v_mul_f32 v250, v250, v5
    v_mul_f32 v251, v251, v5
    v_mul_f32 v252, v252, v6
    v_mul_f32 v253, v253, v6
    v_mul_f32 v254, v254, v6
    v_mul_f32 v255, v255, v6
    s_nop 1
L_k3_skip2:
    s_waitcnt vmcnt(0)
    s_barrier
    s_waitcnt lgkmcnt(5)
    v_mfma_f32_16x16x32_bf16 v[96:99], v[48:51], v[160:163], 0
    s_setprio 3
    v_cvt_pk_bf16_f32 v128, 0, v128
    v_cvt_pk_bf16_f32 v129, 0, v129
    v_cvt_pk_bf16_f32 v130, 0, v130
    v_cvt_pk_bf16_f32 v131, 0, v131
    v_mfma_f32_16x16x32_bf16 v[100:103], v[48:51], v[176:179], 0
    ds_read_b128 v[72:75], v18 offset:36864
    v_mul_f32 v128, s34, v128
    v_mul_f32 v129, s34, v129
    v_mul_f32 v130, s34, v130
    v_mul_f32 v131, s34, v131
    s_waitcnt lgkmcnt(5)
    v_mfma_f32_16x16x32_bf16 v[96:99], v[52:55], v[164:167], v[96:99]
    v_cvt_pk_bf16_f32 v128, 0, v128
    v_cvt_pk_bf16_f32 v129, 0, v129
    v_cvt_pk_bf16_f32 v130, 0, v130
    s_mov_b32 m0, s38
    s_nop 0
    buffer_load_dwordx4 v28, s[8:11], s35 offen lds
    buffer_load_dwordx4 v29, s[8:11], s35 offen offset:1024 lds
    s_add_u32 s35, s35, 16384
    v_mfma_f32_16x16x32_bf16 v[100:103], v[52:55], v[180:183], v[100:103]
    ds_read_b128 v[76:79], v19 offset:36864
    v_cvt_pk_bf16_f32 v131, 0, v131
    v_fma_f32 v128, v128, s32, -v2
    v_fma_f32 v129, v129, s32, -v2
    v_fma_f32 v130, v130, s32, -v2
    s_waitcnt lgkmcnt(5)
    v_mfma_f32_16x16x32_bf16 v[96:99], v[56:59], v[168:171], v[96:99]
    v_fma_f32 v131, v131, s32, -v2
    v_exp_f32 v128, v128
    v_exp_f32 v129, v129
    v_mfma_f32_16x16x32_bf16 v[100:103], v[56:59], v[184:187], v[100:103]
    ds_read_b128 v[48:51], v16 offset:40960
    v_exp_f32 v130, v130
    v_exp_f32 v131, v131
    v_cvt_pk_bf16_f32 v80, v128, v129
    v_cvt_pk_bf16_f32 v81, v130, v131
    s_waitcnt lgkmcnt(5)
    v_mfma_f32_16x16x32_bf16 v[96:99], v[60:63], v[172:175], v[96:99]
    v_cvt_pk_bf16_f32 v132, 0, v132
    v_cvt_pk_bf16_f32 v133, 0, v133
    v_cvt_pk_bf16_f32 v134, 0, v134
    v_cvt_pk_bf16_f32 v135, 0, v135
    s_mov_b32 m0, s40
    s_nop 0
    buffer_load_dwordx4 v30, s[12:15], s36 offen lds
    buffer_load_dwordx4 v31, s[12:15], s36 offen offset:1024 lds
    s_add_u32 s36, s36, 16384
    v_mfma_f32_16x16x32_bf16 v[100:103], v[60:63], v[188:191], v[100:103]
    ds_read_b128 v[52:55], v17 offset:40960
    v_mul_f32 v132, s34, v132
    v_mul_f32 v133, s34, v133
    v_mul_f32 v134, s34, v134
    s_waitcnt lgkmcnt(5)
    v_mfma_f32_16x16x32_bf16 v[104:107], v[64:67], v[160:163], 0
    v_mul_f32 v135, s34, v135
    v_cvt_pk_bf16_f32 v132, 0, v132
    v_cvt_pk_bf16_f32 v133, 0, v133
    v_cvt_pk_bf16_f32 v134, 0, v134
    v_mfma_f32_16x16x32_bf16 v[108:111], v[64:67], v[176:179], 0
    ds_read_b128 v[56:59], v18 offset:40960
    v_cvt_pk_bf16_f32 v135, 0, v135
    v_fma_f32 v132, v132, s32, -v3
    v_fma_f32 v133, v133, s32, -v3
    s_waitcnt lgkmcnt(5)
    v_mfma_f32_16x16x32_bf16 v[104:107], v[68:71], v[164:167], v[104:107]
    v_fma_f32 v134, v134, s32, -v3
    v_fma_f32 v135, v135, s32, -v3
    v_exp_f32 v132, v132
    v_exp_f32 v133, v133
    v_mfma_f32_16x16x32_bf16 v[108:111], v[68:71], v[180:183], v[108:111]
    ds_read_b128 v[60:63], v19 offset:40960
    v_exp_f32 v134, v134
    v_exp_f32 v135, v135
    v_cvt_pk_bf16_f32 v84, v132, v133
    v_cvt_pk_bf16_f32 v85, v134, v135
    s_waitcnt lgkmcnt(5)
    v_mfma_f32_16x16x32_bf16 v[104:107], v[72:75], v[168:171], v[104:107]
    v_cvt_pk_bf16_f32 v136, 0, v136
    v_cvt_pk_bf16_f32 v137, 0, v137
    v_cvt_pk_bf16_f32 v138, 0, v138
    v_mfma_f32_16x16x32_bf16 v[108:111], v[72:75], v[184:187], v[108:111]
    ds_read_b128 v[64:67], v16 offset:45056
    v_cvt_pk_bf16_f32 v139, 0, v139
    v_mul_f32 v136, s34, v136
    v_mul_f32 v137, s34, v137
    v_mul_f32 v138, s34, v138
    s_waitcnt lgkmcnt(5)
    v_mfma_f32_16x16x32_bf16 v[104:107], v[76:79], v[172:175], v[104:107]
    v_mul_f32 v139, s34, v139
    v_cvt_pk_bf16_f32 v136, 0, v136
    v_cvt_pk_bf16_f32 v137, 0, v137
    v_mfma_f32_16x16x32_bf16 v[108:111], v[76:79], v[188:191], v[108:111]
    ds_read_b128 v[68:71], v17 offset:45056
    v_cvt_pk_bf16_f32 v138, 0, v138
    v_cvt_pk_bf16_f32 v139, 0, v139
    v_fma_f32 v136, v136, s32, -v2
    v_fma_f32 v137, v137, s32, -v2
    s_waitcnt lgkmcnt(5)
    v_mfma_f32_16x16x32_bf16 v[112:115], v[48:51], v[160:163], 0
    v_fma_f32 v138, v138, s32, -v2
    v_fma_f32 v139, v139, s32, -v2
    v_exp_f32 v136, v136
    v_exp_f32 v137, v137
    v_mfma_f32_16x16x32_bf16 v[116:119], v[48:51], v[176:179], 0
    ds_read_b128 v[72:75], v18 offset:45056
    s_setprio 2
    v_exp_f32 v138, v138
    v_exp_f32 v139, v139
    v_cvt_pk_bf16_f32 v82, v136, v137
    s_waitcnt lgkmcnt(5)
    v_mfma_f32_16x16x32_bf16 v[112:115], v[52:55], v[164:167], v[112:115]
    v_cvt_pk_bf16_f32 v83, v138, v139
    v_cvt_pk_bf16_f32 v140, 0, v140
    v_cvt_pk_bf16_f32 v141, 0, v141
    v_cvt_pk_bf16_f32 v142, 0, v142
    v_mfma_f32_16x16x32_bf16 v[116:119], v[52:55], v[180:183], v[116:119]
    ds_read_b128 v[76:79], v19 offset:45056
    v_cvt_pk_bf16_f32 v143, 0, v143
    v_mul_f32 v140, s34, v140
    v_mul_f32 v141, s34, v141
    s_waitcnt lgkmcnt(5)
    v_mfma_f32_16x16x32_bf16 v[112:115], v[56:59], v[168:171], v[112:115]
    v_mul_f32 v142, s34, v142
    v_mul_f32 v143, s34, v143
    v_cvt_pk_bf16_f32 v140, 0, v140
    v_cvt_pk_bf16_f32 v141, 0, v141
    v_mfma_f32_16x16x32_bf16 v[116:119], v[56:59], v[184:187], v[116:119]
    ds_read_b64_tr_b16 v[48:49], v20 offset:16384
    ds_read_b64_tr_b16 v[50:51], v20 offset:20480
    v_cvt_pk_bf16_f32 v142, 0, v142
    v_cvt_pk_bf16_f32 v143, 0, v143
    v_fma_f32 v140, v140, s32, -v3
    v_fma_f32 v141, v141, s32, -v3
    s_waitcnt lgkmcnt(6)
    v_mfma_f32_16x16x32_bf16 v[112:115], v[60:63], v[172:175], v[112:115]
    v_fma_f32 v142, v142, s32, -v3
    v_fma_f32 v143, v143, s32, -v3
    v_exp_f32 v140, v140
    v_mfma_f32_16x16x32_bf16 v[116:119], v[60:63], v[188:191], v[116:119]
    ds_read_b64_tr_b16 v[52:53], v21 offset:16384
    ds_read_b64_tr_b16 v[54:55], v21 offset:20480
    v_exp_f32 v141, v141
    v_exp_f32 v142, v142
    v_exp_f32 v143, v143
    v_cvt_pk_bf16_f32 v86, v140, v141
    s_waitcnt lgkmcnt(7)
    v_mfma_f32_16x16x32_bf16 v[120:123], v[64:67], v[160:163], 0
    v_cvt_pk_bf16_f32 v87, v142, v143
    v_cvt_pk_bf16_f32 v144, 0, v144
    v_cvt_pk_bf16_f32 v145, 0, v145
    v_mfma_f32_16x16x32_bf16 v[124:127], v[64:67], v[176:179], 0
    ds_read_b64_tr_b16 v[56:57], v22 offset:16384
    ds_read_b64_tr_b16 v[58:59], v22 offset:20480
    v_cvt_pk_bf16_f32 v146, 0, v146
    v_cvt_pk_bf16_f32 v147, 0, v147
    v_mul_f32 v144, s34, v144
    v_mul_f32 v145, s34, v145
    s_waitcnt lgkmcnt(8)
    v_mfma_f32_16x16x32_bf16 v[120:123], v[68:71], v[164:167], v[120:123]
    v_mul_f32 v146, s34, v146
    v_mul_f32 v147, s34, v147
    v_cvt_pk_bf16_f32 v144, 0, v144
    v_mfma_f32_16x16x32_bf16 v[124:127], v[68:71], v[180:183], v[124:127]
    ds_read_b64_tr_b16 v[60:61], v23 offset:16384
    ds_read_b64_tr_b16 v[62:63], v23 offset:20480
    v_cvt_pk_bf16_f32 v145, 0, v145
    v_cvt_pk_bf16_f32 v146, 0, v146
    v_cvt_pk_bf16_f32 v147, 0, v147
    v_fma_f32 v144, v144, s32, -v2
    s_waitcnt lgkmcnt(9)
    v_mfma_f32_16x16x32_bf16 v[120:123], v[72:75], v[168:171], v[120:123]
    v_fma_f32 v145, v145, s32, -v2
    v_fma_f32 v146, v146, s32, -v2
    v_fma_f32 v147, v147, s32, -v2
    v_exp_f32 v144, v144
    v_mfma_f32_16x16x32_bf16 v[124:127], v[72:75], v[184:187], v[124:127]
    ds_read_b64_tr_b16 v[64:65], v24 offset:16384
    ds_read_b64_tr_b16 v[66:67], v24 offset:20480
    v_exp_f32 v145, v145
    v_exp_f32 v146, v146
    v_exp_f32 v147, v147
    s_waitcnt lgkmcnt(10)
    v_mfma_f32_16x16x32_bf16 v[120:123], v[76:79], v[172:175], v[120:123]
    v_cvt_pk_bf16_f32 v88, v144, v145
    v_cvt_pk_bf16_f32 v89, v146, v147
    v_cvt_pk_bf16_f32 v148, 0, v148
    v_cvt_pk_bf16_f32 v149, 0, v149
    v_mfma_f32_16x16x32_bf16 v[124:127], v[76:79], v[188:191], v[124:127]
    ds_read_b64_tr_b16 v[68:69], v25 offset:16384
    ds_read_b64_tr_b16 v[70:71], v25 offset:20480
    v_cvt_pk_bf16_f32 v150, 0, v150
    v_cvt_pk_bf16_f32 v151, 0, v151
    v_mul_f32 v148, s34, v148
    s_waitcnt lgkmcnt(10)
    v_mfma_f32_16x16x32_bf16 v[192:195], v[48:51], v[80:83], v[192:195]
    v_mul_f32 v149, s34, v149
    v_mul_f32 v150, s34, v150
    v_mul_f32 v151, s34, v151
    v_cvt_pk_bf16_f32 v148, 0, v148
    v_mfma_f32_16x16x32_bf16 v[196:199], v[48:51], v[84:87], v[196:199]
    ds_read_b64_tr_b16 v[72:73], v26 offset:16384
    ds_read_b64_tr_b16 v[74:75], v26 offset:20480
    v_cvt_pk_bf16_f32 v149, 0, v149
    v_cvt_pk_bf16_f32 v150, 0, v150
    v_cvt_pk_bf16_f32 v151, 0, v151
    v_fma_f32 v148, v148, s32, -v3
    s_waitcnt lgkmcnt(10)
    v_mfma_f32_16x16x32_bf16 v[200:203], v[52:55], v[80:83], v[200:203]
    s_setprio 1
    v_fma_f32 v149, v149, s32, -v3
    v_fma_f32 v150, v150, s32, -v3
    v_fma_f32 v151, v151, s32, -v3
    v_mfma_f32_16x16x32_bf16 v[204:207], v[52:55], v[84:87], v[204:207]
    ds_read_b64_tr_b16 v[76:77], v27 offset:16384
    ds_read_b64_tr_b16 v[78:79], v27 offset:20480
    v_exp_f32 v148, v148
    v_exp_f32 v149, v149
    v_exp_f32 v150, v150
    v_exp_f32 v151, v151
    s_waitcnt lgkmcnt(10)
    v_mfma_f32_16x16x32_bf16 v[208:211], v[56:59], v[80:83], v[208:211]
    v_cvt_pk_bf16_f32 v92, v148, v149
    v_cvt_pk_bf16_f32 v93, v150, v151
    v_cvt_pk_bf16_f32 v152, 0, v152
    s_nop 0
    v_mfma_f32_16x16x32_bf16 v[212:215], v[56:59], v[84:87], v[212:215]
    ds_read_b64_tr_b16 v[48:49], v20 offset:24576
    ds_read_b64_tr_b16 v[50:51], v20 offset:28672
    v_cvt_pk_bf16_f32 v153, 0, v153
    v_cvt_pk_bf16_f32 v154, 0, v154
    v_cvt_pk_bf16_f32 v155, 0, v155
    v_mul_f32 v152, s34, v152
    s_waitcnt lgkmcnt(10)
    v_mfma_f32_16x16x32_bf16 v[216:219], v[60:63], v[80:83], v[216:219]
    v_mul_f32 v153, s34, v153
    v_mul_f32 v154, s34, v154
    v_mul_f32 v155, s34, v155
    v_cvt_pk_bf16_f32 v152, 0, v152
    v_mfma_f32_16x16x32_bf16 v[220:223], v[60:63], v[84:87], v[220:223]
    ds_read_b64_tr_b16 v[52:53], v21 offset:24576
    ds_read_b64_tr_b16 v[54:55], v21 offset:28672
    v_cvt_pk_bf16_f32 v153, 0, v153
    v_cvt_pk_bf16_f32 v154, 0, v154
    v_cvt_pk_bf16_f32 v155, 0, v155
    s_waitcnt lgkmcnt(10)
    v_mfma_f32_16x16x32_bf16 v[224:227], v[64:67], v[80:83], v[224:227]
    v_fma_f32 v152, v152, s32, -v2
    v_fma_f32 v153, v153, s32, -v2
    v_fma_f32 v154, v154, s32, -v2
    v_fma_f32 v155, v155, s32, -v2
    v_mfma_f32_16x16x32_bf16 v[228:231], v[64:67], v[84:87], v[228:231]
    ds_read_b64_tr_b16 v[56:57], v22 offset:24576
    ds_read_b64_tr_b16 v[58:59], v22 offset:28672
    v_exp_f32 v152, v152
    v_exp_f32 v153, v153
    v_exp_f32 v154, v154
    s_waitcnt lgkmcnt(10)
    v_mfma_f32_16x16x32_bf16 v[232:235], v[68:71], v[80:83], v[232:235]
    v_exp_f32 v155, v155
    v_cvt_pk_bf16_f32 v90, v152, v153
    v_cvt_pk_bf16_f32 v91, v154, v155
    v_cvt_pk_bf16_f32 v156, 0, v156
    s_nop 0
    v_mfma_f32_16x16x32_bf16 v[236:239], v[68:71], v[84:87], v[236:239]
    ds_read_b64_tr_b16 v[60:61], v23 offset:24576
    ds_read_b64_tr_b16 v[62:63], v23 offset:28672
    v_cvt_pk_bf16_f32 v157, 0, v157
    v_cvt_pk_bf16_f32 v158, 0, v158
    v_cvt_pk_bf16_f32 v159, 0, v159
    v_mul_f32 v156, s34, v156
    s_waitcnt lgkmcnt(10)
    v_mfma_f32_16x16x32_bf16 v[240:243], v[72:75], v[80:83], v[240:243]
    v_mul_f32 v157, s34, v157
    v_mul_f32 v158, s34, v158
    v_mul_f32 v159, s34, v159
    v_mfma_f32_16x16x32_bf16 v[244:247], v[72:75], v[84:87], v[244:247]
    ds_read_b64_tr_b16 v[64:65], v24 offset:24576
    ds_read_b64_tr_b16 v[66:67], v24 offset:28672
    v_cvt_pk_bf16_f32 v156, 0, v156
    v_cvt_pk_bf16_f32 v157, 0, v157
    v_cvt_pk_bf16_f32 v158, 0, v158
    v_cvt_pk_bf16_f32 v159, 0, v159
    s_waitcnt lgkmcnt(10)
    v_mfma_f32_16x16x32_bf16 v[248:251], v[76:79], v[80:83], v[248:251]
    v_fma_f32 v156, v156, s32, -v3
    v_fma_f32 v157, v157, s32, -v3
    v_fma_f32 v158, v158, s32, -v3
    v_mfma_f32_16x16x32_bf16 v[252:255], v[76:79], v[84:87], v[252:255]
    ds_read_b64_tr_b16 v[68:69], v25 offset:24576
    ds_read_b64_tr_b16 v[70:71], v25 offset:28672
    v_fma_f32 v159, v159, s32, -v3
    v_exp_f32 v156, v156
    v_exp_f32 v157, v157
    v_exp_f32 v158, v158
    v_mfma_f32_16x16x32_bf16 v[32:35], v[12:15], v[80:83], v[32:35]
    v_exp_f32 v159, v159
    v_cvt_pk_bf16_f32 v94, v156, v157
    v_cvt_pk_bf16_f32 v95, v158, v159
    s_nop 1
    v_mfma_f32_16x16x32_bf16 v[36:39], v[12:15], v[84:87], v[36:39]
    s_waitcnt lgkmcnt(10)
    v_mfma_f32_16x16x32_bf16 v[192:195], v[48:51], v[88:91], v[192:195]
    v_mfma_f32_16x16x32_bf16 v[196:199], v[48:51], v[92:95], v[196:199]
    ds_read_b64_tr_b16 v[72:73], v26 offset:24576
    ds_read_b64_tr_b16 v[74:75], v26 offset:28672
    s_setprio 0
    s_waitcnt lgkmcnt(10)
    v_mfma_f32_16x16x32_bf16 v[200:203], v[52:55], v[88:91], v[200:203]
    v_max3_f32 v4, v96, v97, v98
    v_max3_f32 v5, v100, v101, v102
    v_mfma_f32_16x16x32_bf16 v[204:207], v[52:55], v[92:95], v[204:207]
    ds_read_b64_tr_b16 v[76:77], v27 offset:24576
    ds_read_b64_tr_b16 v[78:79], v27 offset:28672
    v_max3_f32 v4, v4, v99, v104
    v_max3_f32 v5, v5, v103, v108
    s_waitcnt lgkmcnt(10)
    v_mfma_f32_16x16x32_bf16 v[208:211], v[56:59], v[88:91], v[208:211]
    v_max3_f32 v4, v4, v105, v106
    v_max3_f32 v5, v5, v109, v110
    v_mfma_f32_16x16x32_bf16 v[212:215], v[56:59], v[92:95], v[212:215]
    ds_read_b128 v[48:51], v16 offset:0
    v_max3_f32 v4, v4, v107, v112
    s_waitcnt lgkmcnt(9)
    v_mfma_f32_16x16x32_bf16 v[216:219], v[60:63], v[88:91], v[216:219]
    v_max3_f32 v5, v5, v111, v116
    v_max3_f32 v4, v4, v113, v114
    v_mfma_f32_16x16x32_bf16 v[220:223], v[60:63], v[92:95], v[220:223]
    ds_read_b128 v[52:55], v17 offset:0
    v_max3_f32 v5, v5, v117, v118
    v_max3_f32 v4, v4, v115, v120
    s_waitcnt lgkmcnt(8)
    v_mfma_f32_16x16x32_bf16 v[224:227], v[64:67], v[88:91], v[224:227]
    v_max3_f32 v5, v5, v119, v124
    v_max3_f32 v4, v4, v121, v122
    v_mfma_f32_16x16x32_bf16 v[228:231], v[64:67], v[92:95], v[228:231]
    ds_read_b128 v[56:59], v18 offset:0
    v_max3_f32 v5, v5, v125, v126
    s_waitcnt lgkmcnt(7)
    v_mfma_f32_16x16x32_bf16 v[232:235], v[68:71], v[88:91], v[232:235]
    v_max_f32 v4, v4, v123
    v_max_f32 v5, v5, v127
    v_mfma_f32_16x16x32_bf16 v[236:239], v[68:71], v[92:95], v[236:239]
    ds_read_b128 v[60:63], v19 offset:0
    s_nop 1
    v_permlane32_swap_b32 v4, v5
    s_waitcnt lgkmcnt(6)
    v_mfma_f32_16x16x32_bf16 v[240:243], v[72:75], v[88:91], v[240:243]
    v_max_f32 v4, v4, v5
    v_mov_b32 v6, v4
    v_mfma_f32_16x16x32_bf16 v[244:247], v[72:75], v[92:95], v[244:247]
    ds_read_b128 v[64:67], v16 offset:4096
    v_add_f32 v5, 0x41000000, v1
    s_waitcnt lgkmcnt(5)
    v_mfma_f32_16x16x32_bf16 v[248:251], v[76:79], v[88:91], v[248:251]
    s_nop 0
    v_permlane16_swap_b32 v4, v6
    v_mfma_f32_16x16x32_bf16 v[252:255], v[76:79], v[92:95], v[252:255]
    ds_read_b128 v[68:71], v17 offset:4096
    v_max_f32 v4, v4, v6
    v_cvt_pk_bf16_f32 v4, 0, v4
    v_mfma_f32_16x16x32_bf16 v[32:35], v[12:15], v[88:91], v[32:35]
    v_mul_f32 v4, s34, v4
    v_cvt_pk_bf16_f32 v4, 0, v4
    v_mfma_f32_16x16x32_bf16 v[36:39], v[12:15], v[92:95], v[36:39]
    v_mul_f32 v4, s32, v4
    v_cmp_gt_f32 vcc, v4, v5
    s_nop 1
    s_cbranch_vccz L_k3_skip3
    s_nop 15
    v_max_f32 v4, v4, v1
    v_sub_f32 v5, v1, v4
    v_exp_f32 v5, v5
    v_mov_b32 v1, v4
    v_mov_b32 v2, v4
    v_mov_b32 v3, v4
    v_mov_b32 v6, v5
    s_nop 1
    v_permlane32_swap_b32 v2, v3
    v_permlane32_swap_b32 v5, v6
    s_nop 1
    v_mul_f32 v32, v32, v5
    v_mul_f32 v36, v36, v6
    v_mul_f32 v192, v192, v5
    v_mul_f32 v193, v193, v5
    v_mul_f32 v194, v194, v5
    v_mul_f32 v195, v195, v5
    v_mul_f32 v196, v196, v6
    v_mul_f32 v197, v197, v6
    v_mul_f32 v198, v198, v6
    v_mul_f32 v199, v199, v6
    v_mul_f32 v200, v200, v5
    v_mul_f32 v201, v201, v5
    v_mul_f32 v202, v202, v5
    v_mul_f32 v203, v203, v5
    v_mul_f32 v204, v204, v6
    v_mul_f32 v205, v205, v6
    v_mul_f32 v206, v206, v6
    v_mul_f32 v207, v207, v6
    v_mul_f32 v208, v208, v5
    v_mul_f32 v209, v209, v5
    v_mul_f32 v210, v210, v5
    v_mul_f32 v211, v211, v5
    v_mul_f32 v212, v212, v6
    v_mul_f32 v213, v213, v6
    v_mul_f32 v214, v214, v6
    v_mul_f32 v215, v215, v6
    v_mul_f32 v216, v216, v5
    v_mul_f32 v217, v217, v5
    v_mul_f32 v218, v218, v5
    v_mul_f32 v219, v219, v5
    v_mul_f32 v220, v220, v6
    v_mul_f32 v221, v221, v6
    v_mul_f32 v222, v222, v6
    v_mul_f32 v223, v223, v6
    v_mul_f32 v224, v224, v5
    v_mul_f32 v225, v225, v5
    v_mul_f32 v226, v226, v5
    v_mul_f32 v227, v227, v5
    v_mul_f32 v228, v228, v6
    v_mul_f32 v229, v229, v6
    v_mul_f32 v230, v230, v6
    v_mul_f32 v231, v231, v6
    v_mul_f32 v232, v232, v5
    v_mul_f32 v233, v233, v5
    v_mul_f32 v234, v234, v5
    v_mul_f32 v235, v235, v5
    v_mul_f32 v236, v236, v6
    v_mul_f32 v237, v237, v6
    v_mul_f32 v238, v238, v6
    v_mul_f32 v239, v239, v6
    v_mul_f32 v240, v240, v5
    v_mul_f32 v241, v241, v5
    v_mul_f32 v242, v242, v5
    v_mul_f32 v243, v243, v5
    v_mul_f32 v244, v244, v6
    v_mul_f32 v245, v245, v6
    v_mul_f32 v246, v246, v6
    v_mul_f32 v247, v247, v6
    v_mul_f32 v248, v248, v5
    v_mul_f32 v249, v249, v5
    v_mul_f32 v250, v250, v5
    v_mul_f32 v251, v251, v5
    v_mul_f32 v252, v252, v6
    v_mul_f32 v253, v253, v6
    v_mul_f32 v254, v254, v6
    v_mul_f32 v255, v255, v6
    s_nop 1
L_k3_skip3:
    s_waitcnt vmcnt(0)
    s_barrier
    s_waitcnt lgkmcnt(5)
    v_mfma_f32_16x16x32_bf16 v[128:131], v[48:51], v[160:163], 0
    s_setprio 3
    v_cvt_pk_bf16_f32 v96, 0, v96
    v_cvt_pk_bf16_f32 v97, 0, v97
    v_cvt_pk_bf16_f32 v98, 0, v98
    v_cvt_pk_bf16_f32 v99, 0, v99
    v_mfma_f32_16x16x32_bf16 v[132:135], v[48:51], v[176:179], 0
    ds_read_b128 v[72:75], v18 offset:4096
    v_mul_f32 v96, s34, v96
    v_mul_f32 v97, s34, v97
    v_mul_f32 v98, s34, v98
    v_mul_f32 v99, s34, v99
    s_waitcnt lgkmcnt(5)
    v_mfma_f32_16x16x32_bf16 v[128:131], v[52:55], v[164:167], v[128:131]
    v_cvt_pk_bf16_f32 v96, 0, v96
    v_cvt_pk_bf16_f32 v97, 0, v97
    v_cvt_pk_bf16_f32 v98, 0, v98
    s_mov_b32 m0, s39
    s_nop 0
    buffer_load_dwordx4 v28, s[8:11], s35 offen lds
    buffer_load_dwordx4 v29, s[8:11], s35 offen offset:1024 lds
    s_add_u32 s35, s35, 16384
    v_mfma_f32_16x16x32_bf16 v[132:135], v[52:55], v[180:183], v[132:135]
    ds_read_b128 v[76:79], v19 offset:4096
    v_cvt_pk_bf16_f32 v99, 0, v99
    v_fma_f32 v96, v96, s32, -v2
    v_fma_f32 v97, v97, s32, -v2
    v_fma_f32 v98, v98, s32, -v2
    s_waitcnt lgkmcnt(5)
    v_mfma_f32_16x16x32_bf16 v[128:131], v[56:59], v[168:171], v[128:131]
    v_fma_f32 v99, v99, s32, -v2
    v_exp_f32 v96, v96
    v_exp_f32 v97, v97
    v_mfma_f32_16x16x32_bf16 v[132:135], v[56:59], v[184:187], v[132:135]
    ds_read_b128 v[48:51], v16 offset:8192
    v_exp_f32 v98, v98
    v_exp_f32 v99, v99
    v_cvt_pk_bf16_f32 v80, v96, v97
    v_cvt_pk_bf16_f32 v81, v98, v99
    s_waitcnt lgkmcnt(5)
    v_mfma_f32_16x16x32_bf16 v[128:131], v[60:63], v[172:175], v[128:131]
    v_cvt_pk_bf16_f32 v100, 0, v100
    v_cvt_pk_bf16_f32 v101, 0, v101
    v_cvt_pk_bf16_f32 v102, 0, v102
    v_cvt_pk_bf16_f32 v103, 0, v103
    s_mov_b32 m0, s41
    s_nop 0
    buffer_load_dwordx4 v30, s[12:15], s36 offen lds
    buffer_load_dwordx4 v31, s[12:15], s36 offen offset:1024 lds
    s_add_u32 s36, s36, 16384
    v_mfma_f32_16x16x32_bf16 v[132:135], v[60:63], v[188:191], v[132:135]
    ds_read_b128 v[52:55], v17 offset:8192
    v_mul_f32 v100, s34, v100
    v_mul_f32 v101, s34, v101
    v_mul_f32 v102, s34, v102
    s_waitcnt lgkmcnt(5)
    v_mfma_f32_16x16x32_bf16 v[136:139], v[64:67], v[160:163], 0
    v_mul_f32 v103, s34, v103
    v_cvt_pk_bf16_f32 v100, 0, v100
    v_cvt_pk_bf16_f32 v101, 0, v101
    v_cvt_pk_bf16_f32 v102, 0, v102
    v_mfma_f32_16x16x32_bf16 v[140:143], v[64:67], v[176:179], 0
    ds_read_b128 v[56:59], v18 offset:8192
    v_cvt_pk_bf16_f32 v103, 0, v103
    v_fma_f32 v100, v100, s32, -v3
    v_fma_f32 v101, v101, s32, -v3
    s_waitcnt lgkmcnt(5)
    v_mfma_f32_16x16x32_bf16 v[136:139], v[68:71], v[164:167], v[136:139]
    v_fma_f32 v102, v102, s32, -v3
    v_fma_f32 v103, v103, s32, -v3
    v_exp_f32 v100, v100
    v_exp_f32 v101, v101
    v_mfma_f32_16x16x32_bf16 v[140:143], v[68:71], v[180:183], v[140:143]
    ds_read_b128 v[60:63], v19 offset:8192
    v_exp_f32 v102, v102
    v_exp_f32 v103, v103
    v_cvt_pk_bf16_f32 v84, v100, v101
    v_cvt_pk_bf16_f32 v85, v102, v103
    s_waitcnt lgkmcnt(5)
    v_mfma_f32_16x16x32_bf16 v[136:139], v[72:75], v[168:171], v[136:139]
    v_cvt_pk_bf16_f32 v104, 0, v104
    v_cvt_pk_bf16_f32 v105, 0, v105
    v_cvt_pk_bf16_f32 v106, 0, v106
    v_mfma_f32_16x16x32_bf16 v[140:143], v[72:75], v[184:187], v[140:143]
    ds_read_b128 v[64:67], v16 offset:12288
    v_cvt_pk_bf16_f32 v107, 0, v107
    v_mul_f32 v104, s34, v104
    v_mul_f32 v105, s34, v105
    v_mul_f32 v106, s34, v106
    s_waitcnt lgkmcnt(5)
    v_mfma_f32_16x16x32_bf16 v[136:139], v[76:79], v[172:175], v[136:139]
    v_mul_f32 v107, s34, v107
    v_cvt_pk_bf16_f32 v104, 0, v104
    v_cvt_pk_bf16_f32 v105, 0, v105
    v_mfma_f32_16x16x32_bf16 v[140:143], v[76:79], v[188:191], v[140:143]
    ds_read_b128 v[68:71], v17 offset:12288
    v_cvt_pk_bf16_f32 v106, 0, v106
    v_cvt_pk_bf16_f32 v107, 0, v107
    v_fma_f32 v104, v104, s32, -v2
    v_fma_f32 v105, v105, s32, -v2
    s_waitcnt lgkmcnt(5)
    v_mfma_f32_16x16x32_bf16 v[144:147], v[48:51], v[160:163], 0
    v_fma_f32 v106, v106, s32, -v2
    v_fma_f32 v107, v107, s32, -v2
    v_exp_f32 v104, v104
    v_exp_f32 v105, v105
    v_mfma_f32_16x16x32_bf16 v[148:151], v[48:51], v[176:179], 0
    ds_read_b128 v[72:75], v18 offset:12288
    s_setprio 2
    v_exp_f32 v106, v106
    v_exp_f32 v107, v107
    v_cvt_pk_bf16_f32 v82, v104, v105
    s_waitcnt lgkmcnt(5)
    v_mfma_f32_16x16x32_bf16 v[144:147], v[52:55], v[164:167], v[144:147]
    v_cvt_pk_bf16_f32 v83, v106, v107
    v_cvt_pk_bf16_f32 v108, 0, v108
    v_cvt_pk_bf16_f32 v109, 0, v109
    v_cvt_pk_bf16_f32 v110, 0, v110
    v_mfma_f32_16x16x32_bf16 v[148:151], v[52:55], v[180:183], v[148:151]
    ds_read_b128 v[76:79], v19 offset:12288
    v_cvt_pk_bf16_f32 v111, 0, v111
    v_mul_f32 v108, s34, v108
    v_mul_f32 v109, s34, v109
    s_waitcnt lgkmcnt(5)
    v_mfma_f32_16x16x32_bf16 v[144:147], v[56:59], v[168:171], v[144:147]
    v_mul_f32 v110, s34, v110
    v_mul_f32 v111, s34, v111
    v_cvt_pk_bf16_f32 v108, 0, v108
    v_cvt_pk_bf16_f32 v109, 0, v109
    v_mfma_f32_16x16x32_bf16 v[148:151], v[56:59], v[184:187], v[148:151]
    ds_read_b64_tr_b16 v[48:49], v20 offset:32768
    ds_read_b64_tr_b16 v[50:51], v20 offset:36864
    v_cvt_pk_bf16_f32 v110, 0, v110
    v_cvt_pk_bf16_f32 v111, 0, v111
    v_fma_f32 v108, v108, s32, -v3
    v_fma_f32 v109, v109, s32, -v3
    s_waitcnt lgkmcnt(6)
    v_mfma_f32_16x16x32_bf16 v[144:147], v[60:63], v[172:175], v[144:147]
    v_fma_f32 v110, v110, s32, -v3
    v_fma_f32 v111, v111, s32, -v3
    v_exp_f32 v108, v108
    v_mfma_f32_16x16x32_bf16 v[148:151], v[60:63], v[188:191], v[148:151]
    ds_read_b64_tr_b16 v[52:53], v21 offset:32768
    ds_read_b64_tr_b16 v[54:55], v21 offset:36864
    v_exp_f32 v109, v109
    v_exp_f32 v110, v110
    v_exp_f32 v111, v111
    v_cvt_pk_bf16_f32 v86, v108, v109
    s_waitcnt lgkmcnt(7)
    v_mfma_f32_16x16x32_bf16 v[152:155], v[64:67], v[160:163], 0
    v_cvt_pk_bf16_f32 v87, v110, v111
    v_cvt_pk_bf16_f32 v112, 0, v112
    v_cvt_pk_bf16_f32 v113, 0, v113
    v_mfma_f32_16x16x32_bf16 v[156:159], v[64:67], v[176:179], 0
    ds_read_b64_tr_b16 v[56:57], v22 offset:32768
    ds_read_b64_tr_b16 v[58:59], v22 offset:36864
    v_cvt_pk_bf16_f32 v114, 0, v114
    v_cvt_pk_bf16_f32 v115, 0, v115
    v_mul_f32 v112, s34, v112
    v_mul_f32 v113, s34, v113
    s_waitcnt lgkmcnt(8)
    v_mfma_f32_16x16x32_bf16 v[152:155], v[68:71], v[164:167], v[152:155]
    v_mul_f32 v114, s34, v114
    v_mul_f32 v115, s34, v115
    v_cvt_pk_bf16_f32 v112, 0, v112
    v_mfma_f32_16x16x32_bf16 v[156:159], v[68:71], v[180:183], v[156:159]
    ds_read_b64_tr_b16 v[60:61], v23 offset:32768
    ds_read_b64_tr_b16 v[62:63], v23 offset:36864
    v_cvt_pk_bf16_f32 v113, 0, v113
    v_cvt_pk_bf16_f32 v114, 0, v114
    v_cvt_pk_bf16_f32 v115, 0, v115
    v_fma_f32 v112, v112, s32, -v2
    s_waitcnt lgkmcnt(9)
    v_mfma_f32_16x16x32_bf16 v[152:155], v[72:75], v[168:171], v[152:155]
    v_fma_f32 v113, v113, s32, -v2
    v_fma_f32 v114, v114, s32, -v2
    v_fma_f32 v115, v115, s32, -v2
    v_exp_f32 v112, v112
    v_mfma_f32_16x16x32_bf16 v[156:159], v[72:75], v[184:187], v[156:159]
    ds_read_b64_tr_b16 v[64:65], v24 offset:32768
    ds_read_b64_tr_b16 v[66:67], v24 offset:36864
    v_exp_f32 v113, v113
    v_exp_f32 v114, v114
    v_exp_f32 v115, v115
    s_waitcnt lgkmcnt(10)
    v_mfma_f32_16x16x32_bf16 v[152:155], v[76:79], v[172:175], v[152:155]
    v_cvt_pk_bf16_f32 v88, v112, v113
    v_cvt_pk_bf16_f32 v89, v114, v115
    v_cvt_pk_bf16_f32 v116, 0, v116
    v_cvt_pk_bf16_f32 v117, 0, v117
    v_mfma_f32_16x16x32_bf16 v[156:159], v[76:79], v[188:191], v[156:159]
    ds_read_b64_tr_b16 v[68:69], v25 offset:32768
    ds_read_b64_tr_b16 v[70:71], v25 offset:36864
    v_cvt_pk_bf16_f32 v118, 0, v118
    v_cvt_pk_bf16_f32 v119, 0, v119
    v_mul_f32 v116, s34, v116
    s_waitcnt lgkmcnt(10)
    v_mfma_f32_16x16x32_bf16 v[192:195], v[48:51], v[80:83], v[192:195]
    v_mul_f32 v117, s34, v117
    v_mul_f32 v118, s34, v118
    v_mul_f32 v119, s34, v119
    v_cvt_pk_bf16_f32 v116, 0, v116
    v_mfma_f32_16x16x32_bf16 v[196:199], v[48:51], v[84:87], v[196:199]
    ds_read_b64_tr_b16 v[72:73], v26 offset:32768
    ds_read_b64_tr_b16 v[74:75], v26 offset:36864
    v_cvt_pk_bf16_f32 v117, 0, v117
    v_cvt_pk_bf16_f32 v118, 0, v118
    v_cvt_pk_bf16_f32 v119, 0, v119
    v_fma_f32 v116, v116, s32, -v3
    s_waitcnt lgkmcnt(10)
    v_mfma_f32_16x16x32_bf16 v[200:203], v[52:55], v[80:83], v[200:203]
    s_setprio 1
    v_fma_f32 v117, v117, s32, -v3
    v_fma_f32 v118, v118, s32, -v3
    v_fma_f32 v119, v119, s32, -v3
    v_mfma_f32_16x16x32_bf16 v[204:207], v[52:55], v[84:87], v[204:207]
    ds_read_b64_tr_b16 v[76:77], v27 offset:32768
    ds_read_b64_tr_b16 v[78:79], v27 offset:36864
    v_exp_f32 v116, v116
    v_exp_f32 v117, v117
    v_exp_f32 v118, v118
    v_exp_f32 v119, v119
    s_waitcnt lgkmcnt(10)
    v_mfma_f32_16x16x32_bf16 v[208:211], v[56:59], v[80:83], v[208:211]
    v_cvt_pk_bf16_f32 v92, v116, v117
    v_cvt_pk_bf16_f32 v93, v118, v119
    v_cvt_pk_bf16_f32 v120, 0, v120
    s_nop 0
    v_mfma_f32_16x16x32_bf16 v[212:215], v[56:59], v[84:87], v[212:215]
    ds_read_b64_tr_b16 v[48:49], v20 offset:40960
    ds_read_b64_tr_b16 v[50:51], v20 offset:45056
    v_cvt_pk_bf16_f32 v121, 0, v121
    v_cvt_pk_bf16_f32 v122, 0, v122
    v_cvt_pk_bf16_f32 v123, 0, v123
    v_mul_f32 v120, s34, v120
    s_waitcnt lgkmcnt(10)
    v_mfma_f32_16x16x32_bf16 v[216:219], v[60:63], v[80:83], v[216:219]
    v_mul_f32 v121, s34, v121
    v_mul_f32 v122, s34, v122
    v_mul_f32 v123, s34, v123
    v_cvt_pk_bf16_f32 v120, 0, v120
    v_mfma_f32_16x16x32_bf16 v[220:223], v[60:63], v[84:87], v[220:223]
    ds_read_b64_tr_b16 v[52:53], v21 offset:40960
    ds_read_b64_tr_b16 v[54:55], v21 offset:45056
    v_cvt_pk_bf16_f32 v121, 0, v121
    v_cvt_pk_bf16_f32 v122, 0, v122
    v_cvt_pk_bf16_f32 v123, 0, v123
    s_waitcnt lgkmcnt(10)
    v_mfma_f32_16x16x32_bf16 v[224:227], v[64:67], v[80:83], v[224:227]
    v_fma_f32 v120, v120, s32, -v2
    v_fma_f32 v121, v121, s32, -v2
    v_fma_f32 v122, v122, s32, -v2
    v_fma_f32 v123, v123, s32, -v2
    v_mfma_f32_16x16x32_bf16 v[228:231], v[64:67], v[84:87], v[228:231]
    ds_read_b64_tr_b16 v[56:57], v22 offset:40960
    ds_read_b64_tr_b16 v[58:59], v22 offset:45056
    v_exp_f32 v120, v120
    v_exp_f32 v121, v121
    v_exp_f32 v122, v122
    s_waitcnt lgkmcnt(10)
    v_mfma_f32_16x16x32_bf16 v[232:235], v[68:71], v[80:83], v[232:235]
    v_exp_f32 v123, v123
    v_cvt_pk_bf16_f32 v90, v120, v121
    v_cvt_pk_bf16_f32 v91, v122, v123
    v_cvt_pk_bf16_f32 v124, 0, v124
    s_nop 0
    v_mfma_f32_16x16x32_bf16 v[236:239], v[68:71], v[84:87], v[236:239]
    ds_read_b64_tr_b16 v[60:61], v23 offset:40960
    ds_read_b64_tr_b16 v[62:63], v23 offset:45056
    v_cvt_pk_bf16_f32 v125, 0, v125
    v_cvt_pk_bf16_f32 v126, 0, v126
    v_cvt_pk_bf16_f32 v127, 0, v127
    v_mul_f32 v124, s34, v124
    s_waitcnt lgkmcnt(10)
    v_mfma_f32_16x16x32_bf16 v[240:243], v[72:75], v[80:83], v[240:243]
    v_mul_f32 v125, s34, v125
    v_mul_f32 v126, s34, v126
    v_mul_f32 v127, s34, v127
    v_mfma_f32_16x16x32_bf16 v[244:247], v[72:75], v[84:87], v[244:247]
    ds_read_b64_tr_b16 v[64:65], v24 offset:40960
    ds_read_b64_tr_b16 v[66:67], v24 offset:45056
    v_cvt_pk_bf16_f32 v124, 0, v124
    v_cvt_pk_bf16_f32 v125, 0, v125
    v_cvt_pk_bf16_f32 v126, 0, v126
    v_cvt_pk_bf16_f32 v127, 0, v127
    s_waitcnt lgkmcnt(10)
    v_mfma_f32_16x16x32_bf16 v[248:251], v[76:79], v[80:83], v[248:251]
    v_fma_f32 v124, v124, s32, -v3
    v_fma_f32 v125, v125, s32, -v3
    v_fma_f32 v126, v126, s32, -v3
    v_mfma_f32_16x16x32_bf16 v[252:255], v[76:79], v[84:87], v[252:255]
    ds_read_b64_tr_b16 v[68:69], v25 offset:40960
    ds_read_b64_tr_b16 v[70:71], v25 offset:45056
    v_fma_f32 v127, v127, s32, -v3
    v_exp_f32 v124, v124
    v_exp_f32 v125, v125
    v_exp_f32 v126, v126
    v_mfma_f32_16x16x32_bf16 v[32:35], v[12:15], v[80:83], v[32:35]
    v_exp_f32 v127, v127
    v_cvt_pk_bf16_f32 v94, v124, v125
    v_cvt_pk_bf16_f32 v95, v126, v127
    s_nop 1
    v_mfma_f32_16x16x32_bf16 v[36:39], v[12:15], v[84:87], v[36:39]
    s_waitcnt lgkmcnt(10)
    v_mfma_f32_16x16x32_bf16 v[192:195], v[48:51], v[88:91], v[192:195]
    v_mfma_f32_16x16x32_bf16 v[196:199], v[48:51], v[92:95], v[196:199]
    ds_read_b64_tr_b16 v[72:73], v26 offset:40960
    ds_read_b64_tr_b16 v[74:75], v26 offset:45056
    s_setprio 0
    s_waitcnt lgkmcnt(10)
    v_mfma_f32_16x16x32_bf16 v[200:203], v[52:55], v[88:91], v[200:203]
    v_max3_f32 v4, v128, v129, v130
    v_max3_f32 v5, v132, v133, v134
    v_mfma_f32_16x16x32_bf16 v[204:207], v[52:55], v[92:95], v[204:207]
    ds_read_b64_tr_b16 v[76:77], v27 offset:40960
    ds_read_b64_tr_b16 v[78:79], v27 offset:45056
    v_max3_f32 v4, v4, v131, v136
    v_max3_f32 v5, v5, v135, v140
    s_waitcnt lgkmcnt(10)
    v_mfma_f32_16x16x32_bf16 v[208:211], v[56:59], v[88:91], v[208:211]
    v_max3_f32 v4, v4, v137, v138
    v_max3_f32 v5, v5, v141, v142
    v_mfma_f32_16x16x32_bf16 v[212:215], v[56:59], v[92:95], v[212:215]
    ds_read_b128 v[48:51], v16 offset:16384
    v_max3_f32 v4, v4, v139, v144
    s_waitcnt lgkmcnt(9)
    v_mfma_f32_16x16x32_bf16 v[216:219], v[60:63], v[88:91], v[216:219]
    v_max3_f32 v5, v5, v143, v148
    v_max3_f32 v4, v4, v145, v146
    v_mfma_f32_16x16x32_bf16 v[220:223], v[60:63], v[92:95], v[220:223]
    ds_read_b128 v[52:55], v17 offset:16384
    v_max3_f32 v5, v5, v149, v150
    v_max3_f32 v4, v4, v147, v152
    s_waitcnt lgkmcnt(8)
    v_mfma_f32_16x16x32_bf16 v[224:227], v[64:67], v[88:91], v[224:227]
    v_max3_f32 v5, v5, v151, v156
    v_max3_f32 v4, v4, v153, v154
    v_mfma_f32_16x16x32_bf16 v[228:231], v[64:67], v[92:95], v[228:231]
    ds_read_b128 v[56:59], v18 offset:16384
    v_max3_f32 v5, v5, v157, v158
    s_waitcnt lgkmcnt(7)
    v_mfma_f32_16x16x32_bf16 v[232:235], v[68:71], v[88:91], v[232:235]
    v_max_f32 v4, v4, v155
    v_max_f32 v5, v5, v159
    v_mfma_f32_16x16x32_bf16 v[236:239], v[68:71], v[92:95], v[236:239]
    ds_read_b128 v[60:63], v19 offset:16384
    s_nop 1
    v_permlane32_swap_b32 v4, v5
    s_waitcnt lgkmcnt(6)
    v_mfma_f32_16x16x32_bf16 v[240:243], v[72:75], v[88:91], v[240:243]
    v_max_f32 v4, v4, v5
    v_mov_b32 v6, v4
    v_mfma_f32_16x16x32_bf16 v[244:247], v[72:75], v[92:95], v[244:247]
    ds_read_b128 v[64:67], v16 offset:20480
    v_add_f32 v5, 0x41000000, v1
    s_waitcnt lgkmcnt(5)
    v_mfma_f32_16x16x32_bf16 v[248:251], v[76:79], v[88:91], v[248:251]
    s_nop 0
    v_permlane16_swap_b32 v4, v6
    v_mfma_f32_16x16x32_bf16 v[252:255], v[76:79], v[92:95], v[252:255]
    ds_read_b128 v[68:71], v17 offset:20480
    v_max_f32 v4, v4, v6
    v_cvt_pk_bf16_f32 v4, 0, v4
    v_mfma_f32_16x16x32_bf16 v[32:35], v[12:15], v[88:91], v[32:35]
    v_mul_f32 v4, s34, v4
    v_cvt_pk_bf16_f32 v4, 0, v4
    v_mfma_f32_16x16x32_bf16 v[36:39], v[12:15], v[92:95], v[36:39]
    v_mul_f32 v4, s32, v4
    v_cmp_gt_f32 vcc, v4, v5
    s_nop 1
    s_cbranch_vccz L_k3_skip4
    s_nop 15
    v_max_f32 v4, v4, v1
    v_sub_f32 v5, v1, v4
    v_exp_f32 v5, v5
    v_mov_b32 v1, v4
    v_mov_b32 v2, v4
    v_mov_b32 v3, v4
    v_mov_b32 v6, v5
    s_nop 1
    v_permlane32_swap_b32 v2, v3
    v_permlane32_swap_b32 v5, v6
    s_nop 1
    v_mul_f32 v32, v32, v5
    v_mul_f32 v36, v36, v6
    v_mul_f32 v192, v192, v5
    v_mul_f32 v193, v193, v5
    v_mul_f32 v194, v194, v5
    v_mul_f32 v195, v195, v5
    v_mul_f32 v196, v196, v6
    v_mul_f32 v197, v197, v6
    v_mul_f32 v198, v198, v6
    v_mul_f32 v199, v199, v6
    v_mul_f32 v200, v200, v5
    v_mul_f32 v201, v201, v5
    v_mul_f32 v202, v202, v5
    v_mul_f32 v203, v203, v5
    v_mul_f32 v204, v204, v6
    v_mul_f32 v205, v205, v6
    v_mul_f32 v206, v206, v6
    v_mul_f32 v207, v207, v6
    v_mul_f32 v208, v208, v5
    v_mul_f32 v209, v209, v5
    v_mul_f32 v210, v210, v5
    v_mul_f32 v211, v211, v5
    v_mul_f32 v212, v212, v6
    v_mul_f32 v213, v213, v6
    v_mul_f32 v214, v214, v6
    v_mul_f32 v215, v215, v6
    v_mul_f32 v216, v216, v5
    v_mul_f32 v217, v217, v5
    v_mul_f32 v218, v218, v5
    v_mul_f32 v219, v219, v5
    v_mul_f32 v220, v220, v6
    v_mul_f32 v221, v221, v6
    v_mul_f32 v222, v222, v6
    v_mul_f32 v223, v223, v6
    v_mul_f32 v224, v224, v5
    v_mul_f32 v225, v225, v5
    v_mul_f32 v226, v226, v5
    v_mul_f32 v227, v227, v5
    v_mul_f32 v228, v228, v6
    v_mul_f32 v229, v229, v6
    v_mul_f32 v230, v230, v6
    v_mul_f32 v231, v231, v6
    v_mul_f32 v232, v232, v5
    v_mul_f32 v233, v233, v5
    v_mul_f32 v234, v234, v5
    v_mul_f32 v235, v235, v5
    v_mul_f32 v236, v236, v6
    v_mul_f32 v237, v237, v6
    v_mul_f32 v238, v238, v6
    v_mul_f32 v239, v239, v6
    v_mul_f32 v240, v240, v5
    v_mul_f32 v241, v241, v5
    v_mul_f32 v242, v242, v5
    v_mul_f32 v243, v243, v5
    v_mul_f32 v244, v244, v6
    v_mul_f32 v245, v245, v6
    v_mul_f32 v246, v246, v6
    v_mul_f32 v247, v247, v6
    v_mul_f32 v248, v248, v5
    v_mul_f32 v249, v249, v5
    v_mul_f32 v250, v250, v5
    v_mul_f32 v251, v251, v5
    v_mul_f32 v252, v252, v6
    v_mul_f32 v253, v253, v6
    v_mul_f32 v254, v254, v6
    v_mul_f32 v255, v255, v6
    s_nop 1
L_k3_skip4:
    s_waitcnt vmcnt(0)
    s_barrier
    s_waitcnt lgkmcnt(5)
    v_mfma_f32_16x16x32_bf16 v[96:99], v[48:51], v[160:163], 0
    s_setprio 3
    v_cvt_pk_bf16_f32 v128, 0, v128
    v_cvt_pk_bf16_f32 v129, 0, v129
    v_cvt_pk_bf16_f32 v130, 0, v130
    v_cvt_pk_bf16_f32 v131, 0, v131
    v_mfma_f32_16x16x32_bf16 v[100:103], v[48:51], v[176:179], 0
    ds_read_b128 v[72:75], v18 offset:20480
    v_mul_f32 v128, s34, v128
    v_mul_f32 v129, s34, v129
    v_mul_f32 v130, s34, v130
    v_mul_f32 v131, s34, v131
    s_waitcnt lgkmcnt(5)
    v_mfma_f32_16x16x32_bf16 v[96:99], v[52:55], v[164:167], v[96:99]
    v_cvt_pk_bf16_f32 v128, 0, v128
    v_cvt_pk_bf16_f32 v129, 0, v129
    v_cvt_pk_bf16_f32 v130, 0, v130
    s_mov_b32 m0, s37
    s_nop 0
    buffer_load_dwordx4 v28, s[8:11], s35 offen lds
    buffer_load_dwordx4 v29, s[8:11], s35 offen offset:1024 lds
    s_add_u32 s35, s35, 16384
    v_mfma_f32_16x16x32_bf16 v[100:103], v[52:55], v[180:183], v[100:103]
    ds_read_b128 v[76:79], v19 offset:20480
    v_cvt_pk_bf16_f32 v131, 0, v131
    v_fma_f32 v128, v128, s32, -v2
    v_fma_f32 v129, v129, s32, -v2
    v_fma_f32 v130, v130, s32, -v2
    s_waitcnt lgkmcnt(5)
    v_mfma_f32_16x16x32_bf16 v[96:99], v[56:59], v[168:171], v[96:99]
    v_fma_f32 v131, v131, s32, -v2
    v_exp_f32 v128, v128
    v_exp_f32 v129, v129
    v_mfma_f32_16x16x32_bf16 v[100:103], v[56:59], v[184:187], v[100:103]
    ds_read_b128 v[48:51], v16 offset:24576
    v_exp_f32 v130, v130
    v_exp_f32 v131, v131
    v_cvt_pk_bf16_f32 v80, v128, v129
    v_cvt_pk_bf16_f32 v81, v130, v131
    s_waitcnt lgkmcnt(5)
    v_mfma_f32_16x16x32_bf16 v[96:99], v[60:63], v[172:175], v[96:99]
    v_cvt_pk_bf16_f32 v132, 0, v132
    v_cvt_pk_bf16_f32 v133, 0, v133
    v_cvt_pk_bf16_f32 v134, 0, v134
    v_cvt_pk_bf16_f32 v135, 0, v135
    s_mov_b32 m0, s42
    s_nop 0
    buffer_load_dwordx4 v30, s[12:15], s36 offen lds
    buffer_load_dwordx4 v31, s[12:15], s36 offen offset:1024 lds
    s_add_u32 s36, s36, 16384
    v_mfma_f32_16x16x32_bf16 v[100:103], v[60:63], v[188:191], v[100:103]
    ds_read_b128 v[52:55], v17 offset:24576
    v_mul_f32 v132, s34, v132
    v_mul_f32 v133, s34, v133
    v_mul_f32 v134, s34, v134
    s_waitcnt lgkmcnt(5)
    v_mfma_f32_16x16x32_bf16 v[104:107], v[64:67], v[160:163], 0
    v_mul_f32 v135, s34, v135
    v_cvt_pk_bf16_f32 v132, 0, v132
    v_cvt_pk_bf16_f32 v133, 0, v133
    v_cvt_pk_bf16_f32 v134, 0, v134
    v_mfma_f32_16x16x32_bf16 v[108:111], v[64:67], v[176:179], 0
    ds_read_b128 v[56:59], v18 offset:24576
    v_cvt_pk_bf16_f32 v135, 0, v135
    v_fma_f32 v132, v132, s32, -v3
    v_fma_f32 v133, v133, s32, -v3
    s_waitcnt lgkmcnt(5)
    v_mfma_f32_16x16x32_bf16 v[104:107], v[68:71], v[164:167], v[104:107]
    v_fma_f32 v134, v134, s32, -v3
    v_fma_f32 v135, v135, s32, -v3
    v_exp_f32 v132, v132
    v_exp_f32 v133, v133
    v_mfma_f32_16x16x32_bf16 v[108:111], v[68:71], v[180:183], v[108:111]
    ds_read_b128 v[60:63], v19 offset:24576
    v_exp_f32 v134, v134
    v_exp_f32 v135, v135
    v_cvt_pk_bf16_f32 v84, v132, v133
    v_cvt_pk_bf16_f32 v85, v134, v135
    s_waitcnt lgkmcnt(5)
    v_mfma_f32_16x16x32_bf16 v[104:107], v[72:75], v[168:171], v[104:107]
    v_cvt_pk_bf16_f32 v136, 0, v136
    v_cvt_pk_bf16_f32 v137, 0, v137
    v_cvt_pk_bf16_f32 v138, 0, v138
    v_mfma_f32_16x16x32_bf16 v[108:111], v[72:75], v[184:187], v[108:111]
    ds_read_b128 v[64:67], v16 offset:28672
    v_cvt_pk_bf16_f32 v139, 0, v139
    v_mul_f32 v136, s34, v136
    v_mul_f32 v137, s34, v137
    v_mul_f32 v138, s34, v138
    s_waitcnt lgkmcnt(5)
    v_mfma_f32_16x16x32_bf16 v[104:107], v[76:79], v[172:175], v[104:107]
    v_mul_f32 v139, s34, v139
    v_cvt_pk_bf16_f32 v136, 0, v136
    v_cvt_pk_bf16_f32 v137, 0, v137
    v_mfma_f32_16x16x32_bf16 v[108:111], v[76:79], v[188:191], v[108:111]
    ds_read_b128 v[68:71], v17 offset:28672
    v_cvt_pk_bf16_f32 v138, 0, v138
    v_cvt_pk_bf16_f32 v139, 0, v139
    v_fma_f32 v136, v136, s32, -v2
    v_fma_f32 v137, v137, s32, -v2
    s_waitcnt lgkmcnt(5)
    v_mfma_f32_16x16x32_bf16 v[112:115], v[48:51], v[160:163], 0
    v_fma_f32 v138, v138, s32, -v2
    v_fma_f32 v139, v139, s32, -v2
    v_exp_f32 v136, v136
    v_exp_f32 v137, v137
    v_mfma_f32_16x16x32_bf16 v[116:119], v[48:51], v[176:179], 0
    ds_read_b128 v[72:75], v18 offset:28672
    s_setprio 2
    v_exp_f32 v138, v138
    v_exp_f32 v139, v139
    v_cvt_pk_bf16_f32 v82, v136, v137
    s_waitcnt lgkmcnt(5)
    v_mfma_f32_16x16x32_bf16 v[112:115], v[52:55], v[164:167], v[112:115]
    v_cvt_pk_bf16_f32 v83, v138, v139
    v_cvt_pk_bf16_f32 v140, 0, v140
    v_cvt_pk_bf16_f32 v141, 0, v141
    v_cvt_pk_bf16_f32 v142, 0, v142
    v_mfma_f32_16x16x32_bf16 v[116:119], v[52:55], v[180:183], v[116:119]
    ds_read_b128 v[76:79], v19 offset:28672
    v_cvt_pk_bf16_f32 v143, 0, v143
    v_mul_f32 v140, s34, v140
    v_mul_f32 v141, s34, v141
    s_waitcnt lgkmcnt(5)
    v_mfma_f32_16x16x32_bf16 v[112:115], v[56:59], v[168:171], v[112:115]
    v_mul_f32 v142, s34, v142
    v_mul_f32 v143, s34, v143
    v_cvt_pk_bf16_f32 v140, 0, v140
    v_cvt_pk_bf16_f32 v141, 0, v141
    v_mfma_f32_16x16x32_bf16 v[116:119], v[56:59], v[184:187], v[116:119]
    ds_read_b64_tr_b16 v[48:49], v20 offset:0
    ds_read_b64_tr_b16 v[50:51], v20 offset:4096
    v_cvt_pk_bf16_f32 v142, 0, v142
    v_cvt_pk_bf16_f32 v143, 0, v143
    v_fma_f32 v140, v140, s32, -v3
    v_fma_f32 v141, v141, s32, -v3
    s_waitcnt lgkmcnt(6)
    v_mfma_f32_16x16x32_bf16 v[112:115], v[60:63], v[172:175], v[112:115]
    v_fma_f32 v142, v142, s32, -v3
    v_fma_f32 v143, v143, s32, -v3
    v_exp_f32 v140, v140
    v_mfma_f32_16x16x32_bf16 v[116:119], v[60:63], v[188:191], v[116:119]
    ds_read_b64_tr_b16 v[52:53], v21 offset:0
    ds_read_b64_tr_b16 v[54:55], v21 offset:4096
    v_exp_f32 v141, v141
    v_exp_f32 v142, v142
    v_exp_f32 v143, v143
    v_cvt_pk_bf16_f32 v86, v140, v141
    s_waitcnt lgkmcnt(7)
    v_mfma_f32_16x16x32_bf16 v[120:123], v[64:67], v[160:163], 0
    v_cvt_pk_bf16_f32 v87, v142, v143
    v_cvt_pk_bf16_f32 v144, 0, v144
    v_cvt_pk_bf16_f32 v145, 0, v145
    v_mfma_f32_16x16x32_bf16 v[124:127], v[64:67], v[176:179], 0
    ds_read_b64_tr_b16 v[56:57], v22 offset:0
    ds_read_b64_tr_b16 v[58:59], v22 offset:4096
    v_cvt_pk_bf16_f32 v146, 0, v146
    v_cvt_pk_bf16_f32 v147, 0, v147
    v_mul_f32 v144, s34, v144
    v_mul_f32 v145, s34, v145
    s_waitcnt lgkmcnt(8)
    v_mfma_f32_16x16x32_bf16 v[120:123], v[68:71], v[164:167], v[120:123]
    v_mul_f32 v146, s34, v146
    v_mul_f32 v147, s34, v147
    v_cvt_pk_bf16_f32 v144, 0, v144
    v_mfma_f32_16x16x32_bf16 v[124:127], v[68:71], v[180:183], v[124:127]
    ds_read_b64_tr_b16 v[60:61], v23 offset:0
    ds_read_b64_tr_b16 v[62:63], v23 offset:4096
    v_cvt_pk_bf16_f32 v145, 0, v145
    v_cvt_pk_bf16_f32 v146, 0, v146
    v_cvt_pk_bf16_f32 v147, 0, v147
    v_fma_f32 v144, v144, s32, -v2
    s_waitcnt lgkmcnt(9)
    v_mfma_f32_16x16x32_bf16 v[120:123], v[72:75], v[168:171], v[120:123]
    v_fma_f32 v145, v145, s32, -v2
    v_fma_f32 v146, v146, s32, -v2
    v_fma_f32 v147, v147, s32, -v2
    v_exp_f32 v144, v144
    v_mfma_f32_16x16x32_bf16 v[124:127], v[72:75], v[184:187], v[124:127]
    ds_read_b64_tr_b16 v[64:65], v24 offset:0
    ds_read_b64_tr_b16 v[66:67], v24 offset:4096
    v_exp_f32 v145, v145
    v_exp_f32 v146, v146
    v_exp_f32 v147, v147
    s_waitcnt lgkmcnt(10)
    v_mfma_f32_16x16x32_bf16 v[120:123], v[76:79], v[172:175], v[120:123]
    v_cvt_pk_bf16_f32 v88, v144, v145
    v_cvt_pk_bf16_f32 v89, v146, v147
    v_cvt_pk_bf16_f32 v148, 0, v148
    v_cvt_pk_bf16_f32 v149, 0, v149
    v_mfma_f32_16x16x32_bf16 v[124:127], v[76:79], v[188:191], v[124:127]
    ds_read_b64_tr_b16 v[68:69], v25 offset:0
    ds_read_b64_tr_b16 v[70:71], v25 offset:4096
    v_cvt_pk_bf16_f32 v150, 0, v150
    v_cvt_pk_bf16_f32 v151, 0, v151
    v_mul_f32 v148, s34, v148
    s_waitcnt lgkmcnt(10)
    v_mfma_f32_16x16x32_bf16 v[192:195], v[48:51], v[80:83], v[192:195]
    v_mul_f32 v149, s34, v149
    v_mul_f32 v150, s34, v150
    v_mul_f32 v151, s34, v151
    v_cvt_pk_bf16_f32 v148, 0, v148
    v_mfma_f32_16x16x32_bf16 v[196:199], v[48:51], v[84:87], v[196:199]
    ds_read_b64_tr_b16 v[72:73], v26 offset:0
    ds_read_b64_tr_b16 v[74:75], v26 offset:4096
    v_cvt_pk_bf16_f32 v149, 0, v149
    v_cvt_pk_bf16_f32 v150, 0, v150
    v_cvt_pk_bf16_f32 v151, 0, v151
    v_fma_f32 v148, v148, s32, -v3
    s_waitcnt lgkmcnt(10)
    v_mfma_f32_16x16x32_bf16 v[200:203], v[52:55], v[80:83], v[200:203]
    s_setprio 1
    v_fma_f32 v149, v149, s32, -v3
    v_fma_f32 v150, v150, s32, -v3
    v_fma_f32 v151, v151, s32, -v3
    v_mfma_f32_16x16x32_bf16 v[204:207], v[52:55], v[84:87], v[204:207]
    ds_read_b64_tr_b16 v[76:77], v27 offset:0
    ds_read_b64_tr_b16 v[78:79], v27 offset:4096
    v_exp_f32 v148, v148
    v_exp_f32 v149, v149
    v_exp_f32 v150, v150
    v_exp_f32 v151, v151
    s_waitcnt lgkmcnt(10)
    v_mfma_f32_16x16x32_bf16 v[208:211], v[56:59], v[80:83], v[208:211]
    v_cvt_pk_bf16_f32 v92, v148, v149
    v_cvt_pk_bf16_f32 v93, v150, v151
    v_cvt_pk_bf16_f32 v152, 0, v152
    s_nop 0
    v_mfma_f32_16x16x32_bf16 v[212:215], v[56:59], v[84:87], v[212:215]
    ds_read_b64_tr_b16 v[48:49], v20 offset:8192
    ds_read_b64_tr_b16 v[50:51], v20 offset:12288
    v_cvt_pk_bf16_f32 v153, 0, v153
    v_cvt_pk_bf16_f32 v154, 0, v154
    v_cvt_pk_bf16_f32 v155, 0, v155
    v_mul_f32 v152, s34, v152
    s_waitcnt lgkmcnt(10)
    v_mfma_f32_16x16x32_bf16 v[216:219], v[60:63], v[80:83], v[216:219]
    v_mul_f32 v153, s34, v153
    v_mul_f32 v154, s34, v154
    v_mul_f32 v155, s34, v155
    v_cvt_pk_bf16_f32 v152, 0, v152
    v_mfma_f32_16x16x32_bf16 v[220:223], v[60:63], v[84:87], v[220:223]
    ds_read_b64_tr_b16 v[52:53], v21 offset:8192
    ds_read_b64_tr_b16 v[54:55], v21 offset:12288
    v_cvt_pk_bf16_f32 v153, 0, v153
    v_cvt_pk_bf16_f32 v154, 0, v154
    v_cvt_pk_bf16_f32 v155, 0, v155
    s_waitcnt lgkmcnt(10)
    v_mfma_f32_16x16x32_bf16 v[224:227], v[64:67], v[80:83], v[224:227]
    v_fma_f32 v152, v152, s32, -v2
    v_fma_f32 v153, v153, s32, -v2
    v_fma_f32 v154, v154, s32, -v2
    v_fma_f32 v155, v155, s32, -v2
    v_mfma_f32_16x16x32_bf16 v[228:231], v[64:67], v[84:87], v[228:231]
    ds_read_b64_tr_b16 v[56:57], v22 offset:8192
    ds_read_b64_tr_b16 v[58:59], v22 offset:12288
    v_exp_f32 v152, v152
    v_exp_f32 v153, v153
    v_exp_f32 v154, v154
    s_waitcnt lgkmcnt(10)
    v_mfma_f32_16x16x32_bf16 v[232:235], v[68:71], v[80:83], v[232:235]
    v_exp_f32 v155, v155
    v_cvt_pk_bf16_f32 v90, v152, v153
    v_cvt_pk_bf16_f32 v91, v154, v155
    v_cvt_pk_bf16_f32 v156, 0, v156
    s_nop 0
    v_mfma_f32_16x16x32_bf16 v[236:239], v[68:71], v[84:87], v[236:239]
    ds_read_b64_tr_b16 v[60:61], v23 offset:8192
    ds_read_b64_tr_b16 v[62:63], v23 offset:12288
    v_cvt_pk_bf16_f32 v157, 0, v157
    v_cvt_pk_bf16_f32 v158, 0, v158
    v_cvt_pk_bf16_f32 v159, 0, v159
    v_mul_f32 v156, s34, v156
    s_waitcnt lgkmcnt(10)
    v_mfma_f32_16x16x32_bf16 v[240:243], v[72:75], v[80:83], v[240:243]
    v_mul_f32 v157, s34, v157
    v_mul_f32 v158, s34, v158
    v_mul_f32 v159, s34, v159
    v_mfma_f32_16x16x32_bf16 v[244:247], v[72:75], v[84:87], v[244:247]
    ds_read_b64_tr_b16 v[64:65], v24 offset:8192
    ds_read_b64_tr_b16 v[66:67], v24 offset:12288
    v_cvt_pk_bf16_f32 v156, 0, v156
    v_cvt_pk_bf16_f32 v157, 0, v157
    v_cvt_pk_bf16_f32 v158, 0, v158
    v_cvt_pk_bf16_f32 v159, 0, v159
    s_waitcnt lgkmcnt(10)
    v_mfma_f32_16x16x32_bf16 v[248:251], v[76:79], v[80:83], v[248:251]
    v_fma_f32 v156, v156, s32, -v3
    v_fma_f32 v157, v157, s32, -v3
    v_fma_f32 v158, v158, s32, -v3
    v_mfma_f32_16x16x32_bf16 v[252:255], v[76:79], v[84:87], v[252:255]
    ds_read_b64_tr_b16 v[68:69], v25 offset:8192
    ds_read_b64_tr_b16 v[70:71], v25 offset:12288
    v_fma_f32 v159, v159, s32, -v3
    v_exp_f32 v156, v156
    v_exp_f32 v157, v157
    v_exp_f32 v158, v158
    v_mfma_f32_16x16x32_bf16 v[32:35], v[12:15], v[80:83], v[32:35]
    v_exp_f32 v159, v159
    v_cvt_pk_bf16_f32 v94, v156, v157
    v_cvt_pk_bf16_f32 v95, v158, v159
    s_nop 1
    v_mfma_f32_16x16x32_bf16 v[36:39], v[12:15], v[84:87], v[36:39]
    s_waitcnt lgkmcnt(10)
    v_mfma_f32_16x16x32_bf16 v[192:195], v[48:51], v[88:91], v[192:195]
    v_mfma_f32_16x16x32_bf16 v[196:199], v[48:51], v[92:95], v[196:199]
    ds_read_b64_tr_b16 v[72:73], v26 offset:8192
    ds_read_b64_tr_b16 v[74:75], v26 offset:12288
    s_setprio 0
    s_waitcnt lgkmcnt(10)
    v_mfma_f32_16x16x32_bf16 v[200:203], v[52:55], v[88:91], v[200:203]
    v_max3_f32 v4, v96, v97, v98
    v_max3_f32 v5, v100, v101, v102
    v_mfma_f32_16x16x32_bf16 v[204:207], v[52:55], v[92:95], v[204:207]
    ds_read_b64_tr_b16 v[76:77], v27 offset:8192
    ds_read_b64_tr_b16 v[78:79], v27 offset:12288
    v_max3_f32 v4, v4, v99, v104
    v_max3_f32 v5, v5, v103, v108
    s_waitcnt lgkmcnt(10)
    v_mfma_f32_16x16x32_bf16 v[208:211], v[56:59], v[88:91], v[208:211]
    v_max3_f32 v4, v4, v105, v106
    v_max3_f32 v5, v5, v109, v110
    v_mfma_f32_16x16x32_bf16 v[212:215], v[56:59], v[92:95], v[212:215]
    ds_read_b128 v[48:51], v16 offset:32768
    v_max3_f32 v4, v4, v107, v112
    s_waitcnt lgkmcnt(9)
    v_mfma_f32_16x16x32_bf16 v[216:219], v[60:63], v[88:91], v[216:219]
    v_max3_f32 v5, v5, v111, v116
    v_max3_f32 v4, v4, v113, v114
    v_mfma_f32_16x16x32_bf16 v[220:223], v[60:63], v[92:95], v[220:223]
    ds_read_b128 v[52:55], v17 offset:32768
    v_max3_f32 v5, v5, v117, v118
    v_max3_f32 v4, v4, v115, v120
    s_waitcnt lgkmcnt(8)
    v_mfma_f32_16x16x32_bf16 v[224:227], v[64:67], v[88:91], v[224:227]
    v_max3_f32 v5, v5, v119, v124
    v_max3_f32 v4, v4, v121, v122
    v_mfma_f32_16x16x32_bf16 v[228:231], v[64:67], v[92:95], v[228:231]
    ds_read_b128 v[56:59], v18 offset:32768
    v_max3_f32 v5, v5, v125, v126
    s_waitcnt lgkmcnt(7)
    v_mfma_f32_16x16x32_bf16 v[232:235], v[68:71], v[88:91], v[232:235]
    v_max_f32 v4, v4, v123
    v_max_f32 v5, v5, v127
    v_mfma_f32_16x16x32_bf16 v[236:239], v[68:71], v[92:95], v[236:239]
    ds_read_b128 v[60:63], v19 offset:32768
    s_nop 1
    v_permlane32_swap_b32 v4, v5
    s_waitcnt lgkmcnt(6)
    v_mfma_f32_16x16x32_bf16 v[240:243], v[72:75], v[88:91], v[240:243]
    v_max_f32 v4, v4, v5
    v_mov_b32 v6, v4
    v_mfma_f32_16x16x32_bf16 v[244:247], v[72:75], v[92:95], v[244:247]
    ds_read_b128 v[64:67], v16 offset:36864
    v_add_f32 v5, 0x41000000, v1
    s_waitcnt lgkmcnt(5)
    v_mfma_f32_16x16x32_bf16 v[248:251], v[76:79], v[88:91], v[248:251]
    s_nop 0
    v_permlane16_swap_b32 v4, v6
    v_mfma_f32_16x16x32_bf16 v[252:255], v[76:79], v[92:95], v[252:255]
    ds_read_b128 v[68:71], v17 offset:36864
    v_max_f32 v4, v4, v6
    v_cvt_pk_bf16_f32 v4, 0, v4
    v_mfma_f32_16x16x32_bf16 v[32:35], v[12:15], v[88:91], v[32:35]
    v_mul_f32 v4, s34, v4
    v_cvt_pk_bf16_f32 v4, 0, v4
    v_mfma_f32_16x16x32_bf16 v[36:39], v[12:15], v[92:95], v[36:39]
    v_mul_f32 v4, s32, v4
    v_cmp_gt_f32 vcc, v4, v5
    s_nop 1
    s_cbranch_vccz L_k3_skip5
    s_nop 15
    v_max_f32 v4, v4, v1
    v_sub_f32 v5, v1, v4
    v_exp_f32 v5, v5
    v_mov_b32 v1, v4
    v_mov_b32 v2, v4
    v_mov_b32 v3, v4
    v_mov_b32 v6, v5
    s_nop 1
    v_permlane32_swap_b32 v2, v3
    v_permlane32_swap_b32 v5, v6
    s_nop 1
    v_mul_f32 v32, v32, v5
    v_mul_f32 v36, v36, v6
    v_mul_f32 v192, v192, v5
    v_mul_f32 v193, v193, v5
    v_mul_f32 v194, v194, v5
    v_mul_f32 v195, v195, v5
    v_mul_f32 v196, v196, v6
    v_mul_f32 v197, v197, v6
    v_mul_f32 v198, v198, v6
    v_mul_f32 v199, v199, v6
    v_mul_f32 v200, v200, v5
    v_mul_f32 v201, v201, v5
    v_mul_f32 v202, v202, v5
    v_mul_f32 v203, v203, v5
    v_mul_f32 v204, v204, v6
    v_mul_f32 v205, v205, v6
    v_mul_f32 v206, v206, v6
    v_mul_f32 v207, v207, v6
    v_mul_f32 v208, v208, v5
    v_mul_f32 v209, v209, v5
    v_mul_f32 v210, v210, v5
    v_mul_f32 v211, v211, v5
    v_mul_f32 v212, v212, v6
    v_mul_f32 v213, v213, v6
    v_mul_f32 v214, v214, v6
    v_mul_f32 v215, v215, v6
    v_mul_f32 v216, v216, v5
    v_mul_f32 v217, v217, v5
    v_mul_f32 v218, v218, v5
    v_mul_f32 v219, v219, v5
    v_mul_f32 v220, v220, v6
    v_mul_f32 v221, v221, v6
    v_mul_f32 v222, v222, v6
    v_mul_f32 v223, v223, v6
    v_mul_f32 v224, v224, v5
    v_mul_f32 v225, v225, v5
    v_mul_f32 v226, v226, v5
    v_mul_f32 v227, v227, v5
    v_mul_f32 v228, v228, v6
    v_mul_f32 v229, v229, v6
    v_mul_f32 v230, v230, v6
    v_mul_f32 v231, v231, v6
    v_mul_f32 v232, v232, v5
    v_mul_f32 v233, v233, v5
    v_mul_f32 v234, v234, v5
    v_mul_f32 v235, v235, v5
    v_mul_f32 v236, v236, v6
    v_mul_f32 v237, v237, v6
    v_mul_f32 v238, v238, v6
    v_mul_f32 v239, v239, v6
    v_mul_f32 v240, v240, v5
    v_mul_f32 v241, v241, v5
    v_mul_f32 v242, v242, v5
    v_mul_f32 v243, v243, v5
    v_mul_f32 v244, v244, v6
    v_mul_f32 v245, v245, v6
    v_mul_f32 v246, v246, v6
    v_mul_f32 v247, v247, v6
    v_mul_f32 v248, v248, v5
    v_mul_f32 v249, v249, v5
    v_mul_f32 v250, v250, v5
    v_mul_f32 v251, v251, v5
    v_mul_f32 v252, v252, v6
    v_mul_f32 v253, v253, v6
    v_mul_f32 v254, v254, v6
    v_mul_f32 v255, v255, v6
    s_nop 1
L_k3_skip5:
    s_waitcnt vmcnt(0)
    s_barrier
    s_waitcnt lgkmcnt(5)
    v_mfma_f32_16x16x32_bf16 v[128:131], v[48:51], v[160:163], 0
    s_setprio 3
    v_cvt_pk_bf16_f32 v96, 0, v96
    v_cvt_pk_bf16_f32 v97, 0, v97
    v_cvt_pk_bf16_f32 v98, 0, v98
    v_cvt_pk_bf16_f32 v99, 0, v99
    v_mfma_f32_16x16x32_bf16 v[132:135], v[48:51], v[176:179], 0
    ds_read_b128 v[72:75], v18 offset:36864
    v_mul_f32 v96, s34, v96
    v_mul_f32 v97, s34, v97
    v_mul_f32 v98, s34, v98
    v_mul_f32 v99, s34, v99
    s_waitcnt lgkmcnt(5)
    v_mfma_f32_16x16x32_bf16 v[128:131], v[52:55], v[164:167], v[128:131]
    v_cvt_pk_bf16_f32 v96, 0, v96
    v_cvt_pk_bf16_f32 v97, 0, v97
    v_cvt_pk_bf16_f32 v98, 0, v98
    s_mov_b32 m0, s38
    s_nop 0
    buffer_load_dwordx4 v28, s[8:11], s35 offen lds
    buffer_load_dwordx4 v29, s[8:11], s35 offen offset:1024 lds
    s_add_u32 s35, s35, 16384
    v_mfma_f32_16x16x32_bf16 v[132:135], v[52:55], v[180:183], v[132:135]
    ds_read_b128 v[76:79], v19 offset:36864
    v_cvt_pk_bf16_f32 v99, 0, v99
    v_fma_f32 v96, v96, s32, -v2
    v_fma_f32 v97, v97, s32, -v2
    v_fma_f32 v98, v98, s32, -v2
    s_waitcnt lgkmcnt(5)
    v_mfma_f32_16x16x32_bf16 v[128:131], v[56:59], v[168:171], v[128:131]
    v_fma_f32 v99, v99, s32, -v2
    v_exp_f32 v96, v96
    v_exp_f32 v97, v97
    v_mfma_f32_16x16x32_bf16 v[132:135], v[56:59], v[184:187], v[132:135]
    ds_read_b128 v[48:51], v16 offset:40960
    v_exp_f32 v98, v98
    v_exp_f32 v99, v99
    v_cvt_pk_bf16_f32 v80, v96, v97
    v_cvt_pk_bf16_f32 v81, v98, v99
    s_waitcnt lgkmcnt(5)
    v_mfma_f32_16x16x32_bf16 v[128:131], v[60:63], v[172:175], v[128:131]
    v_cvt_pk_bf16_f32 v100, 0, v100
    v_cvt_pk_bf16_f32 v101, 0, v101
    v_cvt_pk_bf16_f32 v102, 0, v102
    v_cvt_pk_bf16_f32 v103, 0, v103
    s_mov_b32 m0, s40
    s_nop 0
    buffer_load_dwordx4 v30, s[12:15], s36 offen lds
    buffer_load_dwordx4 v31, s[12:15], s36 offen offset:1024 lds
    s_add_u32 s36, s36, 16384
    v_mfma_f32_16x16x32_bf16 v[132:135], v[60:63], v[188:191], v[132:135]
    ds_read_b128 v[52:55], v17 offset:40960
    v_mul_f32 v100, s34, v100
    v_mul_f32 v101, s34, v101
    v_mul_f32 v102, s34, v102
    s_waitcnt lgkmcnt(5)
    v_mfma_f32_16x16x32_bf16 v[136:139], v[64:67], v[160:163], 0
    v_mul_f32 v103, s34, v103
    v_cvt_pk_bf16_f32 v100, 0, v100
    v_cvt_pk_bf16_f32 v101, 0, v101
    v_cvt_pk_bf16_f32 v102, 0, v102
    v_mfma_f32_16x16x32_bf16 v[140:143], v[64:67], v[176:179], 0
    ds_read_b128 v[56:59], v18 offset:40960
    v_cvt_pk_bf16_f32 v103, 0, v103
    v_fma_f32 v100, v100, s32, -v3
    v_fma_f32 v101, v101, s32, -v3
    s_waitcnt lgkmcnt(5)
    v_mfma_f32_16x16x32_bf16 v[136:139], v[68:71], v[164:167], v[136:139]
    v_fma_f32 v102, v102, s32, -v3
    v_fma_f32 v103, v103, s32, -v3
    v_exp_f32 v100, v100
    v_exp_f32 v101, v101
    v_mfma_f32_16x16x32_bf16 v[140:143], v[68:71], v[180:183], v[140:143]
    ds_read_b128 v[60:63], v19 offset:40960
    v_exp_f32 v102, v102
    v_exp_f32 v103, v103
    v_cvt_pk_bf16_f32 v84, v100, v101
    v_cvt_pk_bf16_f32 v85, v102, v103
    s_waitcnt lgkmcnt(5)
    v_mfma_f32_16x16x32_bf16 v[136:139], v[72:75], v[168:171], v[136:139]
    v_cvt_pk_bf16_f32 v104, 0, v104
    v_cvt_pk_bf16_f32 v105, 0, v105
    v_cvt_pk_bf16_f32 v106, 0, v106
    v_mfma_f32_16x16x32_bf16 v[140:143], v[72:75], v[184:187], v[140:143]
    ds_read_b128 v[64:67], v16 offset:45056
    v_cvt_pk_bf16_f32 v107, 0, v107
    v_mul_f32 v104, s34, v104
    v_mul_f32 v105, s34, v105
    v_mul_f32 v106, s34, v106
    s_waitcnt lgkmcnt(5)
    v_mfma_f32_16x16x32_bf16 v[136:139], v[76:79], v[172:175], v[136:139]
    v_mul_f32 v107, s34, v107
    v_cvt_pk_bf16_f32 v104, 0, v104
    v_cvt_pk_bf16_f32 v105, 0, v105
    v_mfma_f32_16x16x32_bf16 v[140:143], v[76:79], v[188:191], v[140:143]
    ds_read_b128 v[68:71], v17 offset:45056
    v_cvt_pk_bf16_f32 v106, 0, v106
    v_cvt_pk_bf16_f32 v107, 0, v107
    v_fma_f32 v104, v104, s32, -v2
    v_fma_f32 v105, v105, s32, -v2
    s_waitcnt lgkmcnt(5)
    v_mfma_f32_16x16x32_bf16 v[144:147], v[48:51], v[160:163], 0
    v_fma_f32 v106, v106, s32, -v2
    v_fma_f32 v107, v107, s32, -v2
    v_exp_f32 v104, v104
    v_exp_f32 v105, v105
    v_mfma_f32_16x16x32_bf16 v[148:151], v[48:51], v[176:179], 0
    ds_read_b128 v[72:75], v18 offset:45056
    s_setprio 2
    v_exp_f32 v106, v106
    v_exp_f32 v107, v107
    v_cvt_pk_bf16_f32 v82, v104, v105
    s_waitcnt lgkmcnt(5)
    v_mfma_f32_16x16x32_bf16 v[144:147], v[52:55], v[164:167], v[144:147]
    v_cvt_pk_bf16_f32 v83, v106, v107
    v_cvt_pk_bf16_f32 v108, 0, v108
    v_cvt_pk_bf16_f32 v109, 0, v109
    v_cvt_pk_bf16_f32 v110, 0, v110
    v_mfma_f32_16x16x32_bf16 v[148:151], v[52:55], v[180:183], v[148:151]
    ds_read_b128 v[76:79], v19 offset:45056
    v_cvt_pk_bf16_f32 v111, 0, v111
    v_mul_f32 v108, s34, v108
    v_mul_f32 v109, s34, v109
    s_waitcnt lgkmcnt(5)
    v_mfma_f32_16x16x32_bf16 v[144:147], v[56:59], v[168:171], v[144:147]
    v_mul_f32 v110, s34, v110
    v_mul_f32 v111, s34, v111
    v_cvt_pk_bf16_f32 v108, 0, v108
    v_cvt_pk_bf16_f32 v109, 0, v109
    v_mfma_f32_16x16x32_bf16 v[148:151], v[56:59], v[184:187], v[148:151]
    ds_read_b64_tr_b16 v[48:49], v20 offset:16384
    ds_read_b64_tr_b16 v[50:51], v20 offset:20480
    v_cvt_pk_bf16_f32 v110, 0, v110
    v_cvt_pk_bf16_f32 v111, 0, v111
    v_fma_f32 v108, v108, s32, -v3
    v_fma_f32 v109, v109, s32, -v3
    s_waitcnt lgkmcnt(6)
    v_mfma_f32_16x16x32_bf16 v[144:147], v[60:63], v[172:175], v[144:147]
    v_fma_f32 v110, v110, s32, -v3
    v_fma_f32 v111, v111, s32, -v3
    v_exp_f32 v108, v108
    v_mfma_f32_16x16x32_bf16 v[148:151], v[60:63], v[188:191], v[148:151]
    ds_read_b64_tr_b16 v[52:53], v21 offset:16384
    ds_read_b64_tr_b16 v[54:55], v21 offset:20480
    v_exp_f32 v109, v109
    v_exp_f32 v110, v110
    v_exp_f32 v111, v111
    v_cvt_pk_bf16_f32 v86, v108, v109
    s_waitcnt lgkmcnt(7)
    v_mfma_f32_16x16x32_bf16 v[152:155], v[64:67], v[160:163], 0
    v_cvt_pk_bf16_f32 v87, v110, v111
    v_cvt_pk_bf16_f32 v112, 0, v112
    v_cvt_pk_bf16_f32 v113, 0, v113
    v_mfma_f32_16x16x32_bf16 v[156:159], v[64:67], v[176:179], 0
    ds_read_b64_tr_b16 v[56:57], v22 offset:16384
    ds_read_b64_tr_b16 v[58:59], v22 offset:20480
    v_cvt_pk_bf16_f32 v114, 0, v114
    v_cvt_pk_bf16_f32 v115, 0, v115
    v_mul_f32 v112, s34, v112
    v_mul_f32 v113, s34, v113
    s_waitcnt lgkmcnt(8)
    v_mfma_f32_16x16x32_bf16 v[152:155], v[68:71], v[164:167], v[152:155]
    v_mul_f32 v114, s34, v114
    v_mul_f32 v115, s34, v115
    v_cvt_pk_bf16_f32 v112, 0, v112
    v_mfma_f32_16x16x32_bf16 v[156:159], v[68:71], v[180:183], v[156:159]
    ds_read_b64_tr_b16 v[60:61], v23 offset:16384
    ds_read_b64_tr_b16 v[62:63], v23 offset:20480
    v_cvt_pk_bf16_f32 v113, 0, v113
    v_cvt_pk_bf16_f32 v114, 0, v114
    v_cvt_pk_bf16_f32 v115, 0, v115
    v_fma_f32 v112, v112, s32, -v2
    s_waitcnt lgkmcnt(9)
    v_mfma_f32_16x16x32_bf16 v[152:155], v[72:75], v[168:171], v[152:155]
    v_fma_f32 v113, v113, s32, -v2
    v_fma_f32 v114, v114, s32, -v2
    v_fma_f32 v115, v115, s32, -v2
    v_exp_f32 v112, v112
    v_mfma_f32_16x16x32_bf16 v[156:159], v[72:75], v[184:187], v[156:159]
    ds_read_b64_tr_b16 v[64:65], v24 offset:16384
    ds_read_b64_tr_b16 v[66:67], v24 offset:20480
    v_exp_f32 v113, v113
    v_exp_f32 v114, v114
    v_exp_f32 v115, v115
    s_waitcnt lgkmcnt(10)
    v_mfma_f32_16x16x32_bf16 v[152:155], v[76:79], v[172:175], v[152:155]
    v_cvt_pk_bf16_f32 v88, v112, v113
    v_cvt_pk_bf16_f32 v89, v114, v115
    v_cvt_pk_bf16_f32 v116, 0, v116
    v_cvt_pk_bf16_f32 v117, 0, v117
    v_mfma_f32_16x16x32_bf16 v[156:159], v[76:79], v[188:191], v[156:159]
    ds_read_b64_tr_b16 v[68:69], v25 offset:16384
    ds_read_b64_tr_b16 v[70:71], v25 offset:20480
    v_cvt_pk_bf16_f32 v118, 0, v118
    v_cvt_pk_bf16_f32 v119, 0, v119
    v_mul_f32 v116, s34, v116
    s_waitcnt lgkmcnt(10)
    v_mfma_f32_16x16x32_bf16 v[192:195], v[48:51], v[80:83], v[192:195]
    v_mul_f32 v117, s34, v117
    v_mul_f32 v118, s34, v118
    v_mul_f32 v119, s34, v119
    v_cvt_pk_bf16_f32 v116, 0, v116
    v_mfma_f32_16x16x32_bf16 v[196:199], v[48:51], v[84:87], v[196:199]
    ds_read_b64_tr_b16 v[72:73], v26 offset:16384
    ds_read_b64_tr_b16 v[74:75], v26 offset:20480
    v_cvt_pk_bf16_f32 v117, 0, v117
    v_cvt_pk_bf16_f32 v118, 0, v118
    v_cvt_pk_bf16_f32 v119, 0, v119
    v_fma_f32 v116, v116, s32, -v3
    s_waitcnt lgkmcnt(10)
    v_mfma_f32_16x16x32_bf16 v[200:203], v[52:55], v[80:83], v[200:203]
    s_setprio 1
    v_fma_f32 v117, v117, s32, -v3
    v_fma_f32 v118, v118, s32, -v3
    v_fma_f32 v119, v119, s32, -v3
    v_mfma_f32_16x16x32_bf16 v[204:207], v[52:55], v[84:87], v[204:207]
    ds_read_b64_tr_b16 v[76:77], v27 offset:16384
    ds_read_b64_tr_b16 v[78:79], v27 offset:20480
    v_exp_f32 v116, v116
    v_exp_f32 v117, v117
    v_exp_f32 v118, v118
    v_exp_f32 v119, v119
    s_waitcnt lgkmcnt(10)
    v_mfma_f32_16x16x32_bf16 v[208:211], v[56:59], v[80:83], v[208:211]
    v_cvt_pk_bf16_f32 v92, v116, v117
    v_cvt_pk_bf16_f32 v93, v118, v119
    v_cvt_pk_bf16_f32 v120, 0, v120
    s_nop 0
    v_mfma_f32_16x16x32_bf16 v[212:215], v[56:59], v[84:87], v[212:215]
    ds_read_b64_tr_b16 v[48:49], v20 offset:24576
    ds_read_b64_tr_b16 v[50:51], v20 offset:28672
    v_cvt_pk_bf16_f32 v121, 0, v121
    v_cvt_pk_bf16_f32 v122, 0, v122
    v_cvt_pk_bf16_f32 v123, 0, v123
    v_mul_f32 v120, s34, v120
    s_waitcnt lgkmcnt(10)
    v_mfma_f32_16x16x32_bf16 v[216:219], v[60:63], v[80:83], v[216:219]
    v_mul_f32 v121, s34, v121
    v_mul_f32 v122, s34, v122
    v_mul_f32 v123, s34, v123
    v_cvt_pk_bf16_f32 v120, 0, v120
    v_mfma_f32_16x16x32_bf16 v[220:223], v[60:63], v[84:87], v[220:223]
    ds_read_b64_tr_b16 v[52:53], v21 offset:24576
    ds_read_b64_tr_b16 v[54:55], v21 offset:28672
    v_cvt_pk_bf16_f32 v121, 0, v121
    v_cvt_pk_bf16_f32 v122, 0, v122
    v_cvt_pk_bf16_f32 v123, 0, v123
    s_waitcnt lgkmcnt(10)
    v_mfma_f32_16x16x32_bf16 v[224:227], v[64:67], v[80:83], v[224:227]
    v_fma_f32 v120, v120, s32, -v2
    v_fma_f32 v121, v121, s32, -v2
    v_fma_f32 v122, v122, s32, -v2
    v_fma_f32 v123, v123, s32, -v2
    v_mfma_f32_16x16x32_bf16 v[228:231], v[64:67], v[84:87], v[228:231]
    ds_read_b64_tr_b16 v[56:57], v22 offset:24576
    ds_read_b64_tr_b16 v[58:59], v22 offset:28672
    v_exp_f32 v120, v120
    v_exp_f32 v121, v121
    v_exp_f32 v122, v122
    s_waitcnt lgkmcnt(10)
    v_mfma_f32_16x16x32_bf16 v[232:235], v[68:71], v[80:83], v[232:235]
    v_exp_f32 v123, v123
    v_cvt_pk_bf16_f32 v90, v120, v121
    v_cvt_pk_bf16_f32 v91, v122, v123
    v_cvt_pk_bf16_f32 v124, 0, v124
    s_nop 0
    v_mfma_f32_16x16x32_bf16 v[236:239], v[68:71], v[84:87], v[236:239]
    ds_read_b64_tr_b16 v[60:61], v23 offset:24576
    ds_read_b64_tr_b16 v[62:63], v23 offset:28672
    v_cvt_pk_bf16_f32 v125, 0, v125
    v_cvt_pk_bf16_f32 v126, 0, v126
    v_cvt_pk_bf16_f32 v127, 0, v127
    v_mul_f32 v124, s34, v124
    s_waitcnt lgkmcnt(10)
    v_mfma_f32_16x16x32_bf16 v[240:243], v[72:75], v[80:83], v[240:243]
    v_mul_f32 v125, s34, v125
    v_mul_f32 v126, s34, v126
    v_mul_f32 v127, s34, v127
    v_mfma_f32_16x16x32_bf16 v[244:247], v[72:75], v[84:87], v[244:247]
    ds_read_b64_tr_b16 v[64:65], v24 offset:24576
    ds_read_b64_tr_b16 v[66:67], v24 offset:28672
    v_cvt_pk_bf16_f32 v124, 0, v124
    v_cvt_pk_bf16_f32 v125, 0, v125
    v_cvt_pk_bf16_f32 v126, 0, v126
    v_cvt_pk_bf16_f32 v127, 0, v127
    s_waitcnt lgkmcnt(10)
    v_mfma_f32_16x16x32_bf16 v[248:251], v[76:79], v[80:83], v[248:251]
    v_fma_f32 v124, v124, s32, -v3
    v_fma_f32 v125, v125, s32, -v3
    v_fma_f32 v126, v126, s32, -v3
    v_mfma_f32_16x16x32_bf16 v[252:255], v[76:79], v[84:87], v[252:255]
    ds_read_b64_tr_b16 v[68:69], v25 offset:24576
    ds_read_b64_tr_b16 v[70:71], v25 offset:28672
    v_fma_f32 v127, v127, s32, -v3
    v_exp_f32 v124, v124
    v_exp_f32 v125, v125
    v_exp_f32 v126, v126
    v_mfma_f32_16x16x32_bf16 v[32:35], v[12:15], v[80:83], v[32:35]
    v_exp_f32 v127, v127
    v_cvt_pk_bf16_f32 v94, v124, v125
    v_cvt_pk_bf16_f32 v95, v126, v127
    s_nop 1
    v_mfma_f32_16x16x32_bf16 v[36:39], v[12:15], v[84:87], v[36:39]
    s_waitcnt lgkmcnt(10)
    v_mfma_f32_16x16x32_bf16 v[192:195], v[48:51], v[88:91], v[192:195]
    v_mfma_f32_16x16x32_bf16 v[196:199], v[48:51], v[92:95], v[196:199]
    ds_read_b64_tr_b16 v[72:73], v26 offset:24576
    ds_read_b64_tr_b16 v[74:75], v26 offset:28672
    s_setprio 0
    s_waitcnt lgkmcnt(10)
    v_mfma_f32_16x16x32_bf16 v[200:203], v[52:55], v[88:91], v[200:203]
    v_max3_f32 v4, v128, v129, v130
    v_max3_f32 v5, v132, v133, v134
    v_mfma_f32_16x16x32_bf16 v[204:207], v[52:55], v[92:95], v[204:207]
    ds_read_b64_tr_b16 v[76:77], v27 offset:24576
    ds_read_b64_tr_b16 v[78:79], v27 offset:28672
    v_max3_f32 v4, v4, v131, v136
    v_max3_f32 v5, v5, v135, v140
    s_waitcnt lgkmcnt(10)
    v_mfma_f32_16x16x32_bf16 v[208:211], v[56:59], v[88:91], v[208:211]
    v_max3_f32 v4, v4, v137, v138
    v_max3_f32 v5, v5, v141, v142
    v_mfma_f32_16x16x32_bf16 v[212:215], v[56:59], v[92:95], v[212:215]
    ds_read_b128 v[48:51], v16 offset:0
    v_max3_f32 v4, v4, v139, v144
    s_waitcnt lgkmcnt(9)
    v_mfma_f32_16x16x32_bf16 v[216:219], v[60:63], v[88:91], v[216:219]
    v_max3_f32 v5, v5, v143, v148
    v_max3_f32 v4, v4, v145, v146
    v_mfma_f32_16x16x32_bf16 v[220:223], v[60:63], v[92:95], v[220:223]
    ds_read_b128 v[52:55], v17 offset:0
    v_max3_f32 v5, v5, v149, v150
    v_max3_f32 v4, v4, v147, v152
    s_waitcnt lgkmcnt(8)
    v_mfma_f32_16x16x32_bf16 v[224:227], v[64:67], v[88:91], v[224:227]
    v_max3_f32 v5, v5, v151, v156
    v_max3_f32 v4, v4, v153, v154
    v_mfma_f32_16x16x32_bf16 v[228:231], v[64:67], v[92:95], v[228:231]
    ds_read_b128 v[56:59], v18 offset:0
    v_max3_f32 v5, v5, v157, v158
    s_waitcnt lgkmcnt(7)
    v_mfma_f32_16x16x32_bf16 v[232:235], v[68:71], v[88:91], v[232:235]
    v_max_f32 v4, v4, v155
    v_max_f32 v5, v5, v159
    v_mfma_f32_16x16x32_bf16 v[236:239], v[68:71], v[92:95], v[236:239]
    ds_read_b128 v[60:63], v19 offset:0
    s_nop 1
    v_permlane32_swap_b32 v4, v5
    s_waitcnt lgkmcnt(6)
    v_mfma_f32_16x16x32_bf16 v[240:243], v[72:75], v[88:91], v[240:243]
    v_max_f32 v4, v4, v5
    v_mov_b32 v6, v4
    v_mfma_f32_16x16x32_bf16 v[244:247], v[72:75], v[92:95], v[244:247]
    ds_read_b128 v[64:67], v16 offset:4096
    v_add_f32 v5, 0x41000000, v1
    s_waitcnt lgkmcnt(5)
    v_mfma_f32_16x16x32_bf16 v[248:251], v[76:79], v[88:91], v[248:251]
    s_nop 0
    v_permlane16_swap_b32 v4, v6
    v_mfma_f32_16x16x32_bf16 v[252:255], v[76:79], v[92:95], v[252:255]
    ds_read_b128 v[68:71], v17 offset:4096
    v_max_f32 v4, v4, v6
    v_cvt_pk_bf16_f32 v4, 0, v4
    v_mfma_f32_16x16x32_bf16 v[32:35], v[12:15], v[88:91], v[32:35]
    v_mul_f32 v4, s34, v4
    v_cvt_pk_bf16_f32 v4, 0, v4
    v_mfma_f32_16x16x32_bf16 v[36:39], v[12:15], v[92:95], v[36:39]
    v_mul_f32 v4, s32, v4
    v_cmp_gt_f32 vcc, v4, v5
    s_nop 1
    s_cbranch_vccz L_k3_skip6
    s_nop 15
    v_max_f32 v4, v4, v1
    v_sub_f32 v5, v1, v4
    v_exp_f32 v5, v5
    v_mov_b32 v1, v4
    v_mov_b32 v2, v4
    v_mov_b32 v3, v4
    v_mov_b32 v6, v5
    s_nop 1
    v_permlane32_swap_b32 v2, v3
    v_permlane32_swap_b32 v5, v6
    s_nop 1
    v_mul_f32 v32, v32, v5
    v_mul_f32 v36, v36, v6
    v_mul_f32 v192, v192, v5
    v_mul_f32 v193, v193, v5
    v_mul_f32 v194, v194, v5
    v_mul_f32 v195, v195, v5
    v_mul_f32 v196, v196, v6
    v_mul_f32 v197, v197, v6
    v_mul_f32 v198, v198, v6
    v_mul_f32 v199, v199, v6
    v_mul_f32 v200, v200, v5
    v_mul_f32 v201, v201, v5
    v_mul_f32 v202, v202, v5
    v_mul_f32 v203, v203, v5
    v_mul_f32 v204, v204, v6
    v_mul_f32 v205, v205, v6
    v_mul_f32 v206, v206, v6
    v_mul_f32 v207, v207, v6
    v_mul_f32 v208, v208, v5
    v_mul_f32 v209, v209, v5
    v_mul_f32 v210, v210, v5
    v_mul_f32 v211, v211, v5
    v_mul_f32 v212, v212, v6
    v_mul_f32 v213, v213, v6
    v_mul_f32 v214, v214, v6
    v_mul_f32 v215, v215, v6
    v_mul_f32 v216, v216, v5
    v_mul_f32 v217, v217, v5
    v_mul_f32 v218, v218, v5
    v_mul_f32 v219, v219, v5
    v_mul_f32 v220, v220, v6
    v_mul_f32 v221, v221, v6
    v_mul_f32 v222, v222, v6
    v_mul_f32 v223, v223, v6
    v_mul_f32 v224, v224, v5
    v_mul_f32 v225, v225, v5
    v_mul_f32 v226, v226, v5
    v_mul_f32 v227, v227, v5
    v_mul_f32 v228, v228, v6
    v_mul_f32 v229, v229, v6
    v_mul_f32 v230, v230, v6
    v_mul_f32 v231, v231, v6
    v_mul_f32 v232, v232, v5
    v_mul_f32 v233, v233, v5
    v_mul_f32 v234, v234, v5
    v_mul_f32 v235, v235, v5
    v_mul_f32 v236, v236, v6
    v_mul_f32 v237, v237, v6
    v_mul_f32 v238, v238, v6
    v_mul_f32 v239, v239, v6
    v_mul_f32 v240, v240, v5
    v_mul_f32 v241, v241, v5
    v_mul_f32 v242, v242, v5
    v_mul_f32 v243, v243, v5
    v_mul_f32 v244, v244, v6
    v_mul_f32 v245, v245, v6
    v_mul_f32 v246, v246, v6
    v_mul_f32 v247, v247, v6
    v_mul_f32 v248, v248, v5
    v_mul_f32 v249, v249, v5
    v_mul_f32 v250, v250, v5
    v_mul_f32 v251, v251, v5
    v_mul_f32 v252, v252, v6
    v_mul_f32 v253, v253, v6
    v_mul_f32 v254, v254, v6
    v_mul_f32 v255, v255, v6
    s_nop 1
L_k3_skip6:
    s_waitcnt vmcnt(0)
    s_barrier
    s_waitcnt lgkmcnt(5)
    v_mfma_f32_16x16x32_bf16 v[96:99], v[48:51], v[160:163], 0
    s_setprio 3
    v_cvt_pk_bf16_f32 v128, 0, v128
    v_cvt_pk_bf16_f32 v129, 0, v129
    v_cvt_pk_bf16_f32 v130, 0, v130
    v_cvt_pk_bf16_f32 v131, 0, v131
    v_mfma_f32_16x16x32_bf16 v[100:103], v[48:51], v[176:179], 0
    ds_read_b128 v[72:75], v18 offset:4096
    v_mul_f32 v128, s34, v128
    v_mul_f32 v129, s34, v129
    v_mul_f32 v130, s34, v130
    v_mul_f32 v131, s34, v131
    s_waitcnt lgkmcnt(5)
    v_mfma_f32_16x16x32_bf16 v[96:99], v[52:55], v[164:167], v[96:99]
    v_cvt_pk_bf16_f32 v128, 0, v128
    v_cvt_pk_bf16_f32 v129, 0, v129
    v_cvt_pk_bf16_f32 v130, 0, v130
    s_mov_b32 m0, s39
    s_nop 0
    buffer_load_dwordx4 v28, s[8:11], s35 offen lds
    buffer_load_dwordx4 v29, s[8:11], s35 offen offset:1024 lds
    s_add_u32 s35, s35, 16384
    v_mfma_f32_16x16x32_bf16 v[100:103], v[52:55], v[180:183], v[100:103]
    ds_read_b128 v[76:79], v19 offset:4096
    v_cvt_pk_bf16_f32 v131, 0, v131
    v_fma_f32 v128, v128, s32, -v2
    v_fma_f32 v129, v129, s32, -v2
    v_fma_f32 v130, v130, s32, -v2
    s_waitcnt lgkmcnt(5)
    v_mfma_f32_16x16x32_bf16 v[96:99], v[56:59], v[168:171], v[96:99]
    v_fma_f32 v131, v131, s32, -v2
    v_exp_f32 v128, v128
    v_exp_f32 v129, v129
    v_mfma_f32_16x16x32_bf16 v[100:103], v[56:59], v[184:187], v[100:103]
    ds_read_b128 v[48:51], v16 offset:8192
    v_exp_f32 v130, v130
    v_exp_f32 v131, v131
    v_cvt_pk_bf16_f32 v80, v128, v129
    v_cvt_pk_bf16_f32 v81, v130, v131
    s_waitcnt lgkmcnt(5)
    v_mfma_f32_16x16x32_bf16 v[96:99], v[60:63], v[172:175], v[96:99]
    v_cvt_pk_bf16_f32 v132, 0, v132
    v_cvt_pk_bf16_f32 v133, 0, v133
    v_cvt_pk_bf16_f32 v134, 0, v134
    v_cvt_pk_bf16_f32 v135, 0, v135
    s_mov_b32 m0, s41
    s_nop 0
    buffer_load_dwordx4 v30, s[12:15], s36 offen lds
    buffer_load_dwordx4 v31, s[12:15], s36 offen offset:1024 lds
    s_add_u32 s36, s36, 16384
    v_mfma_f32_16x16x32_bf16 v[100:103], v[60:63], v[188:191], v[100:103]
    ds_read_b128 v[52:55], v17 offset:8192
    v_mul_f32 v132, s34, v132
    v_mul_f32 v133, s34, v133
    v_mul_f32 v134, s34, v134
    s_waitcnt lgkmcnt(5)
    v_mfma_f32_16x16x32_bf16 v[104:107], v[64:67], v[160:163], 0
    v_mul_f32 v135, s34, v135
    v_cvt_pk_bf16_f32 v132, 0, v132
    v_cvt_pk_bf16_f32 v133, 0, v133
    v_cvt_pk_bf16_f32 v134, 0, v134
    v_mfma_f32_16x16x32_bf16 v[108:111], v[64:67], v[176:179], 0
    ds_read_b128 v[56:59], v18 offset:8192
    v_cvt_pk_bf16_f32 v135, 0, v135
    v_fma_f32 v132, v132, s32, -v3
    v_fma_f32 v133, v133, s32, -v3
    s_waitcnt lgkmcnt(5)
    v_mfma_f32_16x16x32_bf16 v[104:107], v[68:71], v[164:167], v[104:107]
    v_fma_f32 v134, v134, s32, -v3
    v_fma_f32 v135, v135, s32, -v3
    v_exp_f32 v132, v132
    v_exp_f32 v133, v133
    v_mfma_f32_16x16x32_bf16 v[108:111], v[68:71], v[180:183], v[108:111]
    ds_read_b128 v[60:63], v19 offset:8192
    v_exp_f32 v134, v134
    v_exp_f32 v135, v135
    v_cvt_pk_bf16_f32 v84, v132, v133
    v_cvt_pk_bf16_f32 v85, v134, v135
    s_waitcnt lgkmcnt(5)
    v_mfma_f32_16x16x32_bf16 v[104:107], v[72:75], v[168:171], v[104:107]
    v_cvt_pk_bf16_f32 v136, 0, v136
    v_cvt_pk_bf16_f32 v137, 0, v137
    v_cvt_pk_bf16_f32 v138, 0, v138
    v_mfma_f32_16x16x32_bf16 v[108:111], v[72:75], v[184:187], v[108:111]
    ds_read_b128 v[64:67], v16 offset:12288
    v_cvt_pk_bf16_f32 v139, 0, v139
    v_mul_f32 v136, s34, v136
    v_mul_f32 v137, s34, v137
    v_mul_f32 v138, s34, v138
    s_waitcnt lgkmcnt(5)
    v_mfma_f32_16x16x32_bf16 v[104:107], v[76:79], v[172:175], v[104:107]
    v_mul_f32 v139, s34, v139
    v_cvt_pk_bf16_f32 v136, 0, v136
    v_cvt_pk_bf16_f32 v137, 0, v137
    v_mfma_f32_16x16x32_bf16 v[108:111], v[76:79], v[188:191], v[108:111]
    ds_read_b128 v[68:71], v17 offset:12288
    v_cvt_pk_bf16_f32 v138, 0, v138
    v_cvt_pk_bf16_f32 v139, 0, v139
    v_fma_f32 v136, v136, s32, -v2
    v_fma_f32 v137, v137, s32, -v2
    s_waitcnt lgkmcnt(5)
    v_mfma_f32_16x16x32_bf16 v[112:115], v[48:51], v[160:163], 0
    v_fma_f32 v138, v138, s32, -v2
    v_fma_f32 v139, v139, s32, -v2
    v_exp_f32 v136, v136
    v_exp_f32 v137, v137
    v_mfma_f32_16x16x32_bf16 v[116:119], v[48:51], v[176:179], 0
    ds_read_b128 v[72:75], v18 offset:12288
    s_setprio 2
    v_exp_f32 v138, v138
    v_exp_f32 v139, v139
    v_cvt_pk_bf16_f32 v82, v136, v137
    s_waitcnt lgkmcnt(5)
    v_mfma_f32_16x16x32_bf16 v[112:115], v[52:55], v[164:167], v[112:115]
    v_cvt_pk_bf16_f32 v83, v138, v139
    v_cvt_pk_bf16_f32 v140, 0, v140
    v_cvt_pk_bf16_f32 v141, 0, v141
    v_cvt_pk_bf16_f32 v142, 0, v142
    v_mfma_f32_16x16x32_bf16 v[116:119], v[52:55], v[180:183], v[116:119]
    ds_read_b128 v[76:79], v19 offset:12288
    v_cvt_pk_bf16_f32 v143, 0, v143
    v_mul_f32 v140, s34, v140
    v_mul_f32 v141, s34, v141
    s_waitcnt lgkmcnt(5)
    v_mfma_f32_16x16x32_bf16 v[112:115], v[56:59], v[168:171], v[112:115]
    v_mul_f32 v142, s34, v142
    v_mul_f32 v143, s34, v143
    v_cvt_pk_bf16_f32 v140, 0, v140
    v_cvt_pk_bf16_f32 v141, 0, v141
    v_mfma_f32_16x16x32_bf16 v[116:119], v[56:59], v[184:187], v[116:119]
    ds_read_b64_tr_b16 v[48:49], v20 offset:32768
    ds_read_b64_tr_b16 v[50:51], v20 offset:36864
    v_cvt_pk_bf16_f32 v142, 0, v142
    v_cvt_pk_bf16_f32 v143, 0, v143
    v_fma_f32 v140, v140, s32, -v3
    v_fma_f32 v141, v141, s32, -v3
    s_waitcnt lgkmcnt(6)
    v_mfma_f32_16x16x32_bf16 v[112:115], v[60:63], v[172:175], v[112:115]
    v_fma_f32 v142, v142, s32, -v3
    v_fma_f32 v143, v143, s32, -v3
    v_exp_f32 v140, v140
    v_mfma_f32_16x16x32_bf16 v[116:119], v[60:63], v[188:191], v[116:119]
    ds_read_b64_tr_b16 v[52:53], v21 offset:32768
    ds_read_b64_tr_b16 v[54:55], v21 offset:36864
    v_exp_f32 v141, v141
    v_exp_f32 v142, v142
    v_exp_f32 v143, v143
    v_cvt_pk_bf16_f32 v86, v140, v141
    s_waitcnt lgkmcnt(7)
    v_mfma_f32_16x16x32_bf16 v[120:123], v[64:67], v[160:163], 0
    v_cvt_pk_bf16_f32 v87, v142, v143
    v_cvt_pk_bf16_f32 v144, 0, v144
    v_cvt_pk_bf16_f32 v145, 0, v145
    v_mfma_f32_16x16x32_bf16 v[124:127], v[64:67], v[176:179], 0
    ds_read_b64_tr_b16 v[56:57], v22 offset:32768
    ds_read_b64_tr_b16 v[58:59], v22 offset:36864
    v_cvt_pk_bf16_f32 v146, 0, v146
    v_cvt_pk_bf16_f32 v147, 0, v147
    v_mul_f32 v144, s34, v144
    v_mul_f32 v145, s34, v145
    s_waitcnt lgkmcnt(8)
    v_mfma_f32_16x16x32_bf16 v[120:123], v[68:71], v[164:167], v[120:123]
    v_mul_f32 v146, s34, v146
    v_mul_f32 v147, s34, v147
    v_cvt_pk_bf16_f32 v144, 0, v144
    v_mfma_f32_16x16x32_bf16 v[124:127], v[68:71], v[180:183], v[124:127]
    ds_read_b64_tr_b16 v[60:61], v23 offset:32768
    ds_read_b64_tr_b16 v[62:63], v23 offset:36864
    v_cvt_pk_bf16_f32 v145, 0, v145
    v_cvt_pk_bf16_f32 v146, 0, v146
    v_cvt_pk_bf16_f32 v147, 0, v147
    v_fma_f32 v144, v144, s32, -v2
    s_waitcnt lgkmcnt(9)
    v_mfma_f32_16x16x32_bf16 v[120:123], v[72:75], v[168:171], v[120:123]
    v_fma_f32 v145, v145, s32, -v2
    v_fma_f32 v146, v146, s32, -v2
    v_fma_f32 v147, v147, s32, -v2
    v_exp_f32 v144, v144
    v_mfma_f32_16x16x32_bf16 v[124:127], v[72:75], v[184:187], v[124:127]
    ds_read_b64_tr_b16 v[64:65], v24 offset:32768
    ds_read_b64_tr_b16 v[66:67], v24 offset:36864
    v_exp_f32 v145, v145
    v_exp_f32 v146, v146
    v_exp_f32 v147, v147
    s_waitcnt lgkmcnt(10)
    v_mfma_f32_16x16x32_bf16 v[120:123], v[76:79], v[172:175], v[120:123]
    v_cvt_pk_bf16_f32 v88, v144, v145
    v_cvt_pk_bf16_f32 v89, v146, v147
    v_cvt_pk_bf16_f32 v148, 0, v148
    v_cvt_pk_bf16_f32 v149, 0, v149
    v_mfma_f32_16x16x32_bf16 v[124:127], v[76:79], v[188:191], v[124:127]
    ds_read_b64_tr_b16 v[68:69], v25 offset:32768
    ds_read_b64_tr_b16 v[70:71], v25 offset:36864
    v_cvt_pk_bf16_f32 v150, 0, v150
    v_cvt_pk_bf16_f32 v151, 0, v151
    v_mul_f32 v148, s34, v148
    s_waitcnt lgkmcnt(10)
    v_mfma_f32_16x16x32_bf16 v[192:195], v[48:51], v[80:83], v[192:195]
    v_mul_f32 v149, s34, v149
    v_mul_f32 v150, s34, v150
    v_mul_f32 v151, s34, v151
    v_cvt_pk_bf16_f32 v148, 0, v148
    v_mfma_f32_16x16x32_bf16 v[196:199], v[48:51], v[84:87], v[196:199]
    ds_read_b64_tr_b16 v[72:73], v26 offset:32768
    ds_read_b64_tr_b16 v[74:75], v26 offset:36864
    v_cvt_pk_bf16_f32 v149, 0, v149
    v_cvt_pk_bf16_f32 v150, 0, v150
    v_cvt_pk_bf16_f32 v151, 0, v151
    v_fma_f32 v148, v148, s32, -v3
    s_waitcnt lgkmcnt(10)
    v_mfma_f32_16x16x32_bf16 v[200:203], v[52:55], v[80:83], v[200:203]
    s_setprio 1
    v_fma_f32 v149, v149, s32, -v3
    v_fma_f32 v150, v150, s32, -v3
    v_fma_f32 v151, v151, s32, -v3
    v_mfma_f32_16x16x32_bf16 v[204:207], v[52:55], v[84:87], v[204:207]
    ds_read_b64_tr_b16 v[76:77], v27 offset:32768
    ds_read_b64_tr_b16 v[78:79], v27 offset:36864
    v_exp_f32 v148, v148
    v_exp_f32 v149, v149
    v_exp_f32 v150, v150
    v_exp_f32 v151, v151
    s_waitcnt lgkmcnt(10)
    v_mfma_f32_16x16x32_bf16 v[208:211], v[56:59], v[80:83], v[208:211]
    v_cvt_pk_bf16_f32 v92, v148, v149
    v_cvt_pk_bf16_f32 v93, v150, v151
    v_cvt_pk_bf16_f32 v152, 0, v152
    s_nop 0
    v_mfma_f32_16x16x32_bf16 v[212:215], v[56:59], v[84:87], v[212:215]
    ds_read_b64_tr_b16 v[48:49], v20 offset:40960
    ds_read_b64_tr_b16 v[50:51], v20 offset:45056
    v_cvt_pk_bf16_f32 v153, 0, v153
    v_cvt_pk_bf16_f32 v154, 0, v154
    v_cvt_pk_bf16_f32 v155, 0, v155
    v_mul_f32 v152, s34, v152
    s_waitcnt lgkmcnt(10)
    v_mfma_f32_16x16x32_bf16 v[216:219], v[60:63], v[80:83], v[216:219]
    v_mul_f32 v153, s34, v153
    v_mul_f32 v154, s34, v154
    v_mul_f32 v155, s34, v155
    v_cvt_pk_bf16_f32 v152, 0, v152
    v_mfma_f32_16x16x32_bf16 v[220:223], v[60:63], v[84:87], v[220:223]
    ds_read_b64_tr_b16 v[52:53], v21 offset:40960
    ds_read_b64_tr_b16 v[54:55], v21 offset:45056
    v_cvt_pk_bf16_f32 v153, 0, v153
    v_cvt_pk_bf16_f32 v154, 0, v154
    v_cvt_pk_bf16_f32 v155, 0, v155
    s_waitcnt lgkmcnt(10)
    v_mfma_f32_16x16x32_bf16 v[224:227], v[64:67], v[80:83], v[224:227]
    v_fma_f32 v152, v152, s32, -v2
    v_fma_f32 v153, v153, s32, -v2
    v_fma_f32 v154, v154, s32, -v2
    v_fma_f32 v155, v155, s32, -v2
    v_mfma_f32_16x16x32_bf16 v[228:231], v[64:67], v[84:87], v[228:231]
    ds_read_b64_tr_b16 v[56:57], v22 offset:40960
    ds_read_b64_tr_b16 v[58:59], v22 offset:45056
    v_exp_f32 v152, v152
    v_exp_f32 v153, v153
    v_exp_f32 v154, v154
    s_waitcnt lgkmcnt(10)
    v_mfma_f32_16x16x32_bf16 v[232:235], v[68:71], v[80:83], v[232:235]
    v_exp_f32 v155, v155
    v_cvt_pk_bf16_f32 v90, v152, v153
    v_cvt_pk_bf16_f32 v91, v154, v155
    v_cvt_pk_bf16_f32 v156, 0, v156
    s_nop 0
    v_mfma_f32_16x16x32_bf16 v[236:239], v[68:71], v[84:87], v[236:239]
    ds_read_b64_tr_b16 v[60:61], v23 offset:40960
    ds_read_b64_tr_b16 v[62:63], v23 offset:45056
    v_cvt_pk_bf16_f32 v157, 0, v157
    v_cvt_pk_bf16_f32 v158, 0, v158
    v_cvt_pk_bf16_f32 v159, 0, v159
    v_mul_f32 v156, s34, v156
    s_waitcnt lgkmcnt(10)
    v_mfma_f32_16x16x32_bf16 v[240:243], v[72:75], v[80:83], v[240:243]
    v_mul_f32 v157, s34, v157
    v_mul_f32 v158, s34, v158
    v_mul_f32 v159, s34, v159
    v_mfma_f32_16x16x32_bf16 v[244:247], v[72:75], v[84:87], v[244:247]
    ds_read_b64_tr_b16 v[64:65], v24 offset:40960
    ds_read_b64_tr_b16 v[66:67], v24 offset:45056
    v_cvt_pk_bf16_f32 v156, 0, v156
    v_cvt_pk_bf16_f32 v157, 0, v157
    v_cvt_pk_bf16_f32 v158, 0, v158
    v_cvt_pk_bf16_f32 v159, 0, v159
    s_waitcnt lgkmcnt(10)
    v_mfma_f32_16x16x32_bf16 v[248:251], v[76:79], v[80:83], v[248:251]
    v_fma_f32 v156, v156, s32, -v3
    v_fma_f32 v157, v157, s32, -v3
    v_fma_f32 v158, v158, s32, -v3
    v_mfma_f32_16x16x32_bf16 v[252:255], v[76:79], v[84:87], v[252:255]
    ds_read_b64_tr_b16 v[68:69], v25 offset:40960
    ds_read_b64_tr_b16 v[70:71], v25 offset:45056
    v_fma_f32 v159, v159, s32, -v3
    v_exp_f32 v156, v156
    v_exp_f32 v157, v157
    v_exp_f32 v158, v158
    v_mfma_f32_16x16x32_bf16 v[32:35], v[12:15], v[80:83], v[32:35]
    v_exp_f32 v159, v159
    v_cvt_pk_bf16_f32 v94, v156, v157
    v_cvt_pk_bf16_f32 v95, v158, v159
    s_nop 1
    v_mfma_f32_16x16x32_bf16 v[36:39], v[12:15], v[84:87], v[36:39]
    s_waitcnt lgkmcnt(10)
    v_mfma_f32_16x16x32_bf16 v[192:195], v[48:51], v[88:91], v[192:195]
    v_mfma_f32_16x16x32_bf16 v[196:199], v[48:51], v[92:95], v[196:199]
    ds_read_b64_tr_b16 v[72:73], v26 offset:40960
    ds_read_b64_tr_b16 v[74:75], v26 offset:45056
    s_setprio 0
    s_waitcnt lgkmcnt(10)
    v_mfma_f32_16x16x32_bf16 v[200:203], v[52:55], v[88:91], v[200:203]
    v_max3_f32 v4, v96, v97, v98
    v_max3_f32 v5, v100, v101, v102
    v_mfma_f32_16x16x32_bf16 v[204:207], v[52:55], v[92:95], v[204:207]
    ds_read_b64_tr_b16 v[76:77], v27 offset:40960
    ds_read_b64_tr_b16 v[78:79], v27 offset:45056
    v_max3_f32 v4, v4, v99, v104
    v_max3_f32 v5, v5, v103, v108
    s_waitcnt lgkmcnt(10)
    v_mfma_f32_16x16x32_bf16 v[208:211], v[56:59], v[88:91], v[208:211]
    v_max3_f32 v4, v4, v105, v106
    v_max3_f32 v5, v5, v109, v110
    v_mfma_f32_16x16x32_bf16 v[212:215], v[56:59], v[92:95], v[212:215]
    ds_read_b128 v[48:51], v16 offset:16384
    v_max3_f32 v4, v4, v107, v112
    s_waitcnt lgkmcnt(9)
    v_mfma_f32_16x16x32_bf16 v[216:219], v[60:63], v[88:91], v[216:219]
    v_max3_f32 v5, v5, v111, v116
    v_max3_f32 v4, v4, v113, v114
    v_mfma_f32_16x16x32_bf16 v[220:223], v[60:63], v[92:95], v[220:223]
    ds_read_b128 v[52:55], v17 offset:16384
    v_max3_f32 v5, v5, v117, v118
    v_max3_f32 v4, v4, v115, v120
    s_waitcnt lgkmcnt(8)
    v_mfma_f32_16x16x32_bf16 v[224:227], v[64:67], v[88:91], v[224:227]
    v_max3_f32 v5, v5, v119, v124
    v_max3_f32 v4, v4, v121, v122
    v_mfma_f32_16x16x32_bf16 v[228:231], v[64:67], v[92:95], v[228:231]
    ds_read_b128 v[56:59], v18 offset:16384
    v_max3_f32 v5, v5, v125, v126
    s_waitcnt lgkmcnt(7)
    v_mfma_f32_16x16x32_bf16 v[232:235], v[68:71], v[88:91], v[232:235]
    v_max_f32 v4, v4, v123
    v_max_f32 v5, v5, v127
    v_mfma_f32_16x16x32_bf16 v[236:239], v[68:71], v[92:95], v[236:239]
    ds_read_b128 v[60:63], v19 offset:16384
    s_nop 1
    v_permlane32_swap_b32 v4, v5
    s_waitcnt lgkmcnt(6)
    v_mfma_f32_16x16x32_bf16 v[240:243], v[72:75], v[88:91], v[240:243]
    v_max_f32 v4, v4, v5
    v_mov_b32 v6, v4
    v_mfma_f32_16x16x32_bf16 v[244:247], v[72:75], v[92:95], v[244:247]
    ds_read_b128 v[64:67], v16 offset:20480
    v_add_f32 v5, 0x41000000, v1
    s_waitcnt lgkmcnt(5)
    v_mfma_f32_16x16x32_bf16 v[248:251], v[76:79], v[88:91], v[248:251]
    s_nop 0
    v_permlane16_swap_b32 v4, v6
    v_mfma_f32_16x16x32_bf16 v[252:255], v[76:79], v[92:95], v[252:255]
    ds_read_b128 v[68:71], v17 offset:20480
    v_max_f32 v4, v4, v6
    v_cvt_pk_bf16_f32 v4, 0, v4
    v_mfma_f32_16x16x32_bf16 v[32:35], v[12:15], v[88:91], v[32:35]
    v_mul_f32 v4, s34, v4
    v_cvt_pk_bf16_f32 v4, 0, v4
    v_mfma_f32_16x16x32_bf16 v[36:39], v[12:15], v[92:95], v[36:39]
    v_mul_f32 v4, s32, v4
    v_cmp_gt_f32 vcc, v4, v5
    s_nop 1
    s_cbranch_vccz L_k3_skip7
    s_nop 15
    v_max_f32 v4, v4, v1
    v_sub_f32 v5, v1, v4
    v_exp_f32 v5, v5
    v_mov_b32 v1, v4
    v_mov_b32 v2, v4
    v_mov_b32 v3, v4
    v_mov_b32 v6, v5
    s_nop 1
    v_permlane32_swap_b32 v2, v3
    v_permlane32_swap_b32 v5, v6
    s_nop 1
    v_mul_f32 v32, v32, v5
    v_mul_f32 v36, v36, v6
    v_mul_f32 v192, v192, v5
    v_mul_f32 v193, v193, v5
    v_mul_f32 v194, v194, v5
    v_mul_f32 v195, v195, v5
    v_mul_f32 v196, v196, v6
    v_mul_f32 v197, v197, v6
    v_mul_f32 v198, v198, v6
    v_mul_f32 v199, v199, v6
    v_mul_f32 v200, v200, v5
    v_mul_f32 v201, v201, v5
    v_mul_f32 v202, v202, v5
    v_mul_f32 v203, v203, v5
    v_mul_f32 v204, v204, v6
    v_mul_f32 v205, v205, v6
    v_mul_f32 v206, v206, v6
    v_mul_f32 v207, v207, v6
    v_mul_f32 v208, v208, v5
    v_mul_f32 v209, v209, v5
    v_mul_f32 v210, v210, v5
    v_mul_f32 v211, v211, v5
    v_mul_f32 v212, v212, v6
    v_mul_f32 v213, v213, v6
    v_mul_f32 v214, v214, v6
    v_mul_f32 v215, v215, v6
    v_mul_f32 v216, v216, v5
    v_mul_f32 v217, v217, v5
    v_mul_f32 v218, v218, v5
    v_mul_f32 v219, v219, v5
    v_mul_f32 v220, v220, v6
    v_mul_f32 v221, v221, v6
    v_mul_f32 v222, v222, v6
    v_mul_f32 v223, v223, v6
    v_mul_f32 v224, v224, v5
    v_mul_f32 v225, v225, v5
    v_mul_f32 v226, v226, v5
    v_mul_f32 v227, v227, v5
    v_mul_f32 v228, v228, v6
    v_mul_f32 v229, v229, v6
    v_mul_f32 v230, v230, v6
    v_mul_f32 v231, v231, v6
    v_mul_f32 v232, v232, v5
    v_mul_f32 v233, v233, v5
    v_mul_f32 v234, v234, v5
    v_mul_f32 v235, v235, v5
    v_mul_f32 v236, v236, v6
    v_mul_f32 v237, v237, v6
    v_mul_f32 v238, v238, v6
    v_mul_f32 v239, v239, v6
    v_mul_f32 v240, v240, v5
    v_mul_f32 v241, v241, v5
    v_mul_f32 v242, v242, v5
    v_mul_f32 v243, v243, v5
    v_mul_f32 v244, v244, v6
    v_mul_f32 v245, v245, v6
    v_mul_f32 v246, v246, v6
    v_mul_f32 v247, v247, v6
    v_mul_f32 v248, v248, v5
    v_mul_f32 v249, v249, v5
    v_mul_f32 v250, v250, v5
    v_mul_f32 v251, v251, v5
    v_mul_f32 v252, v252, v6
    v_mul_f32 v253, v253, v6
    v_mul_f32 v254, v254, v6
    v_mul_f32 v255, v255, v6
    s_nop 1
L_k3_skip7:
    s_sub_u32 s43, s43, 1
    s_cmp_lg_u32 s43, 0
    s_cbranch_scc1 L_k3_loops
    s_waitcnt vmcnt(0)
    s_barrier
    s_waitcnt lgkmcnt(5)
    v_mfma_f32_16x16x32_bf16 v[128:131], v[48:51], v[160:163], 0
    s_setprio 3
    v_cvt_pk_bf16_f32 v96, 0, v96
    v_cvt_pk_bf16_f32 v97, 0, v97
    v_cvt_pk_bf16_f32 v98, 0, v98
    v_cvt_pk_bf16_f32 v99, 0, v99
    v_mfma_f32_16x16x32_bf16 v[132:135], v[48:51], v[176:179], 0
    ds_read_b128 v[72:75], v18 offset:20480
    v_mul_f32 v96, s34, v96
    v_mul_f32 v97, s34, v97
    v_mul_f32 v98, s34, v98
    v_mul_f32 v99, s34, v99
    s_waitcnt lgkmcnt(5)
    v_mfma_f32_16x16x32_bf16 v[128:131], v[52:55], v[164:167], v[128:131]
    v_cvt_pk_bf16_f32 v96, 0, v96
    v_cvt_pk_bf16_f32 v97, 0, v97
    v_cvt_pk_bf16_f32 v98, 0, v98
    v_mfma_f32_16x16x32_bf16 v[132:135], v[52:55], v[180:183], v[132:135]
    ds_read_b128 v[76:79], v19 offset:20480
    v_cvt_pk_bf16_f32 v99, 0, v99
    v_fma_f32 v96, v96, s32, -v2
    v_fma_f32 v97, v97, s32, -v2
    v_fma_f32 v98, v98, s32, -v2
    s_waitcnt lgkmcnt(5)
    v_mfma_f32_16x16x32_bf16 v[128:131], v[56:59], v[168:171], v[128:131]
    v_fma_f32 v99, v99, s32, -v2
    v_exp_f32 v96, v96
    v_exp_f32 v97, v97
    v_mfma_f32_16x16x32_bf16 v[132:135], v[56:59], v[184:187], v[132:135]
    ds_read_b128 v[48:51], v16 offset:24576
    v_exp_f32 v98, v98
    v_exp_f32 v99, v99
    v_cvt_pk_bf16_f32 v80, v96, v97
    v_cvt_pk_bf16_f32 v81, v98, v99
    s_waitcnt lgkmcnt(5)
    v_mfma_f32_16x16x32_bf16 v[128:131], v[60:63], v[172:175], v[128:131]
    v_cvt_pk_bf16_f32 v100, 0, v100
    v_cvt_pk_bf16_f32 v101, 0, v101
    v_cvt_pk_bf16_f32 v102, 0, v102
    v_cvt_pk_bf16_f32 v103, 0, v103
    v_mfma_f32_16x16x32_bf16 v[132:135], v[60:63], v[188:191], v[132:135]
    ds_read_b128 v[52:55], v17 offset:24576
    v_mul_f32 v100, s34, v100
    v_mul_f32 v101, s34, v101
    v_mul_f32 v102, s34, v102
    s_waitcnt lgkmcnt(5)
    v_mfma_f32_16x16x32_bf16 v[136:139], v[64:67], v[160:163], 0
    v_mul_f32 v103, s34, v103
    v_cvt_pk_bf16_f32 v100, 0, v100
    v_cvt_pk_bf16_f32 v101, 0, v101
    v_cvt_pk_bf16_f32 v102, 0, v102
    v_mfma_f32_16x16x32_bf16 v[140:143], v[64:67], v[176:179], 0
    ds_read_b128 v[56:59], v18 offset:24576
    v_cvt_pk_bf16_f32 v103, 0, v103
    v_fma_f32 v100, v100, s32, -v3
    v_fma_f32 v101, v101, s32, -v3
    s_waitcnt lgkmcnt(5)
    v_mfma_f32_16x16x32_bf16 v[136:139], v[68:71], v[164:167], v[136:139]
    v_fma_f32 v102, v102, s32, -v3
    v_fma_f32 v103, v103, s32, -v3
    v_exp_f32 v100, v100
    v_exp_f32 v101, v101
    v_mfma_f32_16x16x32_bf16 v[140:143], v[68:71], v[180:183], v[140:143]
    ds_read_b128 v[60:63], v19 offset:24576
    v_exp_f32 v102, v102
    v_exp_f32 v103, v103
    v_cvt_pk_bf16_f32 v84, v100, v101
    v_cvt_pk_bf16_f32 v85, v102, v103
    s_waitcnt lgkmcnt(5)
    v_mfma_f32_16x16x32_bf16 v[136:139], v[72:75], v[168:171], v[136:139]
    v_cvt_pk_bf16_f32 v104, 0, v104
    v_cvt_pk_bf16_f32 v105, 0, v105
    v_cvt_pk_bf16_f32 v106, 0, v106
    v_mfma_f32_16x16x32_bf16 v[140:143], v[72:75], v[184:187], v[140:143]
    ds_read_b128 v[64:67], v16 offset:28672
    v_cvt_pk_bf16_f32 v107, 0, v107
    v_mul_f32 v104, s34, v104
    v_mul_f32 v105, s34, v105
    v_mul_f32 v106, s34, v106
    s_waitcnt lgkmcnt(5)
    v_mfma_f32_16x16x32_bf16 v[136:139], v[76:79], v[172:175], v[136:139]
    v_mul_f32 v107, s34, v107
    v_cvt_pk_bf16_f32 v104, 0, v104
    v_cvt_pk_bf16_f32 v105, 0, v105
    v_mfma_f32_16x16x32_bf16 v[140:143], v[76:79], v[188:191], v[140:143]
    ds_read_b128 v[68:71], v17 offset:28672
    v_cvt_pk_bf16_f32 v106, 0, v106
    v_cvt_pk_bf16_f32 v107, 0, v107
    v_fma_f32 v104, v104, s32, -v2
    v_fma_f32 v105, v105, s32, -v2
    s_waitcnt lgkmcnt(5)
    v_mfma_f32_16x16x32_bf16 v[144:147], v[48:51], v[160:163], 0
    v_fma_f32 v106, v106, s32, -v2
    v_fma_f32 v107, v107, s32, -v2
    v_exp_f32 v104, v104
    v_exp_f32 v105, v105
    v_mfma_f32_16x16x32_bf16 v[148:151], v[48:51], v[176:179], 0
    ds_read_b128 v[72:75], v18 offset:28672
    s_setprio 2
    v_exp_f32 v106, v106
    v_exp_f32 v107, v107
    v_cvt_pk_bf16_f32 v82, v104, v105
    s_waitcnt lgkmcnt(5)
    v_mfma_f32_16x16x32_bf16 v[144:147], v[52:55], v[164:167], v[144:147]
    v_cvt_pk_bf16_f32 v83, v106, v107
    v_cvt_pk_bf16_f32 v108, 0, v108
    v_cvt_pk_bf16_f32 v109, 0, v109
    v_cvt_pk_bf16_f32 v110, 0, v110
    v_mfma_f32_16x16x32_bf16 v[148:151], v[52:55], v[180:183], v[148:151]
    ds_read_b128 v[76:79], v19 offset:28672
    v_cvt_pk_bf16_f32 v111, 0, v111
    v_mul_f32 v108, s34, v108
    v_mul_f32 v109, s34, v109
    s_waitcnt lgkmcnt(5)
    v_mfma_f32_16x16x32_bf16 v[144:147], v[56:59], v[168:171], v[144:147]
    v_mul_f32 v110, s34, v110
    v_mul_f32 v111, s34, v111
    v_cvt_pk_bf16_f32 v108, 0, v108
    v_cvt_pk_bf16_f32 v109, 0, v109
    v_mfma_f32_16x16x32_bf16 v[148:151], v[56:59], v[184:187], v[148:151]
    ds_read_b64_tr_b16 v[48:49], v20 offset:0
    ds_read_b64_tr_b16 v[50:51], v20 offset:4096
    v_cvt_pk_bf16_f32 v110, 0, v110
    v_cvt_pk_bf16_f32 v111, 0, v111
    v_fma_f32 v108, v108, s32, -v3
    v_fma_f32 v109, v109, s32, -v3
    s_waitcnt lgkmcnt(6)
    v_mfma_f32_16x16x32_bf16 v[144:147], v[60:63], v[172:175], v[144:147]
    v_fma_f32 v110, v110, s32, -v3
    v_fma_f32 v111, v111, s32, -v3
    v_exp_f32 v108, v108
    v_mfma_f32_16x16x32_bf16 v[148:151], v[60:63], v[188:191], v[148:151]
    ds_read_b64_tr_b16 v[52:53], v21 offset:0
    ds_read_b64_tr_b16 v[54:55], v21 offset:4096
    v_exp_f32 v109, v109
    v_exp_f32 v110, v110
    v_exp_f32 v111, v111
    v_cvt_pk_bf16_f32 v86, v108, v109
    s_waitcnt lgkmcnt(7)
    v_mfma_f32_16x16x32_bf16 v[152:155], v[64:67], v[160:163], 0
    v_cvt_pk_bf16_f32 v87, v110, v111
    v_cvt_pk_bf16_f32 v112, 0, v112
    v_cvt_pk_bf16_f32 v113, 0, v113
    v_mfma_f32_16x16x32_bf16 v[156:159], v[64:67], v[176:179], 0
    ds_read_b64_tr_b16 v[56:57], v22 offset:0
    ds_read_b64_tr_b16 v[58:59], v22 offset:4096
    v_cvt_pk_bf16_f32 v114, 0, v114
    v_cvt_pk_bf16_f32 v115, 0, v115
    v_mul_f32 v112, s34, v112
    v_mul_f32 v113, s34, v113
    s_waitcnt lgkmcnt(8)
    v_mfma_f32_16x16x32_bf16 v[152:155], v[68:71], v[164:167], v[152:155]
    v_mul_f32 v114, s34, v114
    v_mul_f32 v115, s34, v115
    v_cvt_pk_bf16_f32 v112, 0, v112
    v_mfma_f32_16x16x32_bf16 v[156:159], v[68:71], v[180:183], v[156:159]
    ds_read_b64_tr_b16 v[60:61], v23 offset:0
    ds_read_b64_tr_b16 v[62:63], v23 offset:4096
    v_cvt_pk_bf16_f32 v113, 0, v113
    v_cvt_pk_bf16_f32 v114, 0, v114
    v_cvt_pk_bf16_f32 v115, 0, v115
    v_fma_f32 v112, v112, s32, -v2
    s_waitcnt lgkmcnt(9)
    v_mfma_f32_16x16x32_bf16 v[152:155], v[72:75], v[168:171], v[152:155]
    v_fma_f32 v113, v113, s32, -v2
    v_fma_f32 v114, v114, s32, -v2
    v_fma_f32 v115, v115, s32, -v2
    v_exp_f32 v112, v112
    v_mfma_f32_16x16x32_bf16 v[156:159], v[72:75], v[184:187], v[156:159]
    ds_read_b64_tr_b16 v[64:65], v24 offset:0
    ds_read_b64_tr_b16 v[66:67], v24 offset:4096
    v_exp_f32 v113, v113
    v_exp_f32 v114, v114
    v_exp_f32 v115, v115
    s_waitcnt lgkmcnt(10)
    v_mfma_f32_16x16x32_bf16 v[152:155], v[76:79], v[172:175], v[152:155]
    v_cvt_pk_bf16_f32 v88, v112, v113
    v_cvt_pk_bf16_f32 v89, v114, v115
    v_cvt_pk_bf16_f32 v116, 0, v116
    v_cvt_pk_bf16_f32 v117, 0, v117
    v_mfma_f32_16x16x32_bf16 v[156:159], v[76:79], v[188:191], v[156:159]
    ds_read_b64_tr_b16 v[68:69], v25 offset:0
    ds_read_b64_tr_b16 v[70:71], v25 offset:4096
    v_cvt_pk_bf16_f32 v118, 0, v118
    v_cvt_pk_bf16_f32 v119, 0, v119
    v_mul_f32 v116, s34, v116
    s_waitcnt lgkmcnt(10)
    v_mfma_f32_16x16x32_bf16 v[192:195], v[48:51], v[80:83], v[192:195]
    v_mul_f32 v117, s34, v117
    v_mul_f32 v118, s34, v118
    v_mul_f32 v119, s34, v119
    v_cvt_pk_bf16_f32 v116, 0, v116
    v_mfma_f32_16x16x32_bf16 v[196:199], v[48:51], v[84:87], v[196:199]
    ds_read_b64_tr_b16 v[72:73], v26 offset:0
    ds_read_b64_tr_b16 v[74:75], v26 offset:4096
    v_cvt_pk_bf16_f32 v117, 0, v117
    v_cvt_pk_bf16_f32 v118, 0, v118
    v_cvt_pk_bf16_f32 v119, 0, v119
    v_fma_f32 v116, v116, s32, -v3
    s_waitcnt lgkmcnt(10)
    v_mfma_f32_16x16x32_bf16 v[200:203], v[52:55], v[80:83], v[200:203]
    s_setprio 1
    v_fma_f32 v117, v117, s32, -v3
    v_fma_f32 v118, v118, s32, -v3
    v_fma_f32 v119, v119, s32, -v3
    v_mfma_f32_16x16x32_bf16 v[204:207], v[52:55], v[84:87], v[204:207]
    ds_read_b64_tr_b16 v[76:77], v27 offset:0
    ds_read_b64_tr_b16 v[78:79], v27 offset:4096
    v_exp_f32 v116, v116
    v_exp_f32 v117, v117
    v_exp_f32 v118, v118
    v_exp_f32 v119, v119
    s_waitcnt lgkmcnt(10)
    v_mfma_f32_16x16x32_bf16 v[208:211], v[56:59], v[80:83], v[208:211]
    v_cvt_pk_bf16_f32 v92, v116, v117
    v_cvt_pk_bf16_f32 v93, v118, v119
    v_cvt_pk_bf16_f32 v120, 0, v120
    s_nop 0
    v_mfma_f32_16x16x32_bf16 v[212:215], v[56:59], v[84:87], v[212:215]
    ds_read_b64_tr_b16 v[48:49], v20 offset:8192
    ds_read_b64_tr_b16 v[50:51], v20 offset:12288
    v_cvt_pk_bf16_f32 v121, 0, v121
    v_cvt_pk_bf16_f32 v122, 0, v122
    v_cvt_pk_bf16_f32 v123, 0, v123
    v_mul_f32 v120, s34, v120
    s_waitcnt lgkmcnt(10)
    v_mfma_f32_16x16x32_bf16 v[216:219], v[60:63], v[80:83], v[216:219]
    v_mul_f32 v121, s34, v121
    v_mul_f32 v122, s34, v122
    v_mul_f32 v123, s34, v123
    v_cvt_pk_bf16_f32 v120, 0, v120
    v_mfma_f32_16x16x32_bf16 v[220:223], v[60:63], v[84:87], v[220:223]
    ds_read_b64_tr_b16 v[52:53], v21 offset:8192
    ds_read_b64_tr_b16 v[54:55], v21 offset:12288
    v_cvt_pk_bf16_f32 v121, 0, v121
    v_cvt_pk_bf16_f32 v122, 0, v122
    v_cvt_pk_bf16_f32 v123, 0, v123
    s_waitcnt lgkmcnt(10)
    v_mfma_f32_16x16x32_bf16 v[224:227], v[64:67], v[80:83], v[224:227]
    v_fma_f32 v120, v120, s32, -v2
    v_fma_f32 v121, v121, s32, -v2
    v_fma_f32 v122, v122, s32, -v2
    v_fma_f32 v123, v123, s32, -v2
    v_mfma_f32_16x16x32_bf16 v[228:231], v[64:67], v[84:87], v[228:231]
    ds_read_b64_tr_b16 v[56:57], v22 offset:8192
    ds_read_b64_tr_b16 v[58:59], v22 offset:12288
    v_exp_f32 v120, v120
    v_exp_f32 v121, v121
    v_exp_f32 v122, v122
    s_waitcnt lgkmcnt(10)
    v_mfma_f32_16x16x32_bf16 v[232:235], v[68:71], v[80:83], v[232:235]
    v_exp_f32 v123, v123
    v_cvt_pk_bf16_f32 v90, v120, v121
    v_cvt_pk_bf16_f32 v91, v122, v123
    v_cvt_pk_bf16_f32 v124, 0, v124
    s_nop 0
    v_mfma_f32_16x16x32_bf16 v[236:239], v[68:71], v[84:87], v[236:239]
    ds_read_b64_tr_b16 v[60:61], v23 offset:8192
    ds_read_b64_tr_b16 v[62:63], v23 offset:12288
    v_cvt_pk_bf16_f32 v125, 0, v125
    v_cvt_pk_bf16_f32 v126, 0, v126
    v_cvt_pk_bf16_f32 v127, 0, v127
    v_mul_f32 v124, s34, v124
    s_waitcnt lgkmcnt(10)
    v_mfma_f32_16x16x32_bf16 v[240:243], v[72:75], v[80:83], v[240:243]
    v_mul_f32 v125, s34, v125
    v_mul_f32 v126, s34, v126
    v_mul_f32 v127, s34, v127
    v_mfma_f32_16x16x32_bf16 v[244:247], v[72:75], v[84:87], v[244:247]
    ds_read_b64_tr_b16 v[64:65], v24 offset:8192
    ds_read_b64_tr_b16 v[66:67], v24 offset:12288
    v_cvt_pk_bf16_f32 v124, 0, v124
    v_cvt_pk_bf16_f32 v125, 0, v125
    v_cvt_pk_bf16_f32 v126, 0, v126
    v_cvt_pk_bf16_f32 v127, 0, v127
    s_waitcnt lgkmcnt(10)
    v_mfma_f32_16x16x32_bf16 v[248:251], v[76:79], v[80:83], v[248:251]
    v_fma_f32 v124, v124, s32, -v3
    v_fma_f32 v125, v125, s32, -v3
    v_fma_f32 v126, v126, s32, -v3
    v_mfma_f32_16x16x32_bf16 v[252:255], v[76:79], v[84:87], v[252:255]
    ds_read_b64_tr_b16 v[68:69], v25 offset:8192
    ds_read_b64_tr_b16 v[70:71], v25 offset:12288
    v_fma_f32 v127, v127, s32, -v3
    v_exp_f32 v124, v124
    v_exp_f32 v125, v125
    v_exp_f32 v126, v126
    v_mfma_f32_16x16x32_bf16 v[32:35], v[12:15], v[80:83], v[32:35]
    v_exp_f32 v127, v127
    v_cvt_pk_bf16_f32 v94, v124, v125
    v_cvt_pk_bf16_f32 v95, v126, v127
    s_nop 1
    v_mfma_f32_16x16x32_bf16 v[36:39], v[12:15], v[84:87], v[36:39]
    s_waitcnt lgkmcnt(10)
    v_mfma_f32_16x16x32_bf16 v[192:195], v[48:51], v[88:91], v[192:195]
    v_mfma_f32_16x16x32_bf16 v[196:199], v[48:51], v[92:95], v[196:199]
    ds_read_b64_tr_b16 v[72:73], v26 offset:8192
    ds_read_b64_tr_b16 v[74:75], v26 offset:12288
    s_setprio 0
    s_waitcnt lgkmcnt(10)
    v_mfma_f32_16x16x32_bf16 v[200:203], v[52:55], v[88:91], v[200:203]
    v_max3_f32 v4, v128, v129, v130
    v_max3_f32 v5, v132, v133, v134
    v_mfma_f32_16x16x32_bf16 v[204:207], v[52:55], v[92:95], v[204:207]
    ds_read_b64_tr_b16 v[76:77], v27 offset:8192
    ds_read_b64_tr_b16 v[78:79], v27 offset:12288
    v_max3_f32 v4, v4, v131, v136
    v_max3_f32 v5, v5, v135, v140
    s_waitcnt lgkmcnt(10)
    v_mfma_f32_16x16x32_bf16 v[208:211], v[56:59], v[88:91], v[208:211]
    v_max3_f32 v4, v4, v137, v138
    v_max3_f32 v5, v5, v141, v142
    v_mfma_f32_16x16x32_bf16 v[212:215], v[56:59], v[92:95], v[212:215]
    ds_read_b64_tr_b16 v[48:49], v20 offset:16384
    ds_read_b64_tr_b16 v[50:51], v20 offset:20480
    v_max3_f32 v4, v4, v139, v144
    s_waitcnt lgkmcnt(10)
    v_mfma_f32_16x16x32_bf16 v[216:219], v[60:63], v[88:91], v[216:219]
    v_max3_f32 v5, v5, v143, v148
    v_max3_f32 v4, v4, v145, v146
    v_mfma_f32_16x16x32_bf16 v[220:223], v[60:63], v[92:95], v[220:223]
    ds_read_b64_tr_b16 v[52:53], v21 offset:16384
    ds_read_b64_tr_b16 v[54:55], v21 offset:20480
    v_max3_f32 v5, v5, v149, v150
    v_max3_f32 v4, v4, v147, v152
    s_waitcnt lgkmcnt(10)
    v_mfma_f32_16x16x32_bf16 v[224:227], v[64:67], v[88:91], v[224:227]
    v_max3_f32 v5, v5, v151, v156
    v_max3_f32 v4, v4, v153, v154
    v_mfma_f32_16x16x32_bf16 v[228:231], v[64:67], v[92:95], v[228:231]
    ds_read_b64_tr_b16 v[56:57], v22 offset:16384
    ds_read_b64_tr_b16 v[58:59], v22 offset:20480
    v_max3_f32 v5, v5, v157, v158
    s_waitcnt lgkmcnt(10)
    v_mfma_f32_16x16x32_bf16 v[232:235], v[68:71], v[88:91], v[232:235]
    v_max_f32 v4, v4, v155
    v_max_f32 v5, v5, v159
    v_mfma_f32_16x16x32_bf16 v[236:239], v[68:71], v[92:95], v[236:239]
    ds_read_b64_tr_b16 v[60:61], v23 offset:16384
    ds_read_b64_tr_b16 v[62:63], v23 offset:20480
    s_nop 1
    v_permlane32_swap_b32 v4, v5
    s_waitcnt lgkmcnt(10)
    v_mfma_f32_16x16x32_bf16 v[240:243], v[72:75], v[88:91], v[240:243]
    v_max_f32 v4, v4, v5
    v_mov_b32 v6, v4
    v_mfma_f32_16x16x32_bf16 v[244:247], v[72:75], v[92:95], v[244:247]
    ds_read_b64_tr_b16 v[64:65], v24 offset:16384
    ds_read_b64_tr_b16 v[66:67], v24 offset:20480
    v_add_f32 v5, 0x41000000, v1
    s_waitcnt lgkmcnt(10)
    v_mfma_f32_16x16x32_bf16 v[248:251], v[76:79], v[88:91], v[248:251]
    s_nop 0
    v_permlane16_swap_b32 v4, v6
    v_mfma_f32_16x16x32_bf16 v[252:255], v[76:79], v[92:95], v[252:255]
    ds_read_b64_tr_b16 v[68:69], v25 offset:16384
    ds_read_b64_tr_b16 v[70:71], v25 offset:20480
    v_max_f32 v4, v4, v6
    v_cvt_pk_bf16_f32 v4, 0, v4
    v_mfma_f32_16x16x32_bf16 v[32:35], v[12:15], v[88:91], v[32:35]
    v_mul_f32 v4, s34, v4
    v_cvt_pk_bf16_f32 v4, 0, v4
    v_mfma_f32_16x16x32_bf16 v[36:39], v[12:15], v[92:95], v[36:39]
    v_mul_f32 v4, s32, v4
    v_cmp_gt_f32 vcc, v4, v5
    s_nop 1
    s_cbranch_vccz L_k3_skip9
    s_nop 15
    v_max_f32 v4, v4, v1
    v_sub_f32 v5, v1, v4
    v_exp_f32 v5, v5
    v_mov_b32 v1, v4
    v_mov_b32 v2, v4
    v_mov_b32 v3, v4
    v_mov_b32 v6, v5
    s_nop 1
    v_permlane32_swap_b32 v2, v3
    v_permlane32_swap_b32 v5, v6
    s_nop 1
    v_mul_f32 v32, v32, v5
    v_mul_f32 v36, v36, v6
    v_mul_f32 v192, v192, v5
    v_mul_f32 v193, v193, v5
    v_mul_f32 v194, v194, v5
    v_mul_f32 v195, v195, v5
    v_mul_f32 v196, v196, v6
    v_mul_f32 v197, v197, v6
    v_mul_f32 v198, v198, v6
    v_mul_f32 v199, v199, v6
    v_mul_f32 v200, v200, v5
    v_mul_f32 v201, v201, v5
    v_mul_f32 v202, v202, v5
    v_mul_f32 v203, v203, v5
    v_mul_f32 v204, v204, v6
    v_mul_f32 v205, v205, v6
    v_mul_f32 v206, v206, v6
    v_mul_f32 v207, v207, v6
    v_mul_f32 v208, v208, v5
    v_mul_f32 v209, v209, v5
    v_mul_f32 v210, v210, v5
    v_mul_f32 v211, v211, v5
    v_mul_f32 v212, v212, v6
    v_mul_f32 v213, v213, v6
    v_mul_f32 v214, v214, v6
    v_mul_f32 v215, v215, v6
    v_mul_f32 v216, v216, v5
    v_mul_f32 v217, v217, v5
    v_mul_f32 v218, v218, v5
    v_mul_f32 v219, v219, v5
    v_mul_f32 v220, v220, v6
    v_mul_f32 v221, v221, v6
    v_mul_f32 v222, v222, v6
    v_mul_f32 v223, v223, v6
    v_mul_f32 v224, v224, v5
    v_mul_f32 v225, v225, v5
    v_mul_f32 v226, v226, v5
    v_mul_f32 v227, v227, v5
    v_mul_f32 v228, v228, v6
    v_mul_f32 v229, v229, v6
    v_mul_f32 v230, v230, v6
    v_mul_f32 v231, v231, v6
    v_mul_f32 v232, v232, v5
    v_mul_f32 v233, v233, v5
    v_mul_f32 v234, v234, v5
    v_mul_f32 v235, v235, v5
    v_mul_f32 v236, v236, v6
    v_mul_f32 v237, v237, v6
    v_mul_f32 v238, v238, v6
    v_mul_f32 v239, v239, v6
    v_mul_f32 v240, v240, v5
    v_mul_f32 v241, v241, v5
    v_mul_f32 v242, v242, v5
    v_mul_f32 v243, v243, v5
    v_mul_f32 v244, v244, v6
    v_mul_f32 v245, v245, v6
    v_mul_f32 v246, v246, v6
    v_mul_f32 v247, v247, v6
    v_mul_f32 v248, v248, v5
    v_mul_f32 v249, v249, v5
    v_mul_f32 v250, v250, v5
    v_mul_f32 v251, v251, v5
    v_mul_f32 v252, v252, v6
    v_mul_f32 v253, v253, v6
    v_mul_f32 v254, v254, v6
    v_mul_f32 v255, v255, v6
    s_nop 1
L_k3_skip9:
    v_cvt_pk_bf16_f32 v128, 0, v128
    v_cvt_pk_bf16_f32 v129, 0, v129
    v_cvt_pk_bf16_f32 v130, 0, v130
    v_cvt_pk_bf16_f32 v131, 0, v131
    v_mul_f32 v128, s34, v128
    v_mul_f32 v129, s34, v129
    v_mul_f32 v130, s34, v130
    v_mul_f32 v131, s34, v131
    v_cvt_pk_bf16_f32 v128, 0, v128
    v_cvt_pk_bf16_f32 v129, 0, v129
    v_cvt_pk_bf16_f32 v130, 0, v130
    v_cvt_pk_bf16_f32 v131, 0, v131
    v_fma_f32 v128, v128, s32, -v2
    v_fma_f32 v129, v129, s32, -v2
    v_fma_f32 v130, v130, s32, -v2
    v_fma_f32 v131, v131, s32, -v2
    v_exp_f32 v128, v128
    v_exp_f32 v129, v129
    v_exp_f32 v130, v130
    v_exp_f32 v131, v131
    v_cvt_pk_bf16_f32 v80, v128, v129
    v_cvt_pk_bf16_f32 v81, v130, v131
    v_cvt_pk_bf16_f32 v132, 0, v132
    v_cvt_pk_bf16_f32 v133, 0, v133
    v_cvt_pk_bf16_f32 v134, 0, v134
    v_cvt_pk_bf16_f32 v135, 0, v135
    v_mul_f32 v132, s34, v132
    v_mul_f32 v133, s34, v133
    v_mul_f32 v134, s34, v134
    v_mul_f32 v135, s34, v135
    v_cvt_pk_bf16_f32 v132, 0, v132
    v_cvt_pk_bf16_f32 v133, 0, v133
    v_cvt_pk_bf16_f32 v134, 0, v134
    v_cvt_pk_bf16_f32 v135, 0, v135
    v_fma_f32 v132, v132, s32, -v3
    v_fma_f32 v133, v133, s32, -v3
    v_fma_f32 v134, v134, s32, -v3
    v_fma_f32 v135, v135, s32, -v3
    v_exp_f32 v132, v132
    v_exp_f32 v133, v133
    v_exp_f32 v134, v134
    v_exp_f32 v135, v135
    v_cvt_pk_bf16_f32 v84, v132, v133
    v_cvt_pk_bf16_f32 v85, v134, v135
    v_cvt_pk_bf16_f32 v136, 0, v136
    v_cvt_pk_bf16_f32 v137, 0, v137
    v_cvt_pk_bf16_f32 v138, 0, v138
    v_cvt_pk_bf16_f32 v139, 0, v139
    v_mul_f32 v136, s34, v136
    v_mul_f32 v137, s34, v137
    v_mul_f32 v138, s34, v138
    v_mul_f32 v139, s34, v139
    v_cvt_pk_bf16_f32 v136, 0, v136
    v_cvt_pk_bf16_f32 v137, 0, v137
    v_cvt_pk_bf16_f32 v138, 0, v138
    v_cvt_pk_bf16_f32 v139, 0, v139
    v_fma_f32 v136, v136, s32, -v2
    v_fma_f32 v137, v137, s32, -v2
    v_fma_f32 v138, v138, s32, -v2
    v_fma_f32 v139, v139, s32, -v2
    v_exp_f32 v136, v136
    v_exp_f32 v137, v137
    v_exp_f32 v138, v138
    v_exp_f32 v139, v139
    v_cvt_pk_bf16_f32 v82, v136, v137
    v_cvt_pk_bf16_f32 v83, v138, v139
    v_cvt_pk_bf16_f32 v140, 0, v140
    v_cvt_pk_bf16_f32 v141, 0, v141
    v_cvt_pk_bf16_f32 v142, 0, v142
    v_cvt_pk_bf16_f32 v143, 0, v143
    v_mul_f32 v140, s34, v140
    v_mul_f32 v141, s34, v141
    v_mul_f32 v142, s34, v142
    v_mul_f32 v143, s34, v143
    v_cvt_pk_bf16_f32 v140, 0, v140
    v_cvt_pk_bf16_f32 v141, 0, v141
    v_cvt_pk_bf16_f32 v142, 0, v142
    v_cvt_pk_bf16_f32 v143, 0, v143
    v_fma_f32 v140, v140, s32, -v3
    v_fma_f32 v141, v141, s32, -v3
    v_fma_f32 v142, v142, s32, -v3
    v_fma_f32 v143, v143, s32, -v3
    v_exp_f32 v140, v140
    v_exp_f32 v141, v141
    v_exp_f32 v142, v142
    v_exp_f32 v143, v143
    v_cvt_pk_bf16_f32 v86, v140, v141
    v_cvt_pk_bf16_f32 v87, v142, v143
    s_waitcnt lgkmcnt(10)
    s_nop 0
    v_mfma_f32_16x16x32_bf16 v[192:195], v[48:51], v[80:83], v[192:195]
    v_cvt_pk_bf16_f32 v144, 0, v144
    v_cvt_pk_bf16_f32 v145, 0, v145
    v_cvt_pk_bf16_f32 v146, 0, v146
    v_cvt_pk_bf16_f32 v147, 0, v147
    v_mul_f32 v144, s34, v144
    v_mul_f32 v145, s34, v145
    v_mfma_f32_16x16x32_bf16 v[196:199], v[48:51], v[84:87], v[196:199]
    ds_read_b64_tr_b16 v[72:73], v26 offset:16384
    ds_read_b64_tr_b16 v[74:75], v26 offset:20480
    v_mul_f32 v146, s34, v146
    v_mul_f32 v147, s34, v147
    v_cvt_pk_bf16_f32 v144, 0, v144
    v_cvt_pk_bf16_f32 v145, 0, v145
    v_cvt_pk_bf16_f32 v146, 0, v146
    s_waitcnt lgkmcnt(10)
    v_mfma_f32_16x16x32_bf16 v[200:203], v[52:55], v[80:83], v[200:203]
    v_cvt_pk_bf16_f32 v147, 0, v147
    v_fma_f32 v144, v144, s32, -v2
    v_fma_f32 v145, v145, s32, -v2
    v_fma_f32 v146, v146, s32, -v2
    v_fma_f32 v147, v147, s32, -v2
    v_mfma_f32_16x16x32_bf16 v[204:207], v[52:55], v[84:87], v[204:207]
    ds_read_b64_tr_b16 v[76:77], v27 offset:16384
    ds_read_b64_tr_b16 v[78:79], v27 offset:20480
    v_exp_f32 v144, v144
    v_exp_f32 v145, v145
    v_exp_f32 v146, v146
    v_exp_f32 v147, v147
    v_cvt_pk_bf16_f32 v88, v144, v145
    s_waitcnt lgkmcnt(10)
    s_nop 0
    v_mfma_f32_16x16x32_bf16 v[208:211], v[56:59], v[80:83], v[208:211]
    v_cvt_pk_bf16_f32 v89, v146, v147
    v_cvt_pk_bf16_f32 v148, 0, v148
    v_cvt_pk_bf16_f32 v149, 0, v149
    v_cvt_pk_bf16_f32 v150, 0, v150
    v_cvt_pk_bf16_f32 v151, 0, v151
    v_mfma_f32_16x16x32_bf16 v[212:215], v[56:59], v[84:87], v[212:215]
    ds_read_b64_tr_b16 v[48:49], v20 offset:24576
    ds_read_b64_tr_b16 v[50:51], v20 offset:28672
    v_mul_f32 v148, s34, v148
    v_mul_f32 v149, s34, v149
    v_mul_f32 v150, s34, v150
    v_mul_f32 v151, s34, v151
    v_cvt_pk_bf16_f32 v148, 0, v148
    v_cvt_pk_bf16_f32 v149, 0, v149
    s_waitcnt lgkmcnt(10)
    v_mfma_f32_16x16x32_bf16 v[216:219], v[60:63], v[80:83], v[216:219]
    v_cvt_pk_bf16_f32 v150, 0, v150
    v_cvt_pk_bf16_f32 v151, 0, v151
    v_fma_f32 v148, v148, s32, -v3
    v_fma_f32 v149, v149, s32, -v3
    v_fma_f32 v150, v150, s32, -v3
    v_mfma_f32_16x16x32_bf16 v[220:223], v[60:63], v[84:87], v[220:223]
    ds_read_b64_tr_b16 v[52:53], v21 offset:24576
    ds_read_b64_tr_b16 v[54:55], v21 offset:28672
    v_fma_f32 v151, v151, s32, -v3
    v_exp_f32 v148, v148
    v_exp_f32 v149, v149
    v_exp_f32 v150, v150
    v_exp_f32 v151, v151
    s_waitcnt lgkmcnt(10)
    v_mfma_f32_16x16x32_bf16 v[224:227], v[64:67], v[80:83], v[224:227]
    v_cvt_pk_bf16_f32 v92, v148, v149
    v_cvt_pk_bf16_f32 v93, v150, v151
    v_cvt_pk_bf16_f32 v152, 0, v152
    v_cvt_pk_bf16_f32 v153, 0, v153
    v_cvt_pk_bf16_f32 v154, 0, v154
    v_mfma_f32_16x16x32_bf16 v[228:231], v[64:67], v[84:87], v[228:231]
    ds_read_b64_tr_b16 v[56:57], v22 offset:24576
    ds_read_b64_tr_b16 v[58:59], v22 offset:28672
    v_cvt_pk_bf16_f32 v155, 0, v155
    v_mul_f32 v152, s34, v152
    v_mul_f32 v153, s34, v153
    v_mul_f32 v154, s34, v154
    v_mul_f32 v155, s34, v155
    s_waitcnt lgkmcnt(10)
    v_mfma_f32_16x16x32_bf16 v[232:235], v[68:71], v[80:83], v[232:235]
    v_cvt_pk_bf16_f32 v152, 0, v152
    v_cvt_pk_bf16_f32 v153, 0, v153
    v_cvt_pk_bf16_f32 v154, 0, v154
    v_cvt_pk_bf16_f32 v155, 0, v155
    v_fma_f32 v152, v152, s32, -v2
    v_mfma_f32_16x16x32_bf16 v[236:239], v[68:71], v[84:87], v[236:239]
    ds_read_b64_tr_b16 v[60:61], v23 offset:24576
    ds_read_b64_tr_b16 v[62:63], v23 offset:28672
    v_fma_f32 v153, v153, s32, -v2
    v_fma_f32 v154, v154, s32, -v2
    v_fma_f32 v155, v155, s32, -v2
    v_exp_f32 v152, v152
    v_exp_f32 v153, v153
    v_exp_f32 v154, v154
    s_waitcnt lgkmcnt(10)
    v_mfma_f32_16x16x32_bf16 v[240:243], v[72:75], v[80:83], v[240:243]
    v_exp_f32 v155, v155
    v_cvt_pk_bf16_f32 v90, v152, v153
    v_cvt_pk_bf16_f32 v91, v154, v155
    v_cvt_pk_bf16_f32 v156, 0, v156
    v_cvt_pk_bf16_f32 v157, 0, v157
    v_mfma_f32_16x16x32_bf16 v[244:247], v[72:75], v[84:87], v[244:247]
    ds_read_b64_tr_b16 v[64:65], v24 offset:24576
    ds_read_b64_tr_b16 v[66:67], v24 offset:28672
    v_cvt_pk_bf16_f32 v158, 0, v158
    v_cvt_pk_bf16_f32 v159, 0, v159
    v_mul_f32 v156, s34, v156
    v_mul_f32 v157, s34, v157
    v_mul_f32 v158, s34, v158
    s_waitcnt lgkmcnt(10)
    v_mfma_f32_16x16x32_bf16 v[248:251], v[76:79], v[80:83], v[248:251]
    v_mul_f32 v159, s34, v159
    v_cvt_pk_bf16_f32 v156, 0, v156
    v_cvt_pk_bf16_f32 v157, 0, v157
    v_cvt_pk_bf16_f32 v158, 0, v158
    v_cvt_pk_bf16_f32 v159, 0, v159
    v_mfma_f32_16x16x32_bf16 v[252:255], v[76:79], v[84:87], v[252:255]
    ds_read_b64_tr_b16 v[68:69], v25 offset:24576
    ds_read_b64_tr_b16 v[70:71], v25 offset:28672
    v_fma_f32 v156, v156, s32, -v3
    v_fma_f32 v157, v157, s32, -v3
    v_fma_f32 v158, v158, s32, -v3
    v_fma_f32 v159, v159, s32, -v3
    v_exp_f32 v156, v156
    v_mfma_f32_16x16x32_bf16 v[32:35], v[12:15], v[80:83], v[32:35]
    v_exp_f32 v157, v157
    v_exp_f32 v158, v158
    v_exp_f32 v159, v159
    v_cvt_pk_bf16_f32 v94, v156, v157
    v_cvt_pk_bf16_f32 v95, v158, v159
    s_nop 1
    v_mfma_f32_16x16x32_bf16 v[36:39], v[12:15], v[84:87], v[36:39]
    s_waitcnt lgkmcnt(10)
    v_mfma_f32_16x16x32_bf16 v[192:195], v[48:51], v[88:91], v[192:195]
    v_mfma_f32_16x16x32_bf16 v[196:199], v[48:51], v[92:95], v[196:199]
    ds_read_b64_tr_b16 v[72:73], v26 offset:24576
    ds_read_b64_tr_b16 v[74:75], v26 offset:28672
    s_waitcnt lgkmcnt(10)
    v_mfma_f32_16x16x32_bf16 v[200:203], v[52:55], v[88:91], v[200:203]
    v_mfma_f32_16x16x32_bf16 v[204:207], v[52:55], v[92:95], v[204:207]
    ds_read_b64_tr_b16 v[76:77], v27 offset:24576
    ds_read_b64_tr_b16 v[78:79], v27 offset:28672
    s_waitcnt lgkmcnt(10)
    v_mfma_f32_16x16x32_bf16 v[208:211], v[56:59], v[88:91], v[208:211]
    v_mfma_f32_16x16x32_bf16 v[212:215], v[56:59], v[92:95], v[212:215]
    s_waitcnt lgkmcnt(8)
    v_mfma_f32_16x16x32_bf16 v[216:219], v[60:63], v[88:91], v[216:219]
    v_mfma_f32_16x16x32_bf16 v[220:223], v[60:63], v[92:95], v[220:223]
    s_waitcnt lgkmcnt(6)
    v_mfma_f32_16x16x32_bf16 v[224:227], v[64:67], v[88:91], v[224:227]
    v_mfma_f32_16x16x32_bf16 v[228:231], v[64:67], v[92:95], v[228:231]
    s_waitcnt lgkmcnt(4)
    v_mfma_f32_16x16x32_bf16 v[232:235], v[68:71], v[88:91], v[232:235]
    v_mfma_f32_16x16x32_bf16 v[236:239], v[68:71], v[92:95], v[236:239]
    s_waitcnt lgkmcnt(2)
    v_mfma_f32_16x16x32_bf16 v[240:243], v[72:75], v[88:91], v[240:243]
    v_mfma_f32_16x16x32_bf16 v[244:247], v[72:75], v[92:95], v[244:247]
    s_waitcnt lgkmcnt(0)
    v_mfma_f32_16x16x32_bf16 v[248:251], v[76:79], v[88:91], v[248:251]
    v_mfma_f32_16x16x32_bf16 v[252:255], v[76:79], v[92:95], v[252:255]
    v_mfma_f32_16x16x32_bf16 v[32:35], v[12:15], v[88:91], v[32:35]
    v_mfma_f32_16x16x32_bf16 v[36:39], v[12:15], v[92:95], v[36:39]
    s_setprio 0
L_k3_epi:
    s_nop 15
    v_rcp_f32 v2, v32
    v_rcp_f32 v3, v36
    s_nop 0
    v_xor_b32 v8, 0, v40
    v_mul_f32 v192, v192, v2
    v_mul_f32 v193, v193, v2
    v_mul_f32 v194, v194, v2
    v_mul_f32 v195, v195, v2
    v_cvt_pk_bf16_f32 v48, v192, v193
    v_cvt_pk_bf16_f32 v49, v194, v195
    ds_write_b64 v8, v[48:49] offset:0
    v_mul_f32 v196, v196, v3
    v_mul_f32 v197, v197, v3
    v_mul_f32 v198, v198, v3
    v_mul_f32 v199, v199, v3
    v_cvt_pk_bf16_f32 v50, v196, v197
    v_cvt_pk_bf16_f32 v51, v198, v199
    ds_write_b64 v8, v[50:51] offset:4096
    v_xor_b32 v8, 32, v40
    v_mul_f32 v200, v200, v2
    v_mul_f32 v201, v201, v2
    v_mul_f32 v202, v202, v2
    v_mul_f32 v203, v203, v2
    v_cvt_pk_bf16_f32 v52, v200, v201
    v_cvt_pk_bf16_f32 v53, v202, v203
    ds_write_b64 v8, v[52:53] offset:0
    v_mul_f32 v204, v204, v3
    v_mul_f32 v205, v205, v3
    v_mul_f32 v206, v206, v3
    v_mul_f32 v207, v207, v3
    v_cvt_pk_bf16_f32 v54, v204, v205
    v_cvt_pk_bf16_f32 v55, v206, v207
    ds_write_b64 v8, v[54:55] offset:4096
    v_xor_b32 v8, 64, v40
    v_mul_f32 v208, v208, v2
    v_mul_f32 v209, v209, v2
    v_mul_f32 v210, v210, v2
    v_mul_f32 v211, v211, v2
    v_cvt_pk_bf16_f32 v56, v208, v209
    v_cvt_pk_bf16_f32 v57, v210, v211
    ds_write_b64 v8, v[56:57] offset:0
    v_mul_f32 v212, v212, v3
    v_mul_f32 v213, v213, v3
    v_mul_f32 v214, v214, v3
    v_mul_f32 v215, v215, v3
    v_cvt_pk_bf16_f32 v58, v212, v213
    v_cvt_pk_bf16_f32 v59, v214, v215
    ds_write_b64 v8, v[58:59] offset:4096
    v_xor_b32 v8, 96, v40
    v_mul_f32 v216, v216, v2
    v_mul_f32 v217, v217, v2
    v_mul_f32 v218, v218, v2
    v_mul_f32 v219, v219, v2
    v_cvt_pk_bf16_f32 v60, v216, v217
    v_cvt_pk_bf16_f32 v61, v218, v219
    ds_write_b64 v8, v[60:61] offset:0
    v_mul_f32 v220, v220, v3
    v_mul_f32 v221, v221, v3
    v_mul_f32 v222, v222, v3
    v_mul_f32 v223, v223, v3
    v_cvt_pk_bf16_f32 v62, v220, v221
    v_cvt_pk_bf16_f32 v63, v222, v223
    ds_write_b64 v8, v[62:63] offset:4096
    v_xor_b32 v8, 128, v40
    v_mul_f32 v224, v224, v2
    v_mul_f32 v225, v225, v2
    v_mul_f32 v226, v226, v2
    v_mul_f32 v227, v227, v2
    v_cvt_pk_bf16_f32 v64, v224, v225
    v_cvt_pk_bf16_f32 v65, v226, v227
    ds_write_b64 v8, v[64:65] offset:0
    v_mul_f32 v228, v228, v3
    v_mul_f32 v229, v229, v3
    v_mul_f32 v230, v230, v3
    v_mul_f32 v231, v231, v3
    v_cvt_pk_bf16_f32 v66, v228, v229
    v_cvt_pk_bf16_f32 v67, v230, v231
    ds_write_b64 v8, v[66:67] offset:4096
    v_xor_b32 v8, 160, v40
    v_mul_f32 v232, v232, v2
    v_mul_f32 v233, v233, v2
    v_mul_f32 v234, v234, v2
    v_mul_f32 v235, v235, v2
    v_cvt_pk_bf16_f32 v68, v232, v233
    v_cvt_pk_bf16_f32 v69, v234, v235
    ds_write_b64 v8, v[68:69] offset:0
    v_mul_f32 v236, v236, v3
    v_mul_f32 v237, v237, v3
    v_mul_f32 v238, v238, v3
    v_mul_f32 v239, v239, v3
    v_cvt_pk_bf16_f32 v70, v236, v237
    v_cvt_pk_bf16_f32 v71, v238, v239
    ds_write_b64 v8, v[70:71] offset:4096
    v_xor_b32 v8, 192, v40
    v_mul_f32 v240, v240, v2
    v_mul_f32 v241, v241, v2
    v_mul_f32 v242, v242, v2
    v_mul_f32 v243, v243, v2
    v_cvt_pk_bf16_f32 v72, v240, v241
    v_cvt_pk_bf16_f32 v73, v242, v243
    ds_write_b64 v8, v[72:73] offset:0
    v_mul_f32 v244, v244, v3
    v_mul_f32 v245, v245, v3
    v_mul_f32 v246, v246, v3
    v_mul_f32 v247, v247, v3
    v_cvt_pk_bf16_f32 v74, v244, v245
    v_cvt_pk_bf16_f32 v75, v246, v247
    ds_write_b64 v8, v[74:75] offset:4096
    v_xor_b32 v8, 224, v40
    v_mul_f32 v248, v248, v2
    v_mul_f32 v249, v249, v2
    v_mul_f32 v250, v250, v2
    v_mul_f32 v251, v251, v2
    v_cvt_pk_bf16_f32 v76, v248, v249
    v_cvt_pk_bf16_f32 v77, v250, v251
    ds_write_b64 v8, v[76:77] offset:0
    v_mul_f32 v252, v252, v3
    v_mul_f32 v253, v253, v3
    v_mul_f32 v254, v254, v3
    v_mul_f32 v255, v255, v3
    v_cvt_pk_bf16_f32 v78, v252, v253
    v_cvt_pk_bf16_f32 v79, v254, v255
    ds_write_b64 v8, v[78:79] offset:4096
    v_add_u32 v8, 0, v41
    v_xor_b32 v9, v8, v42
    v_lshlrev_b32 v9, 4, v9
    v_lshl_add_u32 v9, v8, 8, v9
    v_add_u32 v16, s55, v9
    v_add_u32 v8, 4, v41
    v_xor_b32 v9, v8, v42
    v_lshlrev_b32 v9, 4, v9
    v_lshl_add_u32 v9, v8, 8, v9
    v_add_u32 v17, s55, v9
    v_add_u32 v8, 8, v41
    v_xor_b32 v9, v8, v42
    v_lshlrev_b32 v9, 4, v9
    v_lshl_add_u32 v9, v8, 8, v9
    v_add_u32 v18, s55, v9
    v_add_u32 v8, 12, v41
    v_xor_b32 v9, v8, v42
    v_lshlrev_b32 v9, 4, v9
    v_lshl_add_u32 v9, v8, 8, v9
    v_add_u32 v19, s55, v9
    s_waitcnt lgkmcnt(0)
    ds_read_b128 v[96:99], v16 offset:0
    ds_read_b128 v[100:103], v17 offset:0
    ds_read_b128 v[104:107], v18 offset:0
    ds_read_b128 v[108:111], v19 offset:0
    ds_read_b128 v[112:115], v16 offset:4096
    ds_read_b128 v[116:119], v17 offset:4096
    ds_read_b128 v[120:123], v18 offset:4096
    ds_read_b128 v[124:127], v19 offset:4096
    s_waitcnt lgkmcnt(7)
    s_mov_b32 s47, 0
    buffer_store_dwordx4 v[96:99], v0, s[24:27], s47 offen sc1
    s_waitcnt lgkmcnt(6)
    s_mov_b32 s47, 32768
    buffer_store_dwordx4 v[100:103], v0, s[24:27], s47 offen sc1
    s_waitcnt lgkmcnt(5)
    s_mov_b32 s47, 65536
    buffer_store_dwordx4 v[104:107], v0, s[24:27], s47 offen sc1
    s_waitcnt lgkmcnt(4)
    s_mov_b32 s47, 98304
    buffer_store_dwordx4 v[108:111], v0, s[24:27], s47 offen sc1
    s_waitcnt lgkmcnt(3)
    s_mov_b32 s47, 131072
    buffer_store_dwordx4 v[112:115], v0, s[24:27], s47 offen sc1
    s_waitcnt lgkmcnt(2)
    s_mov_b32 s47, 163840
    buffer_store_dwordx4 v[116:119], v0, s[24:27], s47 offen sc1
    s_waitcnt lgkmcnt(1)
    s_mov_b32 s47, 196608
    buffer_store_dwordx4 v[120:123], v0, s[24:27], s47 offen sc1
    s_waitcnt lgkmcnt(0)
    s_mov_b32 s47, 229376
    buffer_store_dwordx4 v[124:127], v0, s[24:27], s47 offen sc1
    s_add_u32 s56, s30, 0x45000
    s_addc_u32 s57, s31, 0
    s_mov_b32 s58, 16384
    s_mov_b32 s59, 0x00020000
    v_mbcnt_lo_u32_b32 v0, -1, 0
    v_mbcnt_hi_u32_b32 v0, -1, v0
    s_lshl_b32 s47, s33, 6
    v_add_u32 v0, s47, v0
    s_waitcnt vmcnt(0) lgkmcnt(0)
    s_barrier
    v_mov_b32 v4, 1
    s_lshl_b32 s47, s2, 6
    v_mov_b32 v5, s47
    v_cmp_eq_u32 vcc, 0, v0
    s_and_saveexec_b64 s[48:49], vcc
    buffer_store_dword v4, v5, s[56:59], 0 offen sc1
    s_mov_b64 exec, s[48:49]
    s_load_dwordx2 s[4:5], s[0:1], 32
    s_load_dwordx2 s[6:7], s[0:1], 112
    s_and_b32 s30, s2, 3
    s_lshr_b32 s28, s2, 2
    s_and_b32 s28, s28, 1
    s_lshl_b32 s28, s28, 3
    s_lshr_b32 s29, s2, 3
    s_and_b32 s29, s29, 7
    s_add_u32 s28, s28, s29
    s_lshr_b32 s29, s2, 6
    v_lshrrev_b32 v4, 6, v0
    v_and_b32 v5, 63, v0
    v_readfirstlane_b32 s31, v4
    v_lshrrev_b32 v6, 5, v5
    v_and_b32 v7, 31, v5
    v_and_b32 v8, 15, v5
    v_lshrrev_b32 v9, 4, v5
    s_waitcnt lgkmcnt(0)
    s_lshl_b32 s32, s28, 20
    s_lshl_b32 s33, s30, 11
    s_add_u32 s32, s32, s33
    s_add_u32 s34, s32, 0x800000
    s_add_u32 s8, s6, s34
    s_addc_u32 s9, s7, 0
    s_sub_u32 s10, 1048576, s33
    s_mov_b32 s11, 0x00020000
    s_lshl_b32 s32, s30, 20
    s_lshl_b32 s33, s29, 8
    s_add_u32 s32, s32, s33
    s_add_u32 s12, s4, s32
    s_addc_u32 s13, s5, 0
    s_sub_u32 s14, 1048576, s33
    s_mov_b32 s15, 0x00020000
    s_lshl_b32 s32, s30, 22
    s_lshl_b32 s33, s28, 18
    s_add_u32 s32, s32, s33
    s_lshl_b32 s33, s29, 9
    s_add_u32 s32, s32, s33
    s_add_u32 s32, s32, 0x1800000
    s_add_u32 s16, s6, s32
    s_addc_u32 s17, s7, 0
    s_sub_u32 s18, 262144, s33
    s_mov_b32 s19, 0x00020000
    s_and_b32 s35, s31, 1
    s_lshr_b32 s36, s31, 1
    v_lshrrev_b32 v10, 3, v5
    s_lshl_b32 s37, s31, 4
    v_add_u32 v10, s37, v10
    v_and_b32 v11, 7, v5
    v_add_u32 v12, 0, v10
    v_lshrrev_b32 v13, 1, v12
    v_and_b32 v13, 7, v13
    v_xor_b32 v13, v13, v11
    v_lshlrev_b32 v13, 4, v13
    v_lshl_add_u32 v16, v12, 13, v13
    v_add_u32 v12, 8, v10
    v_lshrrev_b32 v13, 1, v12
    v_and_b32 v13, 7, v13
    v_xor_b32 v13, v13, v11
    v_lshlrev_b32 v13, 4, v13
    v_lshl_add_u32 v17, v12, 13, v13
    v_subrev_u32 v17, 1024, v17
    s_lshl_b32 s37, s31, 3
    v_add_u32 v10, s37, v9
    v_lshlrev_b32 v11, 2, v9
    v_xor_b32 v11, v11, v8
    v_lshlrev_b32 v11, 4, v11
    v_lshl_add_u32 v18, v10, 10, v11
    v_add_u32 v19, 3072, v18
    s_lshl_b32 s37, s35, 6
    v_add_u32 v10, s37, v7
    v_lshrrev_b32 v11, 1, v10
    v_and_b32 v11, 7, v11
    v_xor_b32 v11, v11, v6
    v_lshlrev_b32 v11, 4, v11
    v_lshl_add_u32 v20, v10, 7, v11
    v_xor_b32 v21, 32, v20
    v_xor_b32 v22, 64, v20
    v_xor_b32 v23, 96, v20
    v_lshrrev_b32 v10, 2, v8
    v_lshl_add_u32 v11, v6, 3, v10
    v_lshlrev_b32 v11, 8, v11
    v_and_b32 v12, 1, v9
    v_lshl_add_u32 v11, v12, 5, v11
    v_and_b32 v12, 3, v8
    v_lshl_add_u32 v11, v12, 3, v11
    v_xor_b32 v12, s36, v10
    v_lshl_add_u32 v24, v12, 6, v11
    v_add_u32 v24, 16384, v24
    v_add_u32 v25, 0x10000, v20
    v_add_u32 v104, 0x20000, v20
    v_add_u32 v26, 0x10000, v21
    v_add_u32 v105, 0x20000, v21
    v_add_u32 v27, 0x10000, v22
    v_add_u32 v106, 0x20000, v22
    v_add_u32 v28, 0x10000, v23
    v_add_u32 v107, 0x20000, v23
    v_add_u32 v29, 0x10000, v24
    v_add_u32 v108, 0x20000, v24
    s_lshl_b32 s37, s35, 6
    v_add_u32 v10, s37, v7
    v_lshlrev_b32 v10, 11, v10
    s_lshl_b32 s37, s36, 7
    v_add_u32 v10, s37, v10
    v_lshl_add_u32 v30, v6, 4, v10
    v_add_u32 v31, 65536, v30
    s_lshl_b32 s38, s31, 11
    s_add_u32 s39, s38, 16384
    s_mov_b32 m0, s39
    s_mov_b32 s41, 0
    buffer_load_dwordx4 v18, s[12:15], s41 offen lds
    buffer_load_dwordx4 v19, s[12:15], s41 offen offset:1024 lds
    s_add_u32 s39, s38, 49152
    s_mov_b32 m0, s39
    s_mov_b32 s41, 65536
    buffer_load_dwordx4 v18, s[12:15], s41 offen lds
    buffer_load_dwordx4 v19, s[12:15], s41 offen offset:1024 lds
    s_add_u32 s39, s38, 81920
    s_mov_b32 m0, s39
    s_mov_b32 s41, 131072
    buffer_load_dwordx4 v18, s[12:15], s41 offen lds
    buffer_load_dwordx4 v19, s[12:15], s41 offen offset:1024 lds
    s_add_u32 s39, s38, 114688
    s_mov_b32 m0, s39
    s_mov_b32 s41, 196608
    buffer_load_dwordx4 v18, s[12:15], s41 offen lds
    buffer_load_dwordx4 v19, s[12:15], s41 offen offset:1024 lds
    s_add_u32 s44, s6, 0x45000
    s_addc_u32 s45, s7, 0
    s_mov_b32 s46, 16384
    s_mov_b32 s47, 0x00020000
    s_cmp_lg_u32 s31, 0
    s_cbranch_scc1 L_k4_polldone
    s_lshr_b32 s42, s28, 1
    s_lshl_b32 s42, s42, 11
    s_lshl_b32 s43, s30, 9
    s_add_u32 s42, s42, s43
    v_and_b32 v33, 7, v5
    v_lshl_add_u32 v33, v33, 6, s42
L_k4_poll:
    buffer_load_dword v32, v33, s[44:47], 0 offen sc1
    s_waitcnt vmcnt(0)
    v_cmp_ne_u32 vcc, 1, v32
    s_nop 1
    s_cbranch_vccz L_k4_polldone
    s_sleep 1
    s_branch L_k4_poll
L_k4_polldone:
    s_barrier
    s_add_u32 s39, s38, 0
    s_mov_b32 m0, s39
    s_mov_b32 s40, 0
    buffer_load_dwordx4 v16, s[8:11], s40 offen sc1 lds
    buffer_load_dwordx4 v17, s[8:11], s40 offen offset:1024 sc1 lds
    s_add_u32 s39, s38, 32768
    s_mov_b32 m0, s39
    s_mov_b32 s40, 128
    buffer_load_dwordx4 v16, s[8:11], s40 offen sc1 lds
    buffer_load_dwordx4 v17, s[8:11], s40 offen offset:1024 sc1 lds
    s_add_u32 s39, s38, 65536
    s_mov_b32 m0, s39
    s_mov_b32 s40, 256
    buffer_load_dwordx4 v16, s[8:11], s40 offen sc1 lds
    buffer_load_dwordx4 v17, s[8:11], s40 offen offset:1024 sc1 lds
    s_add_u32 s39, s38, 98304
    s_mov_b32 m0, s39
    s_mov_b32 s40, 384
    buffer_load_dwordx4 v16, s[8:11], s40 offen sc1 lds
    buffer_load_dwordx4 v17, s[8:11], s40 offen offset:1024 sc1 lds
    s_waitcnt vmcnt(4)
    s_barrier
    ds_read_b64_tr_b16 v[32:33], v24 offset:0
    ds_read_b64_tr_b16 v[34:35], v24 offset:1024
    ds_read_b128 v[36:39], v20 offset:0
    ds_read_b128 v[40:43], v20 offset:4096
    ds_read_b64_tr_b16 v[44:45], v24 offset:4096
    ds_read_b64_tr_b16 v[46:47], v24 offset:5120
    ds_read_b128 v[48:51], v21 offset:0
    ds_read_b128 v[52:55], v21 offset:4096
    ds_read_b64_tr_b16 v[56:57], v24 offset:8192
    ds_read_b64_tr_b16 v[58:59], v24 offset:9216
    ds_read_b128 v[60:63], v22 offset:0
    ds_read_b128 v[64:67], v22 offset:4096
    s_waitcnt lgkmcnt(8)
    v_mfma_f32_32x32x16_bf16 v[72:87], v[32:35], v[36:39], 0
    s_add_u32 s39, s38, 131072
    s_mov_b32 m0, s39
    s_mov_b32 s40, 512
    buffer_load_dwordx4 v16, s[8:11], s40 offen sc1 lds
    buffer_load_dwordx4 v17, s[8:11], s40 offen offset:1024 sc1 lds
    s_add_u32 s39, s38, 147456
    s_mov_b32 m0, s39
    s_mov_b32 s41, 262144
    buffer_load_dwordx4 v18, s[12:15], s41 offen lds
    buffer_load_dwordx4 v19, s[12:15], s41 offen offset:1024 lds
    v_mfma_f32_32x32x16_bf16 v[88:103], v[32:35], v[40:43], 0
    ds_read_b64_tr_b16 v[32:33], v24 offset:12288
    ds_read_b64_tr_b16 v[34:35], v24 offset:13312
    ds_read_b128 v[36:39], v23 offset:0
    ds_read_b128 v[40:43], v23 offset:4096
    s_waitcnt lgkmcnt(8)
    v_mfma_f32_32x32x16_bf16 v[72:87], v[44:47], v[48:51], v[72:87]
    v_mfma_f32_32x32x16_bf16 v[88:103], v[44:47], v[52:55], v[88:103]
    ds_read_b64_tr_b16 v[44:45], v24 offset:32768
    ds_read_b64_tr_b16 v[46:47], v24 offset:33792
    ds_read_b128 v[48:51], v20 offset:32768
    ds_read_b128 v[52:55], v20 offset:36864
    s_waitcnt lgkmcnt(8)
    v_mfma_f32_32x32x16_bf16 v[72:87], v[56:59], v[60:63], v[72:87]
    v_mfma_f32_32x32x16_bf16 v[88:103], v[56:59], v[64:67], v[88:103]
    ds_read_b64_tr_b16 v[56:57], v24 offset:36864
    ds_read_b64_tr_b16 v[58:59], v24 offset:37888
    ds_read_b128 v[60:63], v21 offset:32768
    ds_read_b128 v[64:67], v21 offset:36864
    s_waitcnt lgkmcnt(8)
    v_mfma_f32_32x32x16_bf16 v[72:87], v[32:35], v[36:39], v[72:87]
    v_mfma_f32_32x32x16_bf16 v[88:103], v[32:35], v[40:43], v[88:103]
    s_waitcnt vmcnt(6)
    s_barrier
    ds_read_b64_tr_b16 v[32:33], v24 offset:40960
    ds_read_b64_tr_b16 v[34:35], v24 offset:41984
    ds_read_b128 v[36:39], v22 offset:32768
    ds_read_b128 v[40:43], v22 offset:36864
    s_waitcnt lgkmcnt(8)
    v_mfma_f32_32x32x16_bf16 v[72:87], v[44:47], v[48:51], v[72:87]
    s_add_u32 s39, s38, 0
    s_mov_b32 m0, s39
    s_mov_b32 s40, 640
    buffer_load_dwordx4 v16, s[8:11], s40 offen sc1 lds
    buffer_load_dwordx4 v17, s[8:11], s40 offen offset:1024 sc1 lds
    s_add_u32 s39, s38, 16384
    s_mov_b32 m0, s39
    s_mov_b32 s41, 327680
    buffer_load_dwordx4 v18, s[12:15], s41 offen lds
    buffer_load_dwordx4 v19, s[12:15], s41 offen offset:1024 lds
    v_mfma_f32_32x32x16_bf16 v[88:103], v[44:47], v[52:55], v[88:103]
    ds_read_b64_tr_b16 v[44:45], v24 offset:45056
    ds_read_b64_tr_b16 v[46:47], v24 offset:46080
    ds_read_b128 v[48:51], v23 offset:32768
    ds_read_b128 v[52:55], v23 offset:36864
    s_waitcnt lgkmcnt(8)
    v_mfma_f32_32x32x16_bf16 v[72:87], v[56:59], v[60:63], v[72:87]
    v_mfma_f32_32x32x16_bf16 v[88:103], v[56:59], v[64:67], v[88:103]
    ds_read_b64_tr_b16 v[56:57], v29 offset:0
    ds_read_b64_tr_b16 v[58:59], v29 offset:1024
    ds_read_b128 v[60:63], v25 offset:0
    ds_read_b128 v[64:67], v25 offset:4096
    s_waitcnt lgkmcnt(8)
    v_mfma_f32_32x32x16_bf16 v[72:87], v[32:35], v[36:39], v[72:87]
    v_mfma_f32_32x32x16_bf16 v[88:103], v[32:35], v[40:43], v[88:103]
    ds_read_b64_tr_b16 v[32:33], v29 offset:4096
    ds_read_b64_tr_b16 v[34:35], v29 offset:5120
    ds_read_b128 v[36:39], v26 offset:0
    ds_read_b128 v[40:43], v26 offset:4096
    s_waitcnt lgkmcnt(8)
    v_mfma_f32_32x32x16_bf16 v[72:87], v[44:47], v[48:51], v[72:87]
    v_mfma_f32_32x32x16_bf16 v[88:103], v[44:47], v[52:55], v[88:103]
    s_waitcnt vmcnt(8)
    s_barrier
    ds_read_b64_tr_b16 v[44:45], v29 offset:8192
    ds_read_b64_tr_b16 v[46:47], v29 offset:9216
    ds_read_b128 v[48:51], v27 offset:0
    ds_read_b128 v[52:55], v27 offset:4096
    s_waitcnt lgkmcnt(8)
    v_mfma_f32_32x32x16_bf16 v[72:87], v[56:59], v[60:63], v[72:87]
    s_add_u32 s39, s38, 32768
    s_mov_b32 m0, s39
    s_mov_b32 s40, 768
    buffer_load_dwordx4 v16, s[8:11], s40 offen sc1 lds
    buffer_load_dwordx4 v17, s[8:11], s40 offen offset:1024 sc1 lds
    s_add_u32 s39, s38, 49152
    s_mov_b32 m0, s39
    s_mov_b32 s41, 393216
    buffer_load_dwordx4 v18, s[12:15], s41 offen lds
    buffer_load_dwordx4 v19, s[12:15], s41 offen offset:1024 lds
    v_mfma_f32_32x32x16_bf16 v[88:103], v[56:59], v[64:67], v[88:103]
    ds_read_b64_tr_b16 v[56:57], v29 offset:12288
    ds_read_b64_tr_b16 v[58:59], v29 offset:13312
    ds_read_b128 v[60:63], v28 offset:0
    ds_read_b128 v[64:67], v28 offset:4096
    s_waitcnt lgkmcnt(8)
    v_mfma_f32_32x32x16_bf16 v[72:87], v[32:35], v[36:39], v[72:87]
    v_mfma_f32_32x32x16_bf16 v[88:103], v[32:35], v[40:43], v[88:103]
    ds_read_b64_tr_b16 v[32:33], v29 offset:32768
    ds_read_b64_tr_b16 v[34:35], v29 offset:33792
    ds_read_b128 v[36:39], v25 offset:32768
    ds_read_b128 v[40:43], v25 offset:36864
    s_waitcnt lgkmcnt(8)
    v_mfma_f32_32x32x16_bf16 v[72:87], v[44:47], v[48:51], v[72:87]
    v_mfma_f32_32x32x16_bf16 v[88:103], v[44:47], v[52:55], v[88:103]
    ds_read_b64_tr_b16 v[44:45], v29 offset:36864
    ds_read_b64_tr_b16 v[46:47], v29 offset:37888
    ds_read_b128 v[48:51], v26 offset:32768
    ds_read_b128 v[52:55], v26 offset:36864
    s_waitcnt lgkmcnt(8)
    v_mfma_f32_32x32x16_bf16 v[72:87], v[56:59], v[60:63], v[72:87]
    v_mfma_f32_32x32x16_bf16 v[88:103], v[56:59], v[64:67], v[88:103]
    s_waitcnt vmcnt(8)
    s_barrier
    ds_read_b64_tr_b16 v[56:57], v29 offset:40960
    ds_read_b64_tr_b16 v[58:59], v29 offset:41984
    ds_read_b128 v[60:63], v27 offset:32768
    ds_read_b128 v[64:67], v27 offset:36864
    s_waitcnt lgkmcnt(8)
    v_mfma_f32_32x32x16_bf16 v[72:87], v[32:35], v[36:39], v[72:87]
    s_add_u32 s39, s38, 65536
    s_mov_b32 m0, s39
    s_mov_b32 s40, 896
    buffer_load_dwordx4 v16, s[8:11], s40 offen sc1 lds
    buffer_load_dwordx4 v17, s[8:11], s40 offen offset:1024 sc1 lds
    s_add_u32 s39, s38, 81920
    s_mov_b32 m0, s39
    s_mov_b32 s41, 458752
    buffer_load_dwordx4 v18, s[12:15], s41 offen lds
    buffer_load_dwordx4 v19, s[12:15], s41 offen offset:1024 lds
    v_mfma_f32_32x32x16_bf16 v[88:103], v[32:35], v[40:43], v[88:103]
    ds_read_b64_tr_b16 v[32:33], v29 offset:45056
    ds_read_b64_tr_b16 v[34:35], v29 offset:46080
    ds_read_b128 v[36:39], v28 offset:32768
    ds_read_b128 v[40:43], v28 offset:36864
    s_waitcnt lgkmcnt(8)
    v_mfma_f32_32x32x16_bf16 v[72:87], v[44:47], v[48:51], v[72:87]
    v_mfma_f32_32x32x16_bf16 v[88:103], v[44:47], v[52:55], v[88:103]
    ds_read_b64_tr_b16 v[44:45], v108 offset:0
    ds_read_b64_tr_b16 v[46:47], v108 offset:1024
    ds_read_b128 v[48:51], v104 offset:0
    ds_read_b128 v[52:55], v104 offset:4096
    s_waitcnt lgkmcnt(8)
    v_mfma_f32_32x32x16_bf16 v[72:87], v[56:59], v[60:63], v[72:87]
    v_mfma_f32_32x32x16_bf16 v[88:103], v[56:59], v[64:67], v[88:103]
    ds_read_b64_tr_b16 v[56:57], v108 offset:4096
    ds_read_b64_tr_b16 v[58:59], v108 offset:5120
    ds_read_b128 v[60:63], v105 offset:0
    ds_read_b128 v[64:67], v105 offset:4096
    s_waitcnt lgkmcnt(8)
    v_mfma_f32_32x32x16_bf16 v[72:87], v[32:35], v[36:39], v[72:87]
    v_mfma_f32_32x32x16_bf16 v[88:103], v[32:35], v[40:43], v[88:103]
    s_waitcnt vmcnt(8)
    s_barrier
    ds_read_b64_tr_b16 v[32:33], v108 offset:8192
    ds_read_b64_tr_b16 v[34:35], v108 offset:9216
    ds_read_b128 v[36:39], v106 offset:0
    ds_read_b128 v[40:43], v106 offset:4096
    s_waitcnt lgkmcnt(8)
    v_mfma_f32_32x32x16_bf16 v[72:87], v[44:47], v[48:51], v[72:87]
    s_add_u32 s39, s38, 98304
    s_mov_b32 m0, s39
    s_mov_b32 s40, 1024
    buffer_load_dwordx4 v16, s[8:11], s40 offen sc1 lds
    buffer_load_dwordx4 v17, s[8:11], s40 offen offset:1024 sc1 lds
    s_add_u32 s39, s38, 114688
    s_mov_b32 m0, s39
    s_mov_b32 s41, 524288
    buffer_load_dwordx4 v18, s[12:15], s41 offen lds
    buffer_load_dwordx4 v19, s[12:15], s41 offen offset:1024 lds
    v_mfma_f32_32x32x16_bf16 v[88:103], v[44:47], v[52:55], v[88:103]
    ds_read_b64_tr_b16 v[44:45], v108 offset:12288
    ds_read_b64_tr_b16 v[46:47], v108 offset:13312
    ds_read_b128 v[48:51], v107 offset:0
    ds_read_b128 v[52:55], v107 offset:4096
    s_waitcnt lgkmcnt(8)
    v_mfma_f32_32x32x16_bf16 v[72:87], v[56:59], v[60:63], v[72:87]
    v_mfma_f32_32x32x16_bf16 v[88:103], v[56:59], v[64:67], v[88:103]
    ds_read_b64_tr_b16 v[56:57], v24 offset:0
    ds_read_b64_tr_b16 v[58:59], v24 offset:1024
    ds_read_b128 v[60:63], v20 offset:0
    ds_read_b128 v[64:67], v20 offset:4096
    s_waitcnt lgkmcnt(8)
    v_mfma_f32_32x32x16_bf16 v[72:87], v[32:35], v[36:39], v[72:87]
    v_mfma_f32_32x32x16_bf16 v[88:103], v[32:35], v[40:43], v[88:103]
    ds_read_b64_tr_b16 v[32:33], v24 offset:4096
    ds_read_b64_tr_b16 v[34:35], v24 offset:5120
    ds_read_b128 v[36:39], v21 offset:0
    ds_read_b128 v[40:43], v21 offset:4096
    s_waitcnt lgkmcnt(8)
    v_mfma_f32_32x32x16_bf16 v[72:87], v[44:47], v[48:51], v[72:87]
    v_mfma_f32_32x32x16_bf16 v[88:103], v[44:47], v[52:55], v[88:103]
    s_waitcnt vmcnt(8)
    s_barrier
    ds_read_b64_tr_b16 v[44:45], v24 offset:8192
    ds_read_b64_tr_b16 v[46:47], v24 offset:9216
    ds_read_b128 v[48:51], v22 offset:0
    ds_read_b128 v[52:55], v22 offset:4096
    s_waitcnt lgkmcnt(8)
    v_mfma_f32_32x32x16_bf16 v[72:87], v[56:59], v[60:63], v[72:87]
    s_add_u32 s39, s38, 131072
    s_mov_b32 m0, s39
    s_mov_b32 s40, 1152
    buffer_load_dwordx4 v16, s[8:11], s40 offen sc1 lds
    buffer_load_dwordx4 v17, s[8:11], s40 offen offset:1024 sc1 lds
    s_add_u32 s39, s38, 147456
    s_mov_b32 m0, s39
    s_mov_b32 s41, 589824
    buffer_load_dwordx4 v18, s[12:15], s41 offen lds
    buffer_load_dwordx4 v19, s[12:15], s41 offen offset:1024 lds
    v_mfma_f32_32x32x16_bf16 v[88:103], v[56:59], v[64:67], v[88:103]
    ds_read_b64_tr_b16 v[56:57], v24 offset:12288
    ds_read_b64_tr_b16 v[58:59], v24 offset:13312
    ds_read_b128 v[60:63], v23 offset:0
    ds_read_b128 v[64:67], v23 offset:4096
    s_waitcnt lgkmcnt(8)
    v_mfma_f32_32x32x16_bf16 v[72:87], v[32:35], v[36:39], v[72:87]
    v_mfma_f32_32x32x16_bf16 v[88:103], v[32:35], v[40:43], v[88:103]
    ds_read_b64_tr_b16 v[32:33], v24 offset:32768
    ds_read_b64_tr_b16 v[34:35], v24 offset:33792
    ds_read_b128 v[36:39], v20 offset:32768
    ds_read_b128 v[40:43], v20 offset:36864
    s_waitcnt lgkmcnt(8)
    v_mfma_f32_32x32x16_bf16 v[72:87], v[44:47], v[48:51], v[72:87]
    v_mfma_f32_32x32x16_bf16 v[88:103], v[44:47], v[52:55], v[88:103]
    ds_read_b64_tr_b16 v[44:45], v24 offset:36864
    ds_read_b64_tr_b16 v[46:47], v24 offset:37888
    ds_read_b128 v[48:51], v21 offset:32768
    ds_read_b128 v[52:55], v21 offset:36864
    s_waitcnt lgkmcnt(8)
    v_mfma_f32_32x32x16_bf16 v[72:87], v[56:59], v[60:63], v[72:87]
    v_mfma_f32_32x32x16_bf16 v[88:103], v[56:59], v[64:67], v[88:103]
    s_waitcnt vmcnt(8)
    s_barrier
    ds_read_b64_tr_b16 v[56:57], v24 offset:40960
    ds_read_b64_tr_b16 v[58:59], v24 offset:41984
    ds_read_b128 v[60:63], v22 offset:32768
    ds_read_b128 v[64:67], v22 offset:36864
    s_waitcnt lgkmcnt(8)
    v_mfma_f32_32x32x16_bf16 v[72:87], v[32:35], v[36:39], v[72:87]
    s_add_u32 s39, s38, 0
    s_mov_b32 m0, s39
    s_mov_b32 s40, 1280
    buffer_load_dwordx4 v16, s[8:11], s40 offen sc1 lds
    buffer_load_dwordx4 v17, s[8:11], s40 offen offset:1024 sc1 lds
    s_add_u32 s39, s38, 16384
    s_mov_b32 m0, s39
    s_mov_b32 s41, 655360
    buffer_load_dwordx4 v18, s[12:15], s41 offen lds
    buffer_load_dwordx4 v19, s[12:15], s41 offen offset:1024 lds
    v_mfma_f32_32x32x16_bf16 v[88:103], v[32:35], v[40:43], v[88:103]
    ds_read_b64_tr_b16 v[32:33], v24 offset:45056
    ds_read_b64_tr_b16 v[34:35], v24 offset:46080
    ds_read_b128 v[36:39], v23 offset:32768
    ds_read_b128 v[40:43], v23 offset:36864
    s_waitcnt lgkmcnt(8)
    v_mfma_f32_32x32x16_bf16 v[72:87], v[44:47], v[48:51], v[72:87]
    v_mfma_f32_32x32x16_bf16 v[88:103], v[44:47], v[52:55], v[88:103]
    ds_read_b64_tr_b16 v[44:45], v29 offset:0
    ds_read_b64_tr_b16 v[46:47], v29 offset:1024
    ds_read_b128 v[48:51], v25 offset:0
    ds_read_b128 v[52:55], v25 offset:4096
    s_waitcnt lgkmcnt(8)
    v_mfma_f32_32x32x16_bf16 v[72:87], v[56:59], v[60:63], v[72:87]
    v_mfma_f32_32x32x16_bf16 v[88:103], v[56:59], v[64:67], v[88:103]
    ds_read_b64_tr_b16 v[56:57], v29 offset:4096
    ds_read_b64_tr_b16 v[58:59], v29 offset:5120
    ds_read_b128 v[60:63], v26 offset:0
    ds_read_b128 v[64:67], v26 offset:4096
    s_waitcnt lgkmcnt(8)
    v_mfma_f32_32x32x16_bf16 v[72:87], v[32:35], v[36:39], v[72:87]
    v_mfma_f32_32x32x16_bf16 v[88:103], v[32:35], v[40:43], v[88:103]
    s_waitcnt vmcnt(8)
    s_barrier
    ds_read_b64_tr_b16 v[32:33], v29 offset:8192
    ds_read_b64_tr_b16 v[34:35], v29 offset:9216
    ds_read_b128 v[36:39], v27 offset:0
    ds_read_b128 v[40:43], v27 offset:4096
    s_waitcnt lgkmcnt(8)
    v_mfma_f32_32x32x16_bf16 v[72:87], v[44:47], v[48:51], v[72:87]
    s_add_u32 s39, s38, 32768
    s_mov_b32 m0, s39
    s_mov_b32 s40, 1408
    buffer_load_dwordx4 v16, s[8:11], s40 offen sc1 lds
    buffer_load_dwordx4 v17, s[8:11], s40 offen offset:1024 sc1 lds
    s_add_u32 s39, s38, 49152
    s_mov_b32 m0, s39
    s_mov_b32 s41, 720896
    buffer_load_dwordx4 v18, s[12:15], s41 offen lds
    buffer_load_dwordx4 v19, s[12:15], s41 offen offset:1024 lds
    v_mfma_f32_32x32x16_bf16 v[88:103], v[44:47], v[52:55], v[88:103]
    ds_read_b64_tr_b16 v[44:45], v29 offset:12288
    ds_read_b64_tr_b16 v[46:47], v29 offset:13312
    ds_read_b128 v[48:51], v28 offset:0
    ds_read_b128 v[52:55], v28 offset:4096
    s_waitcnt lgkmcnt(8)
    v_mfma_f32_32x32x16_bf16 v[72:87], v[56:59], v[60:63], v[72:87]
    v_mfma_f32_32x32x16_bf16 v[88:103], v[56:59], v[64:67], v[88:103]
    ds_read_b64_tr_b16 v[56:57], v29 offset:32768
    ds_read_b64_tr_b16 v[58:59], v29 offset:33792
    ds_read_b128 v[60:63], v25 offset:32768
    ds_read_b128 v[64:67], v25 offset:36864
    s_waitcnt lgkmcnt(8)
    v_mfma_f32_32x32x16_bf16 v[72:87], v[32:35], v[36:39], v[72:87]
    v_mfma_f32_32x32x16_bf16 v[88:103], v[32:35], v[40:43], v[88:103]
    ds_read_b64_tr_b16 v[32:33], v29 offset:36864
    ds_read_b64_tr_b16 v[34:35], v29 offset:37888
    ds_read_b128 v[36:39], v26 offset:32768
    ds_read_b128 v[40:43], v26 offset:36864
    s_waitcnt lgkmcnt(8)
    v_mfma_f32_32x32x16_bf16 v[72:87], v[44:47], v[48:51], v[72:87]
    v_mfma_f32_32x32x16_bf16 v[88:103], v[44:47], v[52:55], v[88:103]
    s_waitcnt vmcnt(8)
    s_barrier
    ds_read_b64_tr_b16 v[44:45], v29 offset:40960
    ds_read_b64_tr_b16 v[46:47], v29 offset:41984
    ds_read_b128 v[48:51], v27 offset:32768
    ds_read_b128 v[52:55], v27 offset:36864
    s_waitcnt lgkmcnt(8)
    v_mfma_f32_32x32x16_bf16 v[72:87], v[56:59], v[60:63], v[72:87]
    s_add_u32 s39, s38, 65536
    s_mov_b32 m0, s39
    s_mov_b32 s40, 1536
    buffer_load_dwordx4 v16, s[8:11], s40 offen sc1 lds
    buffer_load_dwordx4 v17, s[8:11], s40 offen offset:1024 sc1 lds
    s_add_u32 s39, s38, 81920
    s_mov_b32 m0, s39
    s_mov_b32 s41, 786432
    buffer_load_dwordx4 v18, s[12:15], s41 offen lds
    buffer_load_dwordx4 v19, s[12:15], s41 offen offset:1024 lds
    v_mfma_f32_32x32x16_bf16 v[88:103], v[56:59], v[64:67], v[88:103]
    ds_read_b64_tr_b16 v[56:57], v29 offset:45056
    ds_read_b64_tr_b16 v[58:59], v29 offset:46080
    ds_read_b128 v[60:63], v28 offset:32768
    ds_read_b128 v[64:67], v28 offset:36864
    s_waitcnt lgkmcnt(8)
    v_mfma_f32_32x32x16_bf16 v[72:87], v[32:35], v[36:39], v[72:87]
    v_mfma_f32_32x32x16_bf16 v[88:103], v[32:35], v[40:43], v[88:103]
    ds_read_b64_tr_b16 v[32:33], v108 offset:0
    ds_read_b64_tr_b16 v[34:35], v108 offset:1024
    ds_read_b128 v[36:39], v104 offset:0
    ds_read_b128 v[40:43], v104 offset:4096
    s_waitcnt lgkmcnt(8)
    v_mfma_f32_32x32x16_bf16 v[72:87], v[44:47], v[48:51], v[72:87]
    v_mfma_f32_32x32x16_bf16 v[88:103], v[44:47], v[52:55], v[88:103]
    ds_read_b64_tr_b16 v[44:45], v108 offset:4096
    ds_read_b64_tr_b16 v[46:47], v108 offset:5120
    ds_read_b128 v[48:51], v105 offset:0
    ds_read_b128 v[52:55], v105 offset:4096
    s_waitcnt lgkmcnt(8)
    v_mfma_f32_32x32x16_bf16 v[72:87], v[56:59], v[60:63], v[72:87]
    v_mfma_f32_32x32x16_bf16 v[88:103], v[56:59], v[64:67], v[88:103]
    s_waitcnt vmcnt(8)
    s_barrier
    ds_read_b64_tr_b16 v[56:57], v108 offset:8192
    ds_read_b64_tr_b16 v[58:59], v108 offset:9216
    ds_read_b128 v[60:63], v106 offset:0
    ds_read_b128 v[64:67], v106 offset:4096
    s_waitcnt lgkmcnt(8)
    v_mfma_f32_32x32x16_bf16 v[72:87], v[32:35], v[36:39], v[72:87]
    s_add_u32 s39, s38, 98304
    s_mov_b32 m0, s39
    s_mov_b32 s40, 1664
    buffer_load_dwordx4 v16, s[8:11], s40 offen sc1 lds
    buffer_load_dwordx4 v17, s[8:11], s40 offen offset:1024 sc1 lds
    s_add_u32 s39, s38, 114688
    s_mov_b32 m0, s39
    s_mov_b32 s41, 851968
    buffer_load_dwordx4 v18, s[12:15], s41 offen lds
    buffer_load_dwordx4 v19, s[12:15], s41 offen offset:1024 lds
    v_mfma_f32_32x32x16_bf16 v[88:103], v[32:35], v[40:43], v[88:103]
    ds_read_b64_tr_b16 v[32:33], v108 offset:12288
    ds_read_b64_tr_b16 v[34:35], v108 offset:13312
    ds_read_b128 v[36:39], v107 offset:0
    ds_read_b128 v[40:43], v107 offset:4096
    s_waitcnt lgkmcnt(8)
    v_mfma_f32_32x32x16_bf16 v[72:87], v[44:47], v[48:51], v[72:87]
    v_mfma_f32_32x32x16_bf16 v[88:103], v[44:47], v[52:55], v[88:103]
    ds_read_b64_tr_b16 v[44:45], v24 offset:0
    ds_read_b64_tr_b16 v[46:47], v24 offset:1024
    ds_read_b128 v[48:51], v20 offset:0
    ds_read_b128 v[52:55], v20 offset:4096
    s_waitcnt lgkmcnt(8)
    v_mfma_f32_32x32x16_bf16 v[72:87], v[56:59], v[60:63], v[72:87]
    v_mfma_f32_32x32x16_bf16 v[88:103], v[56:59], v[64:67], v[88:103]
    ds_read_b64_tr_b16 v[56:57], v24 offset:4096
    ds_read_b64_tr_b16 v[58:59], v24 offset:5120
    ds_read_b128 v[60:63], v21 offset:0
    ds_read_b128 v[64:67], v21 offset:4096
    s_waitcnt lgkmcnt(8)
    v_mfma_f32_32x32x16_bf16 v[72:87], v[32:35], v[36:39], v[72:87]
    v_mfma_f32_32x32x16_bf16 v[88:103], v[32:35], v[40:43], v[88:103]
    s_waitcnt vmcnt(8)
    s_barrier
    ds_read_b64_tr_b16 v[32:33], v24 offset:8192
    ds_read_b64_tr_b16 v[34:35], v24 offset:9216
    ds_read_b128 v[36:39], v22 offset:0
    ds_read_b128 v[40:43], v22 offset:4096
    s_waitcnt lgkmcnt(8)
    v_mfma_f32_32x32x16_bf16 v[72:87], v[44:47], v[48:51], v[72:87]
    s_add_u32 s39, s38, 131072
    s_mov_b32 m0, s39
    s_mov_b32 s40, 1792
    buffer_load_dwordx4 v16, s[8:11], s40 offen sc1 lds
    buffer_load_dwordx4 v17, s[8:11], s40 offen offset:1024 sc1 lds
    s_add_u32 s39, s38, 147456
    s_mov_b32 m0, s39
    s_mov_b32 s41, 917504
    buffer_load_dwordx4 v18, s[12:15], s41 offen lds
    buffer_load_dwordx4 v19, s[12:15], s41 offen offset:1024 lds
    v_mfma_f32_32x32x16_bf16 v[88:103], v[44:47], v[52:55], v[88:103]
    ds_read_b64_tr_b16 v[44:45], v24 offset:12288
    ds_read_b64_tr_b16 v[46:47], v24 offset:13312
    ds_read_b128 v[48:51], v23 offset:0
    ds_read_b128 v[52:55], v23 offset:4096
    s_waitcnt lgkmcnt(8)
    v_mfma_f32_32x32x16_bf16 v[72:87], v[56:59], v[60:63], v[72:87]
    v_mfma_f32_32x32x16_bf16 v[88:103], v[56:59], v[64:67], v[88:103]
    ds_read_b64_tr_b16 v[56:57], v24 offset:32768
    ds_read_b64_tr_b16 v[58:59], v24 offset:33792
    ds_read_b128 v[60:63], v20 offset:32768
    ds_read_b128 v[64:67], v20 offset:36864
    s_waitcnt lgkmcnt(8)
    v_mfma_f32_32x32x16_bf16 v[72:87], v[32:35], v[36:39], v[72:87]
    v_mfma_f32_32x32x16_bf16 v[88:103], v[32:35], v[40:43], v[88:103]
    ds_read_b64_tr_b16 v[32:33], v24 offset:36864
    ds_read_b64_tr_b16 v[34:35], v24 offset:37888
    ds_read_b128 v[36:39], v21 offset:32768
    ds_read_b128 v[40:43], v21 offset:36864
    s_waitcnt lgkmcnt(8)
    v_mfma_f32_32x32x16_bf16 v[72:87], v[44:47], v[48:51], v[72:87]
    v_mfma_f32_32x32x16_bf16 v[88:103], v[44:47], v[52:55], v[88:103]
    s_waitcnt vmcnt(8)
    s_barrier
    ds_read_b64_tr_b16 v[44:45], v24 offset:40960
    ds_read_b64_tr_b16 v[46:47], v24 offset:41984
    ds_read_b128 v[48:51], v22 offset:32768
    ds_read_b128 v[52:55], v22 offset:36864
    s_waitcnt lgkmcnt(8)
    v_mfma_f32_32x32x16_bf16 v[72:87], v[56:59], v[60:63], v[72:87]
    s_add_u32 s39, s38, 0
    s_mov_b32 m0, s39
    s_mov_b32 s40, 1920
    buffer_load_dwordx4 v16, s[8:11], s40 offen sc1 lds
    buffer_load_dwordx4 v17, s[8:11], s40 offen offset:1024 sc1 lds
    s_add_u32 s39, s38, 16384
    s_mov_b32 m0, s39
    s_mov_b32 s41, 983040
    buffer_load_dwordx4 v18, s[12:15], s41 offen lds
    buffer_load_dwordx4 v19, s[12:15], s41 offen offset:1024 lds
    v_mfma_f32_32x32x16_bf16 v[88:103], v[56:59], v[64:67], v[88:103]
    ds_read_b64_tr_b16 v[56:57], v24 offset:45056
    ds_read_b64_tr_b16 v[58:59], v24 offset:46080
    ds_read_b128 v[60:63], v23 offset:32768
    ds_read_b128 v[64:67], v23 offset:36864
    s_waitcnt lgkmcnt(8)
    v_mfma_f32_32x32x16_bf16 v[72:87], v[32:35], v[36:39], v[72:87]
    v_mfma_f32_32x32x16_bf16 v[88:103], v[32:35], v[40:43], v[88:103]
    ds_read_b64_tr_b16 v[32:33], v29 offset:0
    ds_read_b64_tr_b16 v[34:35], v29 offset:1024
    ds_read_b128 v[36:39], v25 offset:0
    ds_read_b128 v[40:43], v25 offset:4096
    s_waitcnt lgkmcnt(8)
    v_mfma_f32_32x32x16_bf16 v[72:87], v[44:47], v[48:51], v[72:87]
    v_mfma_f32_32x32x16_bf16 v[88:103], v[44:47], v[52:55], v[88:103]
    ds_read_b64_tr_b16 v[44:45], v29 offset:4096
    ds_read_b64_tr_b16 v[46:47], v29 offset:5120
    ds_read_b128 v[48:51], v26 offset:0
    ds_read_b128 v[52:55], v26 offset:4096
    s_waitcnt lgkmcnt(8)
    v_mfma_f32_32x32x16_bf16 v[72:87], v[56:59], v[60:63], v[72:87]
    v_mfma_f32_32x32x16_bf16 v[88:103], v[56:59], v[64:67], v[88:103]
    s_waitcnt vmcnt(8)
    s_barrier
    ds_read_b64_tr_b16 v[56:57], v29 offset:8192
    ds_read_b64_tr_b16 v[58:59], v29 offset:9216
    ds_read_b128 v[60:63], v27 offset:0
    ds_read_b128 v[64:67], v27 offset:4096
    s_waitcnt lgkmcnt(8)
    v_mfma_f32_32x32x16_bf16 v[72:87], v[32:35], v[36:39], v[72:87]
    v_mfma_f32_32x32x16_bf16 v[88:103], v[32:35], v[40:43], v[88:103]
    ds_read_b64_tr_b16 v[32:33], v29 offset:12288
    ds_read_b64_tr_b16 v[34:35], v29 offset:13312
    ds_read_b128 v[36:39], v28 offset:0
    ds_read_b128 v[40:43], v28 offset:4096
    s_waitcnt lgkmcnt(8)
    v_mfma_f32_32x32x16_bf16 v[72:87], v[44:47], v[48:51], v[72:87]
    v_mfma_f32_32x32x16_bf16 v[88:103], v[44:47], v[52:55], v[88:103]
    ds_read_b64_tr_b16 v[44:45], v29 offset:32768
    ds_read_b64_tr_b16 v[46:47], v29 offset:33792
    ds_read_b128 v[48:51], v25 offset:32768
    ds_read_b128 v[52:55], v25 offset:36864
    s_waitcnt lgkmcnt(8)
    v_mfma_f32_32x32x16_bf16 v[72:87], v[56:59], v[60:63], v[72:87]
    v_mfma_f32_32x32x16_bf16 v[88:103], v[56:59], v[64:67], v[88:103]
    ds_read_b64_tr_b16 v[56:57], v29 offset:36864
    ds_read_b64_tr_b16 v[58:59], v29 offset:37888
    ds_read_b128 v[60:63], v26 offset:32768
    ds_read_b128 v[64:67], v26 offset:36864
    s_waitcnt lgkmcnt(8)
    v_mfma_f32_32x32x16_bf16 v[72:87], v[32:35], v[36:39], v[72:87]
    v_mfma_f32_32x32x16_bf16 v[88:103], v[32:35], v[40:43], v[88:103]
    s_waitcnt vmcnt(4)
    s_barrier
    ds_read_b64_tr_b16 v[32:33], v29 offset:40960
    ds_read_b64_tr_b16 v[34:35], v29 offset:41984
    ds_read_b128 v[36:39], v27 offset:32768
    ds_read_b128 v[40:43], v27 offset:36864
    s_waitcnt lgkmcnt(8)
    v_mfma_f32_32x32x16_bf16 v[72:87], v[44:47], v[48:51], v[72:87]
    v_mfma_f32_32x32x16_bf16 v[88:103], v[44:47], v[52:55], v[88:103]
    ds_read_b64_tr_b16 v[44:45], v29 offset:45056
    ds_read_b64_tr_b16 v[46:47], v29 offset:46080
    ds_read_b128 v[48:51], v28 offset:32768
    ds_read_b128 v[52:55], v28 offset:36864
    s_waitcnt lgkmcnt(8)
    v_mfma_f32_32x32x16_bf16 v[72:87], v[56:59], v[60:63], v[72:87]
    v_mfma_f32_32x32x16_bf16 v[88:103], v[56:59], v[64:67], v[88:103]
    ds_read_b64_tr_b16 v[56:57], v108 offset:0
    ds_read_b64_tr_b16 v[58:59], v108 offset:1024
    ds_read_b128 v[60:63], v104 offset:0
    ds_read_b128 v[64:67], v104 offset:4096
    s_waitcnt lgkmcnt(8)
    v_mfma_f32_32x32x16_bf16 v[72:87], v[32:35], v[36:39], v[72:87]
    v_mfma_f32_32x32x16_bf16 v[88:103], v[32:35], v[40:43], v[88:103]
    ds_read_b64_tr_b16 v[32:33], v108 offset:4096
    ds_read_b64_tr_b16 v[34:35], v108 offset:5120
    ds_read_b128 v[36:39], v105 offset:0
    ds_read_b128 v[40:43], v105 offset:4096
    s_waitcnt lgkmcnt(8)
    v_mfma_f32_32x32x16_bf16 v[72:87], v[44:47], v[48:51], v[72:87]
    v_mfma_f32_32x32x16_bf16 v[88:103], v[44:47], v[52:55], v[88:103]
    s_waitcnt vmcnt(0)
    s_barrier
    ds_read_b64_tr_b16 v[44:45], v108 offset:8192
    ds_read_b64_tr_b16 v[46:47], v108 offset:9216
    ds_read_b128 v[48:51], v106 offset:0
    ds_read_b128 v[52:55], v106 offset:4096
    s_waitcnt lgkmcnt(8)
    v_mfma_f32_32x32x16_bf16 v[72:87], v[56:59], v[60:63], v[72:87]
    v_mfma_f32_32x32x16_bf16 v[88:103], v[56:59], v[64:67], v[88:103]
    ds_read_b64_tr_b16 v[56:57], v108 offset:12288
    ds_read_b64_tr_b16 v[58:59], v108 offset:13312
    ds_read_b128 v[60:63], v107 offset:0
    ds_read_b128 v[64:67], v107 offset:4096
    s_waitcnt lgkmcnt(8)
    v_mfma_f32_32x32x16_bf16 v[72:87], v[32:35], v[36:39], v[72:87]
    v_mfma_f32_32x32x16_bf16 v[88:103], v[32:35], v[40:43], v[88:103]
    ds_read_b64_tr_b16 v[32:33], v24 offset:0
    ds_read_b64_tr_b16 v[34:35], v24 offset:1024
    ds_read_b128 v[36:39], v20 offset:0
    ds_read_b128 v[40:43], v20 offset:4096
    s_waitcnt lgkmcnt(8)
    v_mfma_f32_32x32x16_bf16 v[72:87], v[44:47], v[48:51], v[72:87]
    v_mfma_f32_32x32x16_bf16 v[88:103], v[44:47], v[52:55], v[88:103]
    ds_read_b64_tr_b16 v[44:45], v24 offset:4096
    ds_read_b64_tr_b16 v[46:47], v24 offset:5120
    ds_read_b128 v[48:51], v21 offset:0
    ds_read_b128 v[52:55], v21 offset:4096
    s_waitcnt lgkmcnt(8)
    v_mfma_f32_32x32x16_bf16 v[72:87], v[56:59], v[60:63], v[72:87]
    v_mfma_f32_32x32x16_bf16 v[88:103], v[56:59], v[64:67], v[88:103]
    s_waitcnt vmcnt(0)
    s_barrier
    ds_read_b64_tr_b16 v[56:57], v24 offset:8192
    ds_read_b64_tr_b16 v[58:59], v24 offset:9216
    ds_read_b128 v[60:63], v22 offset:0
    ds_read_b128 v[64:67], v22 offset:4096
    s_waitcnt lgkmcnt(8)
    v_mfma_f32_32x32x16_bf16 v[72:87], v[32:35], v[36:39], v[72:87]
    v_mfma_f32_32x32x16_bf16 v[88:103], v[32:35], v[40:43], v[88:103]
    ds_read_b64_tr_b16 v[32:33], v24 offset:12288
    ds_read_b64_tr_b16 v[34:35], v24 offset:13312
    ds_read_b128 v[36:39], v23 offset:0
    ds_read_b128 v[40:43], v23 offset:4096
    s_waitcnt lgkmcnt(8)
    v_mfma_f32_32x32x16_bf16 v[72:87], v[44:47], v[48:51], v[72:87]
    v_mfma_f32_32x32x16_bf16 v[88:103], v[44:47], v[52:55], v[88:103]
    s_waitcnt lgkmcnt(4)
    v_mfma_f32_32x32x16_bf16 v[72:87], v[56:59], v[60:63], v[72:87]
    v_mfma_f32_32x32x16_bf16 v[88:103], v[56:59], v[64:67], v[88:103]
    s_waitcnt lgkmcnt(0)
    v_mfma_f32_32x32x16_bf16 v[72:87], v[32:35], v[36:39], v[72:87]
    v_mfma_f32_32x32x16_bf16 v[88:103], v[32:35], v[40:43], v[88:103]
    s_nop 15
    s_nop 7
    buffer_store_dwordx4 v[72:75], v30, s[16:19], 0 offen offset:0
    buffer_store_dwordx4 v[76:79], v30, s[16:19], 0 offen offset:32
    buffer_store_dwordx4 v[80:83], v30, s[16:19], 0 offen offset:64
    buffer_store_dwordx4 v[84:87], v30, s[16:19], 0 offen offset:96
    buffer_store_dwordx4 v[88:91], v31, s[16:19], 0 offen offset:0
    buffer_store_dwordx4 v[92:95], v31, s[16:19], 0 offen offset:32
    buffer_store_dwordx4 v[96:99], v31, s[16:19], 0 offen offset:64
    buffer_store_dwordx4 v[100:103], v31, s[16:19], 0 offen offset:96
L_k3_done:
    s_endpgm
.globl k5_tail_kernel
.p2align 8
.type k5_tail_kernel,@function
k5_tail_kernel:
    s_cmp_ge_u32 s2, 256
    s_cbranch_scc1 L_k5_done
    s_load_dwordx2 s[4:5], s[0:1], 0
    s_load_dwordx4 s[60:63], s[0:1], 48
    s_load_dwordx4 s[64:67], s[0:1], 64
    s_load_dwordx2 s[68:69], s[0:1], 96
    s_load_dwordx4 s[20:23], s[0:1], 104
    v_and_b32 v1, 63, v0
    v_lshrrev_b32 v2, 6, v0
    s_nop 0
    v_readfirstlane_b32 s52, v2
    s_waitcnt lgkmcnt(0)
    s_mov_b32 s8, s4
    s_mov_b32 s9, s5
    s_mov_b32 s10, 0x200000
    s_mov_b32 s11, 0x00020000
    s_mov_b32 s12, s22
    s_mov_b32 s13, s23
    s_mov_b32 s14, 0x3000
    s_mov_b32 s15, 0x00020000
    s_add_u32 s16, s22, 0x1800000
    s_addc_u32 s17, s23, 0
    s_mov_b32 s18, 0x1000000
    s_mov_b32 s19, 0x00020000
    s_mov_b32 s24, s60
    s_mov_b32 s25, s61
    s_mov_b32 s26, 0x400
    s_mov_b32 s27, 0x00020000
    s_mov_b32 s28, s68
    s_mov_b32 s29, s69
    s_mov_b32 s30, 0x200000
    s_mov_b32 s31, 0x00020000
    s_add_u32 s32, s22, 0x300000
    s_addc_u32 s33, s23, 0
    s_mov_b32 s34, 0x200000
    s_mov_b32 s35, 0x00020000
    s_add_u32 s36, s22, 0x500000
    s_addc_u32 s37, s23, 0
    s_mov_b32 s38, 0x200000
    s_mov_b32 s39, 0x00020000
    s_add_u32 s72, s22, 0x10000
    s_addc_u32 s73, s23, 0
    s_mov_b32 s74, 0x2000
    s_mov_b32 s75, 0x00020000
    s_add_u32 s76, s22, 0x40000
    s_addc_u32 s77, s23, 0
    s_mov_b32 s78, 0x9000
    s_mov_b32 s79, 0x00020000
    s_add_u32 s80, s22, 0x2a00000
    s_addc_u32 s81, s23, 0
    s_mov_b32 s82, 0x1c0000
    s_mov_b32 s83, 0x00020000
    s_add_u32 s84, s22, 0x2c00000
    s_addc_u32 s85, s23, 0
    s_mov_b32 s86, 0x1c0000
    s_mov_b32 s87, 0x00020000
    s_mov_b32 s88, s66
    s_mov_b32 s89, s67
    s_mov_b32 s90, 0x1c0000
    s_mov_b32 s91, 0x00020000
    s_add_u32 s92, s22, 0x2900000
    s_addc_u32 s93, s23, 0
    s_mov_b32 s94, 0xe0000
    s_mov_b32 s95, 0x00020000
    s_cmp_lt_u32 s52, 8
    s_cbranch_scc1 L_k5_rows
    s_cmp_ge_u32 s2, 56
    s_cbranch_scc1 L_k5_done
    s_sub_u32 s59, s52, 8
    v_lshlrev_b32 v112, 4, v1
    s_lshl_b32 s56, s59, 14
    s_lshl_b32 s53, s2, 15
    s_add_u32 s53, s53, s56
    s_add_u32 s54, s56, 8192
    s_mov_b32 m0, s54
    s_add_u32 s55, s53, 0
    buffer_load_dwordx4 v112, s[80:83], s55 offen lds
    s_add_u32 s54, s56, 9216
    s_mov_b32 m0, s54
    s_add_u32 s55, s53, 1024
    buffer_load_dwordx4 v112, s[80:83], s55 offen lds
    s_add_u32 s54, s56, 10240
    s_mov_b32 m0, s54
    s_add_u32 s55, s53, 2048
    buffer_load_dwordx4 v112, s[80:83], s55 offen lds
    s_add_u32 s54, s56, 11264
    s_mov_b32 m0, s54
    s_add_u32 s55, s53, 3072
    buffer_load_dwordx4 v112, s[80:83], s55 offen lds
    s_add_u32 s54, s56, 12288
    s_mov_b32 m0, s54
    s_add_u32 s55, s53, 4096
    buffer_load_dwordx4 v112, s[80:83], s55 offen lds
    s_add_u32 s54, s56, 13312
    s_mov_b32 m0, s54
    s_add_u32 s55, s53, 5120
    buffer_load_dwordx4 v112, s[80:83], s55 offen lds
    s_add_u32 s54, s56, 14336
    s_mov_b32 m0, s54
    s_add_u32 s55, s53, 6144
    buffer_load_dwordx4 v112, s[80:83], s55 offen lds
    s_add_u32 s54, s56, 15360
    s_mov_b32 m0, s54
    s_add_u32 s55, s53, 7168
    buffer_load_dwordx4 v112, s[80:83], s55 offen lds
    s_add_u32 s54, s56, 16384
    s_mov_b32 m0, s54
    s_add_u32 s55, s53, 8192
    buffer_load_dwordx4 v112, s[80:83], s55 offen lds
    s_add_u32 s54, s56, 17408
    s_mov_b32 m0, s54
    s_add_u32 s55, s53, 9216
    buffer_load_dwordx4 v112, s[80:83], s55 offen lds
    s_add_u32 s54, s56, 18432
    s_mov_b32 m0, s54
    s_add_u32 s55, s53, 10240
    buffer_load_dwordx4 v112, s[80:83], s55 offen lds
    s_add_u32 s54, s56, 19456
    s_mov_b32 m0, s54
    s_add_u32 s55, s53, 11264
    buffer_load_dwordx4 v112, s[80:83], s55 offen lds
    s_add_u32 s54, s56, 20480
    s_mov_b32 m0, s54
    s_add_u32 s55, s53, 12288
    buffer_load_dwordx4 v112, s[80:83], s55 offen lds
    s_add_u32 s54, s56, 21504
    s_mov_b32 m0, s54
    s_add_u32 s55, s53, 13312
    buffer_load_dwordx4 v112, s[80:83], s55 offen lds
    s_add_u32 s54, s56, 22528
    s_mov_b32 m0, s54
    s_add_u32 s55, s53, 14336
    buffer_load_dwordx4 v112, s[80:83], s55 offen lds
    s_add_u32 s54, s56, 23552
    s_mov_b32 m0, s54
    s_add_u32 s55, s53, 15360
    buffer_load_dwordx4 v112, s[80:83], s55 offen lds
    s_add_u32 s54, s56, 40960
    s_mov_b32 m0, s54
    s_add_u32 s55, s53, 0
    buffer_load_dwordx4 v112, s[84:87], s55 offen lds
    s_add_u32 s54, s56, 41984
    s_mov_b32 m0, s54
    s_add_u32 s55, s53, 1024
    buffer_load_dwordx4 v112, s[84:87], s55 offen lds
    s_add_u32 s54, s56, 43008
    s_mov_b32 m0, s54
    s_add_u32 s55, s53, 2048
    buffer_load_dwordx4 v112, s[84:87], s55 offen lds
    s_add_u32 s54, s56, 44032
    s_mov_b32 m0, s54
    s_add_u32 s55, s53, 3072
    buffer_load_dwordx4 v112, s[84:87], s55 offen lds
    s_add_u32 s54, s56, 45056
    s_mov_b32 m0, s54
    s_add_u32 s55, s53, 4096
    buffer_load_dwordx4 v112, s[84:87], s55 offen lds
    s_add_u32 s54, s56, 46080
    s_mov_b32 m0, s54
    s_add_u32 s55, s53, 5120
    buffer_load_dwordx4 v112, s[84:87], s55 offen lds
    s_add_u32 s54, s56, 47104
    s_mov_b32 m0, s54
    s_add_u32 s55, s53, 6144
    buffer_load_dwordx4 v112, s[84:87], s55 offen lds
    s_add_u32 s54, s56, 48128
    s_mov_b32 m0, s54
    s_add_u32 s55, s53, 7168
    buffer_load_dwordx4 v112, s[84:87], s55 offen lds
    s_add_u32 s54, s56, 49152
    s_mov_b32 m0, s54
    s_add_u32 s55, s53, 8192
    buffer_load_dwordx4 v112, s[84:87], s55 offen lds
    s_add_u32 s54, s56, 50176
    s_mov_b32 m0, s54
    s_add_u32 s55, s53, 9216
    buffer_load_dwordx4 v112, s[84:87], s55 offen lds
    s_add_u32 s54, s56, 51200
    s_mov_b32 m0, s54
    s_add_u32 s55, s53, 10240
    buffer_load_dwordx4 v112, s[84:87], s55 offen lds
    s_add_u32 s54, s56, 52224
    s_mov_b32 m0, s54
    s_add_u32 s55, s53, 11264
    buffer_load_dwordx4 v112, s[84:87], s55 offen lds
    s_add_u32 s54, s56, 53248
    s_mov_b32 m0, s54
    s_add_u32 s55, s53, 12288
    buffer_load_dwordx4 v112, s[84:87], s55 offen lds
    s_add_u32 s54, s56, 54272
    s_mov_b32 m0, s54
    s_add_u32 s55, s53, 13312
    buffer_load_dwordx4 v112, s[84:87], s55 offen lds
    s_add_u32 s54, s56, 55296
    s_mov_b32 m0, s54
    s_add_u32 s55, s53, 14336
    buffer_load_dwordx4 v112, s[84:87], s55 offen lds
    s_add_u32 s54, s56, 56320
    s_mov_b32 m0, s54
    s_add_u32 s55, s53, 15360
    buffer_load_dwordx4 v112, s[84:87], s55 offen lds
    s_mul_i32 s57, s59, 16896
    s_add_u32 s54, s57, 73728
    s_mov_b32 m0, s54
    s_add_u32 s55, s53, 0
    buffer_load_dwordx4 v112, s[88:91], s55 offen lds
    s_add_u32 s54, s57, 74784
    s_mov_b32 m0, s54
    s_add_u32 s55, s53, 1024
    buffer_load_dwordx4 v112, s[88:91], s55 offen lds
    s_add_u32 s54, s57, 75840
    s_mov_b32 m0, s54
    s_add_u32 s55, s53, 2048
    buffer_load_dwordx4 v112, s[88:91], s55 offen lds
    s_add_u32 s54, s57, 76896
    s_mov_b32 m0, s54
    s_add_u32 s55, s53, 3072
    buffer_load_dwordx4 v112, s[88:91], s55 offen lds
    s_add_u32 s54, s57, 77952
    s_mov_b32 m0, s54
    s_add_u32 s55, s53, 4096
    buffer_load_dwordx4 v112, s[88:91], s55 offen lds
    s_add_u32 s54, s57, 79008
    s_mov_b32 m0, s54
    s_add_u32 s55, s53, 5120
    buffer_load_dwordx4 v112, s[88:91], s55 offen lds
    s_add_u32 s54, s57, 80064
    s_mov_b32 m0, s54
    s_add_u32 s55, s53, 6144
    buffer_load_dwordx4 v112, s[88:91], s55 offen lds
    s_add_u32 s54, s57, 81120
    s_mov_b32 m0, s54
    s_add_u32 s55, s53, 7168
    buffer_load_dwordx4 v112, s[88:91], s55 offen lds
    s_add_u32 s54, s57, 82176
    s_mov_b32 m0, s54
    s_add_u32 s55, s53, 8192
    buffer_load_dwordx4 v112, s[88:91], s55 offen lds
    s_add_u32 s54, s57, 83232
    s_mov_b32 m0, s54
    s_add_u32 s55, s53, 9216
    buffer_load_dwordx4 v112, s[88:91], s55 offen lds
    s_add_u32 s54, s57, 84288
    s_mov_b32 m0, s54
    s_add_u32 s55, s53, 10240
    buffer_load_dwordx4 v112, s[88:91], s55 offen lds
    s_add_u32 s54, s57, 85344
    s_mov_b32 m0, s54
    s_add_u32 s55, s53, 11264
    buffer_load_dwordx4 v112, s[88:91], s55 offen lds
    s_add_u32 s54, s57, 86400
    s_mov_b32 m0, s54
    s_add_u32 s55, s53, 12288
    buffer_load_dwordx4 v112, s[88:91], s55 offen lds
    s_add_u32 s54, s57, 87456
    s_mov_b32 m0, s54
    s_add_u32 s55, s53, 13312
    buffer_load_dwordx4 v112, s[88:91], s55 offen lds
    s_add_u32 s54, s57, 88512
    s_mov_b32 m0, s54
    s_add_u32 s55, s53, 14336
    buffer_load_dwordx4 v112, s[88:91], s55 offen lds
    s_add_u32 s54, s57, 89568
    s_mov_b32 m0, s54
    s_add_u32 s55, s53, 15360
    buffer_load_dwordx4 v112, s[88:91], s55 offen lds
    s_barrier
    s_waitcnt vmcnt(0)
    s_barrier
    s_branch L_k5_done
L_k5_rows:
    s_lshl_b32 s53, s2, 13
    v_lshlrev_b32 v3, 10, v2
    v_lshlrev_b32 v4, 3, v1
    v_add3_u32 v3, v3, v4, s53
    v_lshlrev_b32 v6, 1, v3
    buffer_load_dwordx2 v[8:9], v3, s[8:11], 0 offen
    buffer_load_dwordx2 v[10:11], v3, s[8:11], 0 offen offset:512
    s_mov_b32 s53, 0x0
    buffer_load_dwordx4 v[64:67], v6, s[16:19], s53 offen
    buffer_load_dwordx4 v[68:71], v6, s[16:19], s53 offen offset:1024
    s_mov_b32 s53, 0x400000
    buffer_load_dwordx4 v[72:75], v6, s[16:19], s53 offen
    buffer_load_dwordx4 v[76:79], v6, s[16:19], s53 offen offset:1024
    s_mov_b32 s53, 0x800000
    buffer_load_dwordx4 v[80:83], v6, s[16:19], s53 offen
    buffer_load_dwordx4 v[84:87], v6, s[16:19], s53 offen offset:1024
    s_mov_b32 s53, 0xc00000
    buffer_load_dwordx4 v[88:91], v6, s[16:19], s53 offen
    buffer_load_dwordx4 v[92:95], v6, s[16:19], s53 offen offset:1024
    v_lshlrev_b32 v5, 4, v1
    s_mov_b32 s53, 4096
    buffer_load_dwordx4 v[24:27], v5, s[12:15], s53 offen
    buffer_load_dwordx4 v[28:31], v5, s[12:15], s53 offen offset:1024
    s_mov_b32 s53, 6144
    buffer_load_dwordx4 v[32:35], v5, s[12:15], s53 offen
    buffer_load_dwordx4 v[36:39], v5, s[12:15], s53 offen offset:1024
    s_mov_b32 s53, 8192
    buffer_load_dwordx4 v[40:43], v5, s[12:15], s53 offen
    buffer_load_dwordx4 v[44:47], v5, s[12:15], s53 offen offset:1024
    s_mov_b32 s53, 10240
    buffer_load_dwordx4 v[48:51], v5, s[12:15], s53 offen
    buffer_load_dwordx4 v[52:55], v5, s[12:15], s53 offen offset:1024
    buffer_load_dwordx2 v[12:13], v4, s[24:27], 0 offen
    buffer_load_dwordx2 v[14:15], v4, s[24:27], 0 offen offset:512
    s_waitcnt vmcnt(0)
L_k5_p1:
    v_lshlrev_b32 v16, 16, v8
    v_and_b32 v17, 0xffff0000, v8
    v_lshlrev_b32 v18, 16, v9
    v_and_b32 v19, 0xffff0000, v9
    v_lshlrev_b32 v20, 16, v10
    v_and_b32 v21, 0xffff0000, v10
    v_lshlrev_b32 v22, 16, v11
    v_and_b32 v23, 0xffff0000, v11
    v_add_f32 v64, v64, v72
    v_add_f32 v65, v65, v73
    v_add_f32 v66, v66, v74
    v_add_f32 v67, v67, v75
    v_add_f32 v68, v68, v76
    v_add_f32 v69, v69, v77
    v_add_f32 v70, v70, v78
    v_add_f32 v71, v71, v79
    v_add_f32 v64, v64, v80
    v_add_f32 v65, v65, v81
    v_add_f32 v66, v66, v82
    v_add_f32 v67, v67, v83
    v_add_f32 v68, v68, v84
    v_add_f32 v69, v69, v85
    v_add_f32 v70, v70, v86
    v_add_f32 v71, v71, v87
    v_add_f32 v64, v64, v88
    v_add_f32 v65, v65, v89
    v_add_f32 v66, v66, v90
    v_add_f32 v67, v67, v91
    v_add_f32 v68, v68, v92
    v_add_f32 v69, v69, v93
    v_add_f32 v70, v70, v94
    v_add_f32 v71, v71, v95
    v_cvt_pk_bf16_f32 v100, v64, v65
    v_lshlrev_b32 v64, 16, v100
    v_and_b32 v65, 0xffff0000, v100
    v_mul_f32 v64, v64, v24
    v_mul_f32 v65, v65, v25
    v_cvt_pk_bf16_f32 v100, v64, v65
    v_lshlrev_b32 v64, 16, v100
    v_and_b32 v65, 0xffff0000, v100
    v_add_f32 v16, v16, v64
    v_add_f32 v17, v17, v65
    v_cvt_pk_bf16_f32 v100, v16, v17
    v_lshlrev_b32 v16, 16, v100
    v_and_b32 v17, 0xffff0000, v100
    v_cvt_pk_bf16_f32 v100, v66, v67
    v_lshlrev_b32 v66, 16, v100
    v_and_b32 v67, 0xffff0000, v100
    v_mul_f32 v66, v66, v26
    v_mul_f32 v67, v67, v27
    v_cvt_pk_bf16_f32 v100, v66, v67
    v_lshlrev_b32 v66, 16, v100
    v_and_b32 v67, 0xffff0000, v100
    v_add_f32 v18, v18, v66
    v_add_f32 v19, v19, v67
    v_cvt_pk_bf16_f32 v100, v18, v19
    v_lshlrev_b32 v18, 16, v100
    v_and_b32 v19, 0xffff0000, v100
    v_cvt_pk_bf16_f32 v100, v68, v69
    v_lshlrev_b32 v68, 16, v100
    v_and_b32 v69, 0xffff0000, v100
    v_mul_f32 v68, v68, v28
    v_mul_f32 v69, v69, v29
    v_cvt_pk_bf16_f32 v100, v68, v69
    v_lshlrev_b32 v68, 16, v100
    v_and_b32 v69, 0xffff0000, v100
    v_add_f32 v20, v20, v68
    v_add_f32 v21, v21, v69
    v_cvt_pk_bf16_f32 v100, v20, v21
    v_lshlrev_b32 v20, 16, v100
    v_and_b32 v21, 0xffff0000, v100
    v_cvt_pk_bf16_f32 v100, v70, v71
    v_lshlrev_b32 v70, 16, v100
    v_and_b32 v71, 0xffff0000, v100
    v_mul_f32 v70, v70, v30
    v_mul_f32 v71, v71, v31
    v_cvt_pk_bf16_f32 v100, v70, v71
    v_lshlrev_b32 v70, 16, v100
    v_and_b32 v71, 0xffff0000, v100
    v_add_f32 v22, v22, v70
    v_add_f32 v23, v23, v71
    v_cvt_pk_bf16_f32 v100, v22, v23
    v_lshlrev_b32 v22, 16, v100
    v_and_b32 v23, 0xffff0000, v100
    v_mov_b32 v72, v16
    v_mov_b32 v73, v17
    v_mov_b32 v74, v18
    v_mov_b32 v75, v19
    v_mov_b32 v76, v20
    v_mov_b32 v77, v21
    v_mov_b32 v78, v22
    v_mov_b32 v79, v23
    v_cvt_pk_bf16_f32 v8, v16, v17
    v_cvt_pk_bf16_f32 v9, v18, v19
    v_cvt_pk_bf16_f32 v10, v20, v21
    v_cvt_pk_bf16_f32 v11, v22, v23
    buffer_store_dwordx2 v[8:9], v3, s[32:35], 0 offen sc1
    buffer_store_dwordx2 v[10:11], v3, s[32:35], 0 offen offset:512 sc1
    v_add_f32 v100, v16, v17
    v_add_f32 v100, v100, v18
    v_add_f32 v100, v100, v19
    v_add_f32 v100, v100, v20
    v_add_f32 v100, v100, v21
    v_add_f32 v100, v100, v22
    v_add_f32 v100, v100, v23
    s_nop 1
    v_add_f32_dpp v101, v100, v100 quad_perm:[1,0,3,2] row_mask:0xf bank_mask:0xf
    v_mov_b32 v100, v101
    s_nop 1
    v_add_f32_dpp v101, v100, v100 quad_perm:[2,3,0,1] row_mask:0xf bank_mask:0xf
    v_mov_b32 v100, v101
    s_nop 1
    v_add_f32_dpp v101, v100, v100 row_half_mirror row_mask:0xf bank_mask:0xf
    v_mov_b32 v100, v101
    s_nop 1
    v_add_f32_dpp v101, v100, v100 row_mirror row_mask:0xf bank_mask:0xf
    v_mov_b32 v100, v101
    ds_swizzle_b32 v101, v100 offset:0x401F
    s_waitcnt lgkmcnt(0)
    v_add_f32 v100, v100, v101
    v_mov_b32 v101, v100
    s_nop 1
    v_permlane32_swap_b32 v100, v101
    s_nop 1
    v_add_f32 v100, v100, v101
    v_mul_f32 v102, 0x3b000000, v100
    v_mov_b32 v103, v102
    v_cvt_pk_bf16_f32 v103, v103, v103
    v_lshlrev_b32 v103, 16, v103
    v_mov_b32 v100, 0
    v_sub_f32 v106, v16, v102
    v_fmac_f32 v100, v106, v106
    v_sub_f32 v106, v17, v102
    v_fmac_f32 v100, v106, v106
    v_sub_f32 v106, v18, v102
    v_fmac_f32 v100, v106, v106
    v_sub_f32 v106, v19, v102
    v_fmac_f32 v100, v106, v106
    v_sub_f32 v106, v20, v102
    v_fmac_f32 v100, v106, v106
    v_sub_f32 v106, v21, v102
    v_fmac_f32 v100, v106, v106
    v_sub_f32 v106, v22, v102
    v_fmac_f32 v100, v106, v106
    v_sub_f32 v106, v23, v102
    v_fmac_f32 v100, v106, v106
    s_nop 1
    v_add_f32_dpp v101, v100, v100 quad_perm:[1,0,3,2] row_mask:0xf bank_mask:0xf
    v_mov_b32 v100, v101
    s_nop 1
    v_add_f32_dpp v101, v100, v100 quad_perm:[2,3,0,1] row_mask:0xf bank_mask:0xf
    v_mov_b32 v100, v101
    s_nop 1
    v_add_f32_dpp v101, v100, v100 row_half_mirror row_mask:0xf bank_mask:0xf
    v_mov_b32 v100, v101
    s_nop 1
    v_add_f32_dpp v101, v100, v100 row_mirror row_mask:0xf bank_mask:0xf
    v_mov_b32 v100, v101
    ds_swizzle_b32 v101, v100 offset:0x401F
    s_waitcnt lgkmcnt(0)
    v_add_f32 v100, v100, v101
    v_mov_b32 v101, v100
    s_nop 1
    v_permlane32_swap_b32 v100, v101
    s_nop 1
    v_add_f32 v100, v100, v101
    v_mul_f32 v104, 0x3b000000, v100
    v_cvt_pk_bf16_f32 v104, v104, v104
    v_lshlrev_b32 v104, 16, v104
    v_add_f32 v104, 0x3727c5ac, v104
    v_cvt_pk_bf16_f32 v104, v104, v104
    v_lshlrev_b32 v104, 16, v104
    v_sqrt_f32 v104, v104
    s_nop 0
    v_cvt_pk_bf16_f32 v104, v104, v104
    v_lshlrev_b32 v104, 16, v104
    v_rcp_f32 v105, v104
    s_nop 0
    v_sub_f32 v16, v16, v103
    v_sub_f32 v17, v17, v103
    v_cvt_pk_bf16_f32 v101, v16, v17
    v_lshlrev_b32 v16, 16, v101
    v_and_b32 v17, 0xffff0000, v101
    v_mul_f32 v106, v16, v105
    v_fma_f32 v107, -v106, v104, v16
    v_fma_f32 v16, v107, v105, v106
    v_mul_f32 v106, v17, v105
    v_fma_f32 v107, -v106, v104, v17
    v_fma_f32 v17, v107, v105, v106
    v_cvt_pk_bf16_f32 v101, v16, v17
    v_lshlrev_b32 v16, 16, v101
    v_and_b32 v17, 0xffff0000, v101
    v_sub_f32 v18, v18, v103
    v_sub_f32 v19, v19, v103
    v_cvt_pk_bf16_f32 v101, v18, v19
    v_lshlrev_b32 v18, 16, v101
    v_and_b32 v19, 0xffff0000, v101
    v_mul_f32 v106, v18, v105
    v_fma_f32 v107, -v106, v104, v18
    v_fma_f32 v18, v107, v105, v106
    v_mul_f32 v106, v19, v105
    v_fma_f32 v107, -v106, v104, v19
    v_fma_f32 v19, v107, v105, v106
    v_cvt_pk_bf16_f32 v101, v18, v19
    v_lshlrev_b32 v18, 16, v101
    v_and_b32 v19, 0xffff0000, v101
    v_sub_f32 v20, v20, v103
    v_sub_f32 v21, v21, v103
    v_cvt_pk_bf16_f32 v101, v20, v21
    v_lshlrev_b32 v20, 16, v101
    v_and_b32 v21, 0xffff0000, v101
    v_mul_f32 v106, v20, v105
    v_fma_f32 v107, -v106, v104, v20
    v_fma_f32 v20, v107, v105, v106
    v_mul_f32 v106, v21, v105
    v_fma_f32 v107, -v106, v104, v21
    v_fma_f32 v21, v107, v105, v106
    v_cvt_pk_bf16_f32 v101, v20, v21
    v_lshlrev_b32 v20, 16, v101
    v_and_b32 v21, 0xffff0000, v101
    v_sub_f32 v22, v22, v103
    v_sub_f32 v23, v23, v103
    v_cvt_pk_bf16_f32 v101, v22, v23
    v_lshlrev_b32 v22, 16, v101
    v_and_b32 v23, 0xffff0000, v101
    v_mul_f32 v106, v22, v105
    v_fma_f32 v107, -v106, v104, v22
    v_fma_f32 v22, v107, v105, v106
    v_mul_f32 v106, v23, v105
    v_fma_f32 v107, -v106, v104, v23
    v_fma_f32 v23, v107, v105, v106
    v_cvt_pk_bf16_f32 v101, v22, v23
    v_lshlrev_b32 v22, 16, v101
    v_and_b32 v23, 0xffff0000, v101
    v_add_f32 v40, 1.0, v40
    v_add_f32 v41, 1.0, v41
    v_cvt_pk_bf16_f32 v100, v40, v41
    v_lshlrev_b32 v40, 16, v100
    v_and_b32 v41, 0xffff0000, v100
    v_mul_f32 v16, v16, v40
    v_mul_f32 v17, v17, v41
    v_cvt_pk_bf16_f32 v100, v16, v17
    v_lshlrev_b32 v16, 16, v100
    v_and_b32 v17, 0xffff0000, v100
    v_add_f32 v16, v16, v32
    v_add_f32 v17, v17, v33
    v_cvt_pk_bf16_f32 v100, v16, v17
    v_lshlrev_b32 v16, 16, v100
    v_and_b32 v17, 0xffff0000, v100
    v_add_f32 v42, 1.0, v42
    v_add_f32 v43, 1.0, v43
    v_cvt_pk_bf16_f32 v100, v42, v43
    v_lshlrev_b32 v42, 16, v100
    v_and_b32 v43, 0xffff0000, v100
    v_mul_f32 v18, v18, v42
    v_mul_f32 v19, v19, v43
    v_cvt_pk_bf16_f32 v100, v18, v19
    v_lshlrev_b32 v18, 16, v100
    v_and_b32 v19, 0xffff0000, v100
    v_add_f32 v18, v18, v34
    v_add_f32 v19, v19, v35
    v_cvt_pk_bf16_f32 v100, v18, v19
    v_lshlrev_b32 v18, 16, v100
    v_and_b32 v19, 0xffff0000, v100
    v_add_f32 v44, 1.0, v44
    v_add_f32 v45, 1.0, v45
    v_cvt_pk_bf16_f32 v100, v44, v45
    v_lshlrev_b32 v44, 16, v100
    v_and_b32 v45, 0xffff0000, v100
    v_mul_f32 v20, v20, v44
    v_mul_f32 v21, v21, v45
    v_cvt_pk_bf16_f32 v100, v20, v21
    v_lshlrev_b32 v20, 16, v100
    v_and_b32 v21, 0xffff0000, v100
    v_add_f32 v20, v20, v36
    v_add_f32 v21, v21, v37
    v_cvt_pk_bf16_f32 v100, v20, v21
    v_lshlrev_b32 v20, 16, v100
    v_and_b32 v21, 0xffff0000, v100
    v_add_f32 v46, 1.0, v46
    v_add_f32 v47, 1.0, v47
    v_cvt_pk_bf16_f32 v100, v46, v47
    v_lshlrev_b32 v46, 16, v100
    v_and_b32 v47, 0xffff0000, v100
    v_mul_f32 v22, v22, v46
    v_mul_f32 v23, v23, v47
    v_cvt_pk_bf16_f32 v100, v22, v23
    v_lshlrev_b32 v22, 16, v100
    v_and_b32 v23, 0xffff0000, v100
    v_add_f32 v22, v22, v38
    v_add_f32 v23, v23, v39
    v_cvt_pk_bf16_f32 v100, v22, v23
    v_lshlrev_b32 v22, 16, v100
    v_and_b32 v23, 0xffff0000, v100
    v_cvt_pk_bf16_f32 v84, v16, v17
    v_cvt_pk_bf16_f32 v85, v18, v19
    v_cvt_pk_bf16_f32 v86, v20, v21
    v_cvt_pk_bf16_f32 v87, v22, v23
    buffer_store_dwordx2 v[84:85], v3, s[36:39], 0 offen sc1
    buffer_store_dwordx2 v[86:87], v3, s[36:39], 0 offen offset:512 sc1
    v_lshlrev_b32 v88, 16, v12
    v_and_b32 v89, 0xffff0000, v12
    v_lshlrev_b32 v90, 16, v13
    v_and_b32 v91, 0xffff0000, v13
    v_lshlrev_b32 v92, 16, v14
    v_and_b32 v93, 0xffff0000, v14
    v_lshlrev_b32 v94, 16, v15
    v_and_b32 v95, 0xffff0000, v15
    v_mul_f32 v100, v16, v88
    v_fmac_f32 v100, v17, v89
    v_fmac_f32 v100, v18, v90
    v_fmac_f32 v100, v19, v91
    v_fmac_f32 v100, v20, v92
    v_fmac_f32 v100, v21, v93
    v_fmac_f32 v100, v22, v94
    v_fmac_f32 v100, v23, v95
    s_nop 1
    v_add_f32_dpp v101, v100, v100 quad_perm:[1,0,3,2] row_mask:0xf bank_mask:0xf
    v_mov_b32 v100, v101
    s_nop 1
    v_add_f32_dpp v101, v100, v100 quad_perm:[2,3,0,1] row_mask:0xf bank_mask:0xf
    v_mov_b32 v100, v101
    s_nop 1
    v_add_f32_dpp v101, v100, v100 row_half_mirror row_mask:0xf bank_mask:0xf
    v_mov_b32 v100, v101
    s_nop 1
    v_add_f32_dpp v101, v100, v100 row_mirror row_mask:0xf bank_mask:0xf
    v_mov_b32 v100, v101
    ds_swizzle_b32 v101, v100 offset:0x401F
    s_waitcnt lgkmcnt(0)
    v_add_f32 v100, v100, v101
    v_mov_b32 v101, v100
    s_nop 1
    v_permlane32_swap_b32 v100, v101
    s_nop 1
    v_add_f32 v100, v100, v101
    v_cvt_pk_bf16_f32 v100, v100, v100
    v_lshlrev_b32 v100, 16, v100
    v_lshrrev_b32 v7, 8, v3
    v_cmp_eq_u32 vcc, 0, v1
    s_and_saveexec_b64 s[48:49], vcc
    buffer_store_dword v100, v7, s[72:75], 0 offen sc1
    s_mov_b64 exec, s[48:49]
    v_mul_f32 v16, v16, v48
    v_mul_f32 v17, v17, v49
    v_cvt_pk_bf16_f32 v100, v16, v17
    v_lshlrev_b32 v16, 16, v100
    v_and_b32 v17, 0xffff0000, v100
    v_add_f32 v16, v16, v72
    v_add_f32 v17, v17, v73
    v_mul_f32 v18, v18, v50
    v_mul_f32 v19, v19, v51
    v_cvt_pk_bf16_f32 v100, v18, v19
    v_lshlrev_b32 v18, 16, v100
    v_and_b32 v19, 0xffff0000, v100
    v_add_f32 v18, v18, v74
    v_add_f32 v19, v19, v75
    v_mul_f32 v20, v20, v52
    v_mul_f32 v21, v21, v53
    v_cvt_pk_bf16_f32 v100, v20, v21
    v_lshlrev_b32 v20, 16, v100
    v_and_b32 v21, 0xffff0000, v100
    v_add_f32 v20, v20, v76
    v_add_f32 v21, v21, v77
    v_mul_f32 v22, v22, v54
    v_mul_f32 v23, v23, v55
    v_cvt_pk_bf16_f32 v100, v22, v23
    v_lshlrev_b32 v22, 16, v100
    v_and_b32 v23, 0xffff0000, v100
    v_add_f32 v22, v22, v78
    v_add_f32 v23, v23, v79
    v_cvt_pk_bf16_f32 v92, v16, v17
    v_cvt_pk_bf16_f32 v93, v18, v19
    v_cvt_pk_bf16_f32 v94, v20, v21
    v_cvt_pk_bf16_f32 v95, v22, v23
    buffer_store_dwordx2 v[92:93], v3, s[28:31], 0 offen sc1
    buffer_store_dwordx2 v[94:95], v3, s[28:31], 0 offen offset:512 sc1
    s_waitcnt vmcnt(0) lgkmcnt(0)
    s_barrier
    v_mov_b32 v5, 1
    s_lshl_b32 s58, s2, 6
    s_add_u32 s58, s58, 0
    v_mov_b32 v6, s58
    v_cmp_eq_u32 vcc, 0, v0
    s_and_saveexec_b64 s[48:49], vcc
    buffer_store_dword v5, v6, s[76:79], 0 offen sc1
    s_mov_b64 exec, s[48:49]
    s_cmp_ge_u32 s2, 56
    s_cbranch_scc1 L_k5_done
    s_cmp_ge_u32 s52, 4
    s_cbranch_scc1 L_k5_done
L_k5_p2:
    v_mov_b32 v5, v1
    v_and_b32 v6, 15, v5
    v_lshrrev_b32 v7, 4, v5
    s_cmp_lg_u32 s52, 0
    s_cbranch_scc1 L_polldone1
    v_lshlrev_b32 v32, 6, v0
    v_add_u32 v32, 0, v32
L_poll1:
    s_mov_b32 s58, 0
    buffer_load_dword v28, v32, s[76:79], s58 offen sc1
    s_mov_b32 s58, 4096
    buffer_load_dword v29, v32, s[76:79], s58 offen sc1
    s_mov_b32 s58, 8192
    buffer_load_dword v30, v32, s[76:79], s58 offen sc1
    s_mov_b32 s58, 12288
    buffer_load_dword v31, v32, s[76:79], s58 offen sc1
    s_waitcnt vmcnt(0)
    v_and_b32 v28, v28, v29
    v_and_b32 v30, v30, v31
    v_and_b32 v28, v28, v30
    v_cmp_ne_u32 vcc, 1, v28
    s_nop 1
    s_cbranch_vccz L_polldone1
    s_sleep 1
    s_branch L_poll1
L_polldone1:
    s_barrier
    v_lshlrev_b32 v16, 5, v0
    buffer_load_dwordx4 v[8:11], v16, s[72:75], 0 offen sc1
    buffer_load_dwordx4 v[12:15], v16, s[72:75], 0 offen offset:16 sc1
    v_lshlrev_b32 v17, 3, v0
    v_sub_u32 v17, 2047, v17
    v_lshrrev_b32 v20, 6, v0
    v_lshlrev_b32 v20, 2, v20
    s_waitcnt vmcnt(0)
    v_ashrrev_i32 v18, 31, v8
    v_or_b32 v18, 0x80000000, v18
    v_xor_b32 v8, v8, v18
    v_and_b32 v8, 0xffff0000, v8
    v_subrev_u32 v18, 0, v17
    v_or_b32 v8, v8, v18
    v_ashrrev_i32 v18, 31, v9
    v_or_b32 v18, 0x80000000, v18
    v_xor_b32 v9, v9, v18
    v_and_b32 v9, 0xffff0000, v9
    v_subrev_u32 v18, 1, v17
    v_or_b32 v9, v9, v18
    v_ashrrev_i32 v18, 31, v10
    v_or_b32 v18, 0x80000000, v18
    v_xor_b32 v10, v10, v18
    v_and_b32 v10, 0xffff0000, v10
    v_subrev_u32 v18, 2, v17
    v_or_b32 v10, v10, v18
    v_ashrrev_i32 v18, 31, v11
    v_or_b32 v18, 0x80000000, v18
    v_xor_b32 v11, v11, v18
    v_and_b32 v11, 0xffff0000, v11
    v_subrev_u32 v18, 3, v17
    v_or_b32 v11, v11, v18
    v_ashrrev_i32 v18, 31, v12
    v_or_b32 v18, 0x80000000, v18
    v_xor_b32 v12, v12, v18
    v_and_b32 v12, 0xffff0000, v12
    v_subrev_u32 v18, 4, v17
    v_or_b32 v12, v12, v18
    v_ashrrev_i32 v18, 31, v13
    v_or_b32 v18, 0x80000000, v18
    v_xor_b32 v13, v13, v18
    v_and_b32 v13, 0xffff0000, v13
    v_subrev_u32 v18, 5, v17
    v_or_b32 v13, v13, v18
    v_ashrrev_i32 v18, 31, v14
    v_or_b32 v18, 0x80000000, v18
    v_xor_b32 v14, v14, v18
    v_and_b32 v14, 0xffff0000, v14
    v_subrev_u32 v18, 6, v17
    v_or_b32 v14, v14, v18
    v_ashrrev_i32 v18, 31, v15
    v_or_b32 v18, 0x80000000, v18
    v_xor_b32 v15, v15, v18
    v_and_b32 v15, 0xffff0000, v15
    v_subrev_u32 v18, 7, v17
    v_or_b32 v15, v15, v18
    v_max_u32 v57, v8, v9
    v_min_u32 v9, v8, v9
    v_max_u32 v8, v10, v11
    v_min_u32 v11, v10, v11
    v_max_u32 v10, v12, v13
    v_min_u32 v13, v12, v13
    v_max_u32 v12, v14, v15
    v_min_u32 v15, v14, v15
    v_max_u32 v14, v57, v8
    v_min_u32 v8, v57, v8
    v_max_u32 v57, v9, v11
    v_min_u32 v11, v9, v11
    v_max_u32 v9, v10, v12
    v_min_u32 v12, v10, v12
    v_max_u32 v10, v13, v15
    v_min_u32 v15, v13, v15
    v_max_u32 v13, v57, v8
    v_min_u32 v8, v57, v8
    v_max_u32 v57, v10, v12
    v_min_u32 v12, v10, v12
    v_max_u32 v10, v14, v9
    v_min_u32 v9, v14, v9
    v_max_u32 v14, v11, v15
    v_min_u32 v15, v11, v15
    v_max_u32 v11, v13, v57
    v_min_u32 v57, v13, v57
    v_max_u32 v13, v8, v12
    v_min_u32 v12, v8, v12
    v_max_u32 v8, v11, v9
    v_min_u32 v9, v11, v9
    v_max_u32 v11, v14, v12
    v_min_u32 v12, v14, v12
    v_max_u32 v14, v13, v9
    v_min_u32 v9, v13, v9
    v_max_u32 v13, v11, v57
    v_min_u32 v57, v11, v57
    v_max_u32 v11, v13, v9
    v_min_u32 v9, v13, v9
    s_nop 1
    v_mov_b32_dpp v32, v10 quad_perm:[1,0,3,2] row_mask:0xf bank_mask:0xf
    v_mov_b32_dpp v33, v8 quad_perm:[1,0,3,2] row_mask:0xf bank_mask:0xf
    v_mov_b32_dpp v34, v14 quad_perm:[1,0,3,2] row_mask:0xf bank_mask:0xf
    v_mov_b32_dpp v35, v11 quad_perm:[1,0,3,2] row_mask:0xf bank_mask:0xf
    v_mov_b32_dpp v36, v9 quad_perm:[1,0,3,2] row_mask:0xf bank_mask:0xf
    v_mov_b32_dpp v37, v57 quad_perm:[1,0,3,2] row_mask:0xf bank_mask:0xf
    v_mov_b32_dpp v38, v12 quad_perm:[1,0,3,2] row_mask:0xf bank_mask:0xf
    v_mov_b32_dpp v39, v15 quad_perm:[1,0,3,2] row_mask:0xf bank_mask:0xf
    v_max_u32 v10, v10, v39
    v_max_u32 v8, v8, v38
    v_max_u32 v14, v14, v37
    v_max_u32 v11, v11, v36
    v_max_u32 v9, v9, v35
    v_max_u32 v57, v57, v34
    v_max_u32 v12, v12, v33
    v_max_u32 v15, v15, v32
    v_max_u32 v13, v10, v9
    v_min_u32 v9, v10, v9
    v_max_u32 v10, v8, v57
    v_min_u32 v57, v8, v57
    v_max_u32 v8, v14, v12
    v_min_u32 v12, v14, v12
    v_max_u32 v14, v11, v15
    v_min_u32 v15, v11, v15
    v_max_u32 v11, v13, v8
    v_min_u32 v8, v13, v8
    v_max_u32 v13, v10, v14
    v_min_u32 v14, v10, v14
    v_max_u32 v10, v9, v12
    v_min_u32 v12, v9, v12
    v_max_u32 v9, v57, v15
    v_min_u32 v15, v57, v15
    v_max_u32 v57, v11, v13
    v_min_u32 v13, v11, v13
    v_max_u32 v11, v8, v14
    v_min_u32 v14, v8, v14
    v_max_u32 v8, v10, v9
    v_min_u32 v9, v10, v9
    v_max_u32 v10, v12, v15
    v_min_u32 v15, v12, v15
    s_nop 1
    v_mov_b32_dpp v32, v57 quad_perm:[2,3,0,1] row_mask:0xf bank_mask:0xf
    v_mov_b32_dpp v33, v13 quad_perm:[2,3,0,1] row_mask:0xf bank_mask:0xf
    v_mov_b32_dpp v34, v11 quad_perm:[2,3,0,1] row_mask:0xf bank_mask:0xf
    v_mov_b32_dpp v35, v14 quad_perm:[2,3,0,1] row_mask:0xf bank_mask:0xf
    v_mov_b32_dpp v36, v8 quad_perm:[2,3,0,1] row_mask:0xf bank_mask:0xf
    v_mov_b32_dpp v37, v9 quad_perm:[2,3,0,1] row_mask:0xf bank_mask:0xf
    v_mov_b32_dpp v38, v10 quad_perm:[2,3,0,1] row_mask:0xf bank_mask:0xf
    v_mov_b32_dpp v39, v15 quad_perm:[2,3,0,1] row_mask:0xf bank_mask:0xf
    v_max_u32 v57, v57, v39
    v_max_u32 v13, v13, v38
    v_max_u32 v11, v11, v37
    v_max_u32 v14, v14, v36
    v_max_u32 v8, v8, v35
    v_max_u32 v9, v9, v34
    v_max_u32 v10, v10, v33
    v_max_u32 v15, v15, v32
    v_max_u32 v12, v57, v8
    v_min_u32 v8, v57, v8
    v_max_u32 v57, v13, v9
    v_min_u32 v9, v13, v9
    v_max_u32 v13, v11, v10
    v_min_u32 v10, v11, v10
    v_max_u32 v11, v14, v15
    v_min_u32 v15, v14, v15
    v_max_u32 v14, v12, v13
    v_min_u32 v13, v12, v13
    v_max_u32 v12, v57, v11
    v_min_u32 v11, v57, v11
    v_max_u32 v57, v8, v10
    v_min_u32 v10, v8, v10
    v_max_u32 v8, v9, v15
    v_min_u32 v15, v9, v15
    v_max_u32 v9, v14, v12
    v_min_u32 v12, v14, v12
    v_max_u32 v14, v13, v11
    v_min_u32 v11, v13, v11
    v_max_u32 v13, v57, v8
    v_min_u32 v8, v57, v8
    v_max_u32 v57, v10, v15
    v_min_u32 v15, v10, v15
    s_nop 1
    v_mov_b32_dpp v32, v9 row_half_mirror row_mask:0xf bank_mask:0xf
    v_mov_b32_dpp v33, v12 row_half_mirror row_mask:0xf bank_mask:0xf
    v_mov_b32_dpp v34, v14 row_half_mirror row_mask:0xf bank_mask:0xf
    v_mov_b32_dpp v35, v11 row_half_mirror row_mask:0xf bank_mask:0xf
    v_mov_b32_dpp v36, v13 row_half_mirror row_mask:0xf bank_mask:0xf
    v_mov_b32_dpp v37, v8 row_half_mirror row_mask:0xf bank_mask:0xf
    v_mov_b32_dpp v38, v57 row_half_mirror row_mask:0xf bank_mask:0xf
    v_mov_b32_dpp v39, v15 row_half_mirror row_mask:0xf bank_mask:0xf
    v_max_u32 v9, v9, v39
    v_max_u32 v12, v12, v38
    v_max_u32 v14, v14, v37
    v_max_u32 v11, v11, v36
    v_max_u32 v13, v13, v35
    v_max_u32 v8, v8, v34
    v_max_u32 v57, v57, v33
    v_max_u32 v15, v15, v32
    v_max_u32 v10, v9, v13
    v_min_u32 v13, v9, v13
    v_max_u32 v9, v12, v8
    v_min_u32 v8, v12, v8
    v_max_u32 v12, v14, v57
    v_min_u32 v57, v14, v57
    v_max_u32 v14, v11, v15
    v_min_u32 v15, v11, v15
    v_max_u32 v11, v10, v12
    v_min_u32 v12, v10, v12
    v_max_u32 v10, v9, v14
    v_min_u32 v14, v9, v14
    v_max_u32 v9, v13, v57
    v_min_u32 v57, v13, v57
    v_max_u32 v13, v8, v15
    v_min_u32 v15, v8, v15
    v_max_u32 v8, v11, v10
    v_min_u32 v10, v11, v10
    v_max_u32 v11, v12, v14
    v_min_u32 v14, v12, v14
    v_max_u32 v12, v9, v13
    v_min_u32 v13, v9, v13
    v_max_u32 v9, v57, v15
    v_min_u32 v15, v57, v15
    s_nop 1
    v_mov_b32_dpp v32, v8 row_mirror row_mask:0xf bank_mask:0xf
    v_mov_b32_dpp v33, v10 row_mirror row_mask:0xf bank_mask:0xf
    v_mov_b32_dpp v34, v11 row_mirror row_mask:0xf bank_mask:0xf
    v_mov_b32_dpp v35, v14 row_mirror row_mask:0xf bank_mask:0xf
    v_mov_b32_dpp v36, v12 row_mirror row_mask:0xf bank_mask:0xf
    v_mov_b32_dpp v37, v13 row_mirror row_mask:0xf bank_mask:0xf
    v_mov_b32_dpp v38, v9 row_mirror row_mask:0xf bank_mask:0xf
    v_mov_b32_dpp v39, v15 row_mirror row_mask:0xf bank_mask:0xf
    v_max_u32 v8, v8, v39
    v_max_u32 v10, v10, v38
    v_max_u32 v11, v11, v37
    v_max_u32 v14, v14, v36
    v_max_u32 v12, v12, v35
    v_max_u32 v13, v13, v34
    v_max_u32 v9, v9, v33
    v_max_u32 v15, v15, v32
    v_max_u32 v57, v8, v12
    v_min_u32 v12, v8, v12
    v_max_u32 v8, v10, v13
    v_min_u32 v13, v10, v13
    v_max_u32 v10, v11, v9
    v_min_u32 v9, v11, v9
    v_max_u32 v11, v14, v15
    v_min_u32 v15, v14, v15
    v_max_u32 v14, v57, v10
    v_min_u32 v10, v57, v10
    v_max_u32 v57, v8, v11
    v_min_u32 v11, v8, v11
    v_max_u32 v8, v12, v9
    v_min_u32 v9, v12, v9
    v_max_u32 v12, v13, v15
    v_min_u32 v15, v13, v15
    v_max_u32 v13, v14, v57
    v_min_u32 v57, v14, v57
    v_max_u32 v14, v10, v11
    v_min_u32 v11, v10, v11
    v_max_u32 v10, v8, v12
    v_min_u32 v12, v8, v12
    v_max_u32 v8, v9, v15
    v_min_u32 v15, v9, v15
    v_mov_b32 v32, v13
    v_mov_b32 v33, v57
    v_mov_b32 v34, v14
    v_mov_b32 v35, v11
    v_mov_b32 v36, v10
    v_mov_b32 v37, v12
    v_mov_b32 v38, v8
    v_mov_b32 v39, v15
    s_nop 1
    v_permlane16_swap_b32 v13, v32
    v_permlane16_swap_b32 v57, v33
    v_permlane16_swap_b32 v14, v34
    v_permlane16_swap_b32 v11, v35
    v_permlane16_swap_b32 v10, v36
    v_permlane16_swap_b32 v12, v37
    v_permlane16_swap_b32 v8, v38
    v_permlane16_swap_b32 v15, v39
    v_max_u32 v13, v13, v39
    v_max_u32 v57, v57, v38
    v_max_u32 v14, v14, v37
    v_max_u32 v11, v11, v36
    v_max_u32 v10, v10, v35
    v_max_u32 v12, v12, v34
    v_max_u32 v8, v8, v33
    v_max_u32 v15, v15, v32
    v_max_u32 v9, v13, v10
    v_min_u32 v10, v13, v10
    v_max_u32 v13, v57, v12
    v_min_u32 v12, v57, v12
    v_max_u32 v57, v14, v8
    v_min_u32 v8, v14, v8
    v_max_u32 v14, v11, v15
    v_min_u32 v15, v11, v15
    v_max_u32 v11, v9, v57
    v_min_u32 v57, v9, v57
    v_max_u32 v9, v13, v14
    v_min_u32 v14, v13, v14
    v_max_u32 v13, v10, v8
    v_min_u32 v8, v10, v8
    v_max_u32 v10, v12, v15
    v_min_u32 v15, v12, v15
    v_max_u32 v12, v11, v9
    v_min_u32 v9, v11, v9
    v_max_u32 v11, v57, v14
    v_min_u32 v14, v57, v14
    v_max_u32 v57, v13, v10
    v_min_u32 v10, v13, v10
    v_max_u32 v13, v8, v15
    v_min_u32 v15, v8, v15
    v_mov_b32 v32, v12
    v_mov_b32 v33, v9
    v_mov_b32 v34, v11
    v_mov_b32 v35, v14
    v_mov_b32 v36, v57
    v_mov_b32 v37, v10
    v_mov_b32 v38, v13
    v_mov_b32 v39, v15
    s_nop 1
    v_permlane32_swap_b32 v12, v32
    v_permlane32_swap_b32 v9, v33
    v_permlane32_swap_b32 v11, v34
    v_permlane32_swap_b32 v14, v35
    v_permlane32_swap_b32 v57, v36
    v_permlane32_swap_b32 v10, v37
    v_permlane32_swap_b32 v13, v38
    v_permlane32_swap_b32 v15, v39
    v_max_u32 v12, v12, v39
    v_max_u32 v9, v9, v38
    v_max_u32 v11, v11, v37
    v_max_u32 v14, v14, v36
    v_max_u32 v57, v57, v35
    v_max_u32 v10, v10, v34
    v_max_u32 v13, v13, v33
    v_max_u32 v15, v15, v32
    v_max_u32 v8, v12, v57
    v_min_u32 v57, v12, v57
    v_max_u32 v12, v9, v10
    v_min_u32 v10, v9, v10
    v_max_u32 v9, v11, v13
    v_min_u32 v13, v11, v13
    v_max_u32 v11, v14, v15
    v_min_u32 v15, v14, v15
    v_max_u32 v14, v8, v9
    v_min_u32 v9, v8, v9
    v_max_u32 v8, v12, v11
    v_min_u32 v11, v12, v11
    v_max_u32 v12, v57, v13
    v_min_u32 v13, v57, v13
    v_max_u32 v57, v10, v15
    v_min_u32 v15, v10, v15
    v_max_u32 v10, v14, v8
    v_min_u32 v8, v14, v8
    v_max_u32 v14, v9, v11
    v_min_u32 v11, v9, v11
    v_max_u32 v9, v12, v57
    v_min_u32 v57, v12, v57
    v_max_u32 v12, v13, v15
    v_min_u32 v15, v13, v15
    v_mov_b32 v32, v10
    v_mov_b32 v33, v8
    v_mov_b32 v34, v14
    v_mov_b32 v35, v11
    v_mov_b32 v36, v9
    v_mov_b32 v37, v57
    v_mov_b32 v38, v12
    v_mov_b32 v39, v15
    v_lshlrev_b32 v18, 3, v20
    ds_write_b128 v18, v[32:35] offset:4096
    ds_write_b128 v18, v[36:39] offset:4112
    s_waitcnt lgkmcnt(0)
    s_barrier
    v_xor_b32 v19, 32, v18
    ds_read_b128 v[32:35], v19 offset:4096
    ds_read_b128 v[36:39], v19 offset:4112
    v_xor_b32 v19, 64, v18
    ds_read_b128 v[40:43], v19 offset:4096
    ds_read_b128 v[44:47], v19 offset:4112
    s_waitcnt lgkmcnt(2)
    v_max_u32 v10, v10, v39
    v_max_u32 v8, v8, v38
    v_max_u32 v14, v14, v37
    v_max_u32 v11, v11, v36
    v_max_u32 v9, v9, v35
    v_max_u32 v57, v57, v34
    v_max_u32 v12, v12, v33
    v_max_u32 v15, v15, v32
    v_max_u32 v13, v10, v9
    v_min_u32 v9, v10, v9
    v_max_u32 v10, v8, v57
    v_min_u32 v57, v8, v57
    v_max_u32 v8, v14, v12
    v_min_u32 v12, v14, v12
    v_max_u32 v14, v11, v15
    v_min_u32 v15, v11, v15
    v_max_u32 v11, v13, v8
    v_min_u32 v8, v13, v8
    v_max_u32 v13, v10, v14
    v_min_u32 v14, v10, v14
    v_max_u32 v10, v9, v12
    v_min_u32 v12, v9, v12
    v_max_u32 v9, v57, v15
    v_min_u32 v15, v57, v15
    v_max_u32 v57, v11, v13
    v_min_u32 v13, v11, v13
    v_max_u32 v11, v8, v14
    v_min_u32 v14, v8, v14
    v_max_u32 v8, v10, v9
    v_min_u32 v9, v10, v9
    v_max_u32 v10, v12, v15
    v_min_u32 v15, v12, v15
    v_xor_b32 v19, 96, v18
    ds_read_b128 v[32:35], v19 offset:4096
    ds_read_b128 v[36:39], v19 offset:4112
    s_waitcnt lgkmcnt(2)
    v_max_u32 v57, v57, v47
    v_max_u32 v13, v13, v46
    v_max_u32 v11, v11, v45
    v_max_u32 v14, v14, v44
    v_max_u32 v8, v8, v43
    v_max_u32 v9, v9, v42
    v_max_u32 v10, v10, v41
    v_max_u32 v15, v15, v40
    v_max_u32 v12, v57, v8
    v_min_u32 v8, v57, v8
    v_max_u32 v57, v13, v9
    v_min_u32 v9, v13, v9
    v_max_u32 v13, v11, v10
    v_min_u32 v10, v11, v10
    v_max_u32 v11, v14, v15
    v_min_u32 v15, v14, v15
    v_max_u32 v14, v12, v13
    v_min_u32 v13, v12, v13
    v_max_u32 v12, v57, v11
    v_min_u32 v11, v57, v11
    v_max_u32 v57, v8, v10
    v_min_u32 v10, v8, v10
    v_max_u32 v8, v9, v15
    v_min_u32 v15, v9, v15
    v_max_u32 v9, v14, v12
    v_min_u32 v12, v14, v12
    v_max_u32 v14, v13, v11
    v_min_u32 v11, v13, v11
    v_max_u32 v13, v57, v8
    v_min_u32 v8, v57, v8
    v_max_u32 v57, v10, v15
    v_min_u32 v15, v10, v15
    s_waitcnt lgkmcnt(0)
    v_max_u32 v9, v9, v39
    v_max_u32 v12, v12, v38
    v_max_u32 v14, v14, v37
    v_max_u32 v11, v11, v36
    v_max_u32 v13, v13, v35
    v_max_u32 v8, v8, v34
    v_max_u32 v57, v57, v33
    v_max_u32 v15, v15, v32
    v_max_u32 v10, v9, v13
    v_min_u32 v13, v9, v13
    v_max_u32 v9, v12, v8
    v_min_u32 v8, v12, v8
    v_max_u32 v12, v14, v57
    v_min_u32 v57, v14, v57
    v_max_u32 v14, v11, v15
    v_min_u32 v15, v11, v15
    v_max_u32 v11, v10, v12
    v_min_u32 v12, v10, v12
    v_max_u32 v10, v9, v14
    v_min_u32 v14, v9, v14
    v_max_u32 v9, v13, v57
    v_min_u32 v57, v13, v57
    v_max_u32 v13, v8, v15
    v_min_u32 v15, v8, v15
    v_max_u32 v8, v11, v10
    v_min_u32 v10, v11, v10
    v_max_u32 v11, v12, v14
    v_min_u32 v14, v12, v14
    v_max_u32 v12, v9, v13
    v_min_u32 v13, v9, v13
    v_max_u32 v9, v57, v15
    v_min_u32 v15, v57, v15
    s_nop 0
    v_readfirstlane_b32 s40, v8
    v_readfirstlane_b32 s41, v10
    v_readfirstlane_b32 s42, v11
    v_readfirstlane_b32 s43, v14
    v_readfirstlane_b32 s44, v12
    v_readfirstlane_b32 s45, v13
    v_readfirstlane_b32 s46, v9
    v_readfirstlane_b32 s47, v15
    s_nop 3
    s_and_b32 s40, s40, 0xffff
    s_sub_u32 s40, 2047, s40
    s_and_b32 s41, s41, 0xffff
    s_sub_u32 s41, 2047, s41
    s_and_b32 s42, s42, 0xffff
    s_sub_u32 s42, 2047, s42
    s_and_b32 s43, s43, 0xffff
    s_sub_u32 s43, 2047, s43
    s_and_b32 s44, s44, 0xffff
    s_sub_u32 s44, 2047, s44
    s_and_b32 s45, s45, 0xffff
    s_sub_u32 s45, 2047, s45
    s_and_b32 s46, s46, 0xffff
    s_sub_u32 s46, 2047, s46
    s_and_b32 s47, s47, 0xffff
    s_sub_u32 s47, 2047, s47
    v_and_b32 v16, 7, v6
    v_mov_b32 v17, s40
    v_mov_b32 v18, s41
    v_cmp_eq_u32 vcc, 1, v16
    s_nop 1
    v_cndmask_b32 v17, v17, v18, vcc
    v_mov_b32 v18, s42
    v_cmp_eq_u32 vcc, 2, v16
    s_nop 1
    v_cndmask_b32 v17, v17, v18, vcc
    v_mov_b32 v18, s43
    v_cmp_eq_u32 vcc, 3, v16
    s_nop 1
    v_cndmask_b32 v17, v17, v18, vcc
    v_mov_b32 v18, s44
    v_cmp_eq_u32 vcc, 4, v16
    s_nop 1
    v_cndmask_b32 v17, v17, v18, vcc
    v_mov_b32 v18, s45
    v_cmp_eq_u32 vcc, 5, v16
    s_nop 1
    v_cndmask_b32 v17, v17, v18, vcc
    v_mov_b32 v18, s46
    v_cmp_eq_u32 vcc, 6, v16
    s_nop 1
    v_cndmask_b32 v17, v17, v18, vcc
    v_mov_b32 v18, s47
    v_cmp_eq_u32 vcc, 7, v16
    s_nop 1
    v_cndmask_b32 v17, v17, v18, vcc
    v_lshlrev_b32 v17, 10, v17
    v_lshl_add_u32 v17, v7, 4, v17
    buffer_load_dwordx4 v[64:67], v17, s[36:39], 0 offen offset:0 sc1
    buffer_load_dwordx4 v[68:71], v17, s[36:39], 0 offen offset:64 sc1
    buffer_load_dwordx4 v[72:75], v17, s[36:39], 0 offen offset:128 sc1
    buffer_load_dwordx4 v[76:79], v17, s[36:39], 0 offen offset:192 sc1
    buffer_load_dwordx4 v[80:83], v17, s[36:39], 0 offen offset:256 sc1
    buffer_load_dwordx4 v[84:87], v17, s[36:39], 0 offen offset:320 sc1
    buffer_load_dwordx4 v[88:91], v17, s[36:39], 0 offen offset:384 sc1
    buffer_load_dwordx4 v[92:95], v17, s[36:39], 0 offen offset:448 sc1
    buffer_load_dwordx4 v[96:99], v17, s[36:39], 0 offen offset:512 sc1
    buffer_load_dwordx4 v[100:103], v17, s[36:39], 0 offen offset:576 sc1
    buffer_load_dwordx4 v[104:107], v17, s[36:39], 0 offen offset:640 sc1
    buffer_load_dwordx4 v[108:111], v17, s[36:39], 0 offen offset:704 sc1
    buffer_load_dwordx4 v[112:115], v17, s[36:39], 0 offen offset:768 sc1
    buffer_load_dwordx4 v[116:119], v17, s[36:39], 0 offen offset:832 sc1
    buffer_load_dwordx4 v[120:123], v17, s[36:39], 0 offen offset:896 sc1
    buffer_load_dwordx4 v[124:127], v17, s[36:39], 0 offen offset:960 sc1
    v_lshrrev_b32 v18, 2, v6
    v_lshl_add_u32 v18, v7, 3, v18
    v_lshlrev_b32 v19, 6, v18
    v_and_b32 v20, 3, v6
    v_lshl_add_u32 v19, v20, 3, v19
    s_and_b32 s54, s52, 1
    s_lshl_b32 s54, s54, 5
    s_lshr_b32 s55, s52, 1
    s_lshl_b32 s55, s55, 15
    s_add_u32 s54, s54, s55
    v_add_u32 v19, s54, v19
    ds_read_b64_tr_b16 v[32:33], v19 offset:8192
    ds_read_b64_tr_b16 v[34:35], v19 offset:8448
    ds_read_b64_tr_b16 v[36:37], v19 offset:10240
    ds_read_b64_tr_b16 v[38:39], v19 offset:10496
    ds_read_b64_tr_b16 v[40:41], v19 offset:12288
    ds_read_b64_tr_b16 v[42:43], v19 offset:12544
    ds_read_b64_tr_b16 v[44:45], v19 offset:14336
    ds_read_b64_tr_b16 v[46:47], v19 offset:14592
    s_waitcnt lgkmcnt(0) vmcnt(12)
    v_mfma_f32_16x16x32_bf16 v[28:31], v[32:35], v[64:67], 0
    v_mfma_f32_16x16x32_bf16 v[28:31], v[36:39], v[68:71], v[28:31]
    v_mfma_f32_16x16x32_bf16 v[28:31], v[40:43], v[72:75], v[28:31]
    v_mfma_f32_16x16x32_bf16 v[28:31], v[44:47], v[76:79], v[28:31]
    ds_read_b64_tr_b16 v[48:49], v19 offset:16384
    ds_read_b64_tr_b16 v[50:51], v19 offset:16640
    ds_read_b64_tr_b16 v[52:53], v19 offset:18432
    ds_read_b64_tr_b16 v[54:55], v19 offset:18688
    ds_read_b64_tr_b16 v[56:57], v19 offset:20480
    ds_read_b64_tr_b16 v[58:59], v19 offset:20736
    ds_read_b64_tr_b16 v[60:61], v19 offset:22528
    ds_read_b64_tr_b16 v[62:63], v19 offset:22784
    s_waitcnt lgkmcnt(0) vmcnt(8)
    v_mfma_f32_16x16x32_bf16 v[28:31], v[48:51], v[80:83], v[28:31]
    v_mfma_f32_16x16x32_bf16 v[28:31], v[52:55], v[84:87], v[28:31]
    v_mfma_f32_16x16x32_bf16 v[28:31], v[56:59], v[88:91], v[28:31]
    v_mfma_f32_16x16x32_bf16 v[28:31], v[60:63], v[92:95], v[28:31]
    ds_read_b64_tr_b16 v[32:33], v19 offset:24576
    ds_read_b64_tr_b16 v[34:35], v19 offset:24832
    ds_read_b64_tr_b16 v[36:37], v19 offset:26624
    ds_read_b64_tr_b16 v[38:39], v19 offset:26880
    ds_read_b64_tr_b16 v[40:41], v19 offset:28672
    ds_read_b64_tr_b16 v[42:43], v19 offset:28928
    ds_read_b64_tr_b16 v[44:45], v19 offset:30720
    ds_read_b64_tr_b16 v[46:47], v19 offset:30976
    s_waitcnt lgkmcnt(0) vmcnt(4)
    v_mfma_f32_16x16x32_bf16 v[28:31], v[32:35], v[96:99], v[28:31]
    v_mfma_f32_16x16x32_bf16 v[28:31], v[36:39], v[100:103], v[28:31]
    v_mfma_f32_16x16x32_bf16 v[28:31], v[40:43], v[104:107], v[28:31]
    v_mfma_f32_16x16x32_bf16 v[28:31], v[44:47], v[108:111], v[28:31]
    ds_read_b64_tr_b16 v[48:49], v19 offset:32768
    ds_read_b64_tr_b16 v[50:51], v19 offset:33024
    ds_read_b64_tr_b16 v[52:53], v19 offset:34816
    ds_read_b64_tr_b16 v[54:55], v19 offset:35072
    ds_read_b64_tr_b16 v[56:57], v19 offset:36864
    ds_read_b64_tr_b16 v[58:59], v19 offset:37120
    ds_read_b64_tr_b16 v[60:61], v19 offset:38912
    ds_read_b64_tr_b16 v[62:63], v19 offset:39168
    s_waitcnt lgkmcnt(0) vmcnt(0)
    v_mfma_f32_16x16x32_bf16 v[28:31], v[48:51], v[112:115], v[28:31]
    v_mfma_f32_16x16x32_bf16 v[28:31], v[52:55], v[116:119], v[28:31]
    v_mfma_f32_16x16x32_bf16 v[28:31], v[56:59], v[120:123], v[28:31]
    v_mfma_f32_16x16x32_bf16 v[28:31], v[60:63], v[124:127], v[28:31]
    s_nop 15
    v_lshlrev_b32 v20, 7, v6
    v_lshl_add_u32 v20, v7, 4, v20
    s_and_b32 s54, s52, 1
    s_lshl_b32 s54, s54, 6
    s_lshr_b32 s55, s52, 1
    s_lshl_b32 s55, s55, 11
    s_add_u32 s54, s54, s55
    v_add_u32 v20, s54, v20
    ds_write_b128 v20, v[28:31] offset:0
    s_waitcnt lgkmcnt(0)
    s_barrier
    v_lshlrev_b32 v20, 2, v0
    ds_read_b32 v21, v20 offset:0
    ds_read_b32 v22, v20 offset:2048
    s_waitcnt lgkmcnt(0)
    v_cvt_pk_bf16_f32 v24, v21, v22
    v_lshlrev_b32 v21, 16, v24
    v_and_b32 v22, 0xffff0000, v24
    v_mul_f32 v24, 0xbfb8aa3b, v21
    v_exp_f32 v24, v24
    s_nop 0
    v_add_f32 v24, 1.0, v24
    v_rcp_f32 v24, v24
    s_nop 0
    v_mul_f32 v21, v21, v24
    v_cvt_pk_bf16_f32 v21, v21, v21
    v_lshlrev_b32 v21, 16, v21
    v_mul_f32 v21, v21, v22
    v_cvt_pk_bf16_f32 v21, v21, v21
    v_lshlrev_b32 v20, 1, v0
    ds_write_b16 v20, v21 offset:6144
    s_waitcnt lgkmcnt(0)
    s_barrier
    v_lshlrev_b32 v20, 6, v16
    v_lshl_add_u32 v20, v7, 4, v20
    ds_read_b128 v[24:27], v20 offset:6144
    s_mov_b32 s53, 1056
    v_mul_lo_u32 v21, v18, s53
    v_and_b32 v22, 3, v6
    v_lshl_add_u32 v21, v22, 3, v21
    s_lshl_b32 s54, s52, 8
    s_add_u32 s54, s54, 73728
    v_add_u32 v21, s54, v21
    ds_read_b64_tr_b16 v[32:33], v21 offset:0
    ds_read_b64_tr_b16 v[34:35], v21 offset:4224
    ds_read_b64_tr_b16 v[36:37], v21 offset:32
    ds_read_b64_tr_b16 v[38:39], v21 offset:4256
    ds_read_b64_tr_b16 v[40:41], v21 offset:64
    ds_read_b64_tr_b16 v[42:43], v21 offset:4288
    ds_read_b64_tr_b16 v[44:45], v21 offset:96
    ds_read_b64_tr_b16 v[46:47], v21 offset:4320
    s_waitcnt lgkmcnt(0)
    ds_read_b64_tr_b16 v[48:49], v21 offset:128
    ds_read_b64_tr_b16 v[50:51], v21 offset:4352
    ds_read_b64_tr_b16 v[52:53], v21 offset:160
    ds_read_b64_tr_b16 v[54:55], v21 offset:4384
    ds_read_b64_tr_b16 v[56:57], v21 offset:192
    ds_read_b64_tr_b16 v[58:59], v21 offset:4416
    ds_read_b64_tr_b16 v[60:61], v21 offset:224
    ds_read_b64_tr_b16 v[62:63], v21 offset:4448
    s_waitcnt lgkmcnt(0)
    v_mfma_f32_16x16x32_bf16 v[64:67], v[32:35], v[24:27], 0
    v_mfma_f32_16x16x32_bf16 v[68:71], v[36:39], v[24:27], 0
    v_mfma_f32_16x16x32_bf16 v[72:75], v[40:43], v[24:27], 0
    v_mfma_f32_16x16x32_bf16 v[76:79], v[44:47], v[24:27], 0
    v_mfma_f32_16x16x32_bf16 v[80:83], v[48:51], v[24:27], 0
    v_mfma_f32_16x16x32_bf16 v[84:87], v[52:55], v[24:27], 0
    v_mfma_f32_16x16x32_bf16 v[88:91], v[56:59], v[24:27], 0
    v_mfma_f32_16x16x32_bf16 v[92:95], v[60:63], v[24:27], 0
    v_lshlrev_b32 v20, 11, v6
    v_lshl_add_u32 v20, v7, 4, v20
    s_lshl_b32 s54, s2, 14
    s_lshl_b32 s55, s52, 9
    s_add_u32 s54, s54, s55
    v_add_u32 v20, s54, v20
    v_cmp_gt_u32 vcc, 8, v6
    s_nop 7
    s_and_saveexec_b64 s[48:49], vcc
    buffer_store_dwordx4 v[64:67], v20, s[92:95], 0 offen offset:0 sc1
    buffer_store_dwordx4 v[68:71], v20, s[92:95], 0 offen offset:64 sc1
    buffer_store_dwordx4 v[72:75], v20, s[92:95], 0 offen offset:128 sc1
    buffer_store_dwordx4 v[76:79], v20, s[92:95], 0 offen offset:192 sc1
    buffer_store_dwordx4 v[80:83], v20, s[92:95], 0 offen offset:256 sc1
    buffer_store_dwordx4 v[84:87], v20, s[92:95], 0 offen offset:320 sc1
    buffer_store_dwordx4 v[88:91], v20, s[92:95], 0 offen offset:384 sc1
    buffer_store_dwordx4 v[92:95], v20, s[92:95], 0 offen offset:448 sc1
    s_mov_b64 exec, s[48:49]
    s_waitcnt vmcnt(0) lgkmcnt(0)
    s_barrier
    v_mov_b32 v5, 1
    s_lshl_b32 s58, s2, 6
    s_add_u32 s58, s58, 16384
    v_mov_b32 v6, s58
    v_cmp_eq_u32 vcc, 0, v0
    s_and_saveexec_b64 s[48:49], vcc
    buffer_store_dword v5, v6, s[76:79], 0 offen sc1
    s_mov_b64 exec, s[48:49]
    s_cmp_ge_u32 s2, 16
    s_cbranch_scc1 L_k5_done
    s_lshr_b32 s53, s2, 1
    s_mov_b32 s54, s40
    s_cmp_eq_u32 s53, 1
    s_cselect_b32 s54, s41, s54
    s_cmp_eq_u32 s53, 2
    s_cselect_b32 s54, s42, s54
    s_cmp_eq_u32 s53, 3
    s_cselect_b32 s54, s43, s54
    s_cmp_eq_u32 s53, 4
    s_cselect_b32 s54, s44, s54
    s_cmp_eq_u32 s53, 5
    s_cselect_b32 s54, s45, s54
    s_cmp_eq_u32 s53, 6
    s_cselect_b32 s54, s46, s54
    s_cmp_eq_u32 s53, 7
    s_cselect_b32 s54, s47, s54
    s_lshl_b32 s53, s2, 8
    v_add_u32 v1, s53, v0
    v_lshlrev_b32 v2, 2, v1
    v_and_b32 v3, 511, v1
    s_lshl_b32 s55, s54, 10
    v_lshl_add_u32 v4, v3, 1, s55
    s_lshl_b32 s55, s54, 2
    v_mov_b32 v5, s55
    v_lshlrev_b32 v6, 2, v3
    v_and_b32 v7, 0xfffffffc, v4
    buffer_load_dword v67, v7, s[36:39], 0 offen sc1
    buffer_load_dword v68, v7, s[32:35], 0 offen sc1
    buffer_load_dword v69, v5, s[72:75], 0 offen sc1
    s_mov_b32 s53, 10240
    buffer_load_dword v70, v6, s[12:15], s53 offen
    s_cmp_lg_u32 s52, 0
    s_cbranch_scc1 L_polldone2
    v_min_u32 v76, 55, v0
    v_lshlrev_b32 v76, 6, v76
    v_add_u32 v76, 16384, v76
L_poll2:
    buffer_load_dword v72, v76, s[76:79], 0 offen sc1
    s_waitcnt vmcnt(0)
    v_cmp_ne_u32 vcc, 1, v72
    s_nop 1
    s_cbranch_vccz L_polldone2
    s_sleep 1
    s_branch L_poll2
L_polldone2:
    s_barrier
    s_mov_b32 s53, 0
    buffer_load_dword v8, v2, s[92:95], s53 offen sc1
    s_mov_b32 s53, 16384
    buffer_load_dword v9, v2, s[92:95], s53 offen sc1
    s_mov_b32 s53, 32768
    buffer_load_dword v10, v2, s[92:95], s53 offen sc1
    s_mov_b32 s53, 49152
    buffer_load_dword v11, v2, s[92:95], s53 offen sc1
    s_mov_b32 s53, 65536
    buffer_load_dword v12, v2, s[92:95], s53 offen sc1
    s_mov_b32 s53, 81920
    buffer_load_dword v13, v2, s[92:95], s53 offen sc1
    s_mov_b32 s53, 98304
    buffer_load_dword v14, v2, s[92:95], s53 offen sc1
    s_mov_b32 s53, 114688
    buffer_load_dword v15, v2, s[92:95], s53 offen sc1
    s_mov_b32 s53, 131072
    buffer_load_dword v16, v2, s[92:95], s53 offen sc1
    s_mov_b32 s53, 147456
    buffer_load_dword v17, v2, s[92:95], s53 offen sc1
    s_mov_b32 s53, 163840
    buffer_load_dword v18, v2, s[92:95], s53 offen sc1
    s_mov_b32 s53, 180224
    buffer_load_dword v19, v2, s[92:95], s53 offen sc1
    s_mov_b32 s53, 196608
    buffer_load_dword v20, v2, s[92:95], s53 offen sc1
    s_mov_b32 s53, 212992
    buffer_load_dword v21, v2, s[92:95], s53 offen sc1
    s_mov_b32 s53, 229376
    buffer_load_dword v22, v2, s[92:95], s53 offen sc1
    s_mov_b32 s53, 245760
    buffer_load_dword v23, v2, s[92:95], s53 offen sc1
    s_mov_b32 s53, 262144
    buffer_load_dword v24, v2, s[92:95], s53 offen sc1
    s_mov_b32 s53, 278528
    buffer_load_dword v25, v2, s[92:95], s53 offen sc1
    s_mov_b32 s53, 294912
    buffer_load_dword v26, v2, s[92:95], s53 offen sc1
    s_mov_b32 s53, 311296
    buffer_load_dword v27, v2, s[92:95], s53 offen sc1
    s_mov_b32 s53, 327680
    buffer_load_dword v28, v2, s[92:95], s53 offen sc1
    s_mov_b32 s53, 344064
    buffer_load_dword v29, v2, s[92:95], s53 offen sc1
    s_mov_b32 s53, 360448
    buffer_load_dword v30, v2, s[92:95], s53 offen sc1
    s_mov_b32 s53, 376832
    buffer_load_dword v31, v2, s[92:95], s53 offen sc1
    s_mov_b32 s53, 393216
    buffer_load_dword v32, v2, s[92:95], s53 offen sc1
    s_mov_b32 s53, 409600
    buffer_load_dword v33, v2, s[92:95], s53 offen sc1
    s_mov_b32 s53, 425984
    buffer_load_dword v34, v2, s[92:95], s53 offen sc1
    s_mov_b32 s53, 442368
    buffer_load_dword v35, v2, s[92:95], s53 offen sc1
    s_mov_b32 s53, 458752
    buffer_load_dword v36, v2, s[92:95], s53 offen sc1
    s_mov_b32 s53, 475136
    buffer_load_dword v37, v2, s[92:95], s53 offen sc1
    s_mov_b32 s53, 491520
    buffer_load_dword v38, v2, s[92:95], s53 offen sc1
    s_mov_b32 s53, 507904
    buffer_load_dword v39, v2, s[92:95], s53 offen sc1
    s_mov_b32 s53, 524288
    buffer_load_dword v40, v2, s[92:95], s53 offen sc1
    s_mov_b32 s53, 540672
    buffer_load_dword v41, v2, s[92:95], s53 offen sc1
    s_mov_b32 s53, 557056
    buffer_load_dword v42, v2, s[92:95], s53 offen sc1
    s_mov_b32 s53, 573440
    buffer_load_dword v43, v2, s[92:95], s53 offen sc1
    s_mov_b32 s53, 589824
    buffer_load_dword v44, v2, s[92:95], s53 offen sc1
    s_mov_b32 s53, 606208
    buffer_load_dword v45, v2, s[92:95], s53 offen sc1
    s_mov_b32 s53, 622592
    buffer_load_dword v46, v2, s[92:95], s53 offen sc1
    s_mov_b32 s53, 638976
    buffer_load_dword v47, v2, s[92:95], s53 offen sc1
    s_mov_b32 s53, 655360
    buffer_load_dword v48, v2, s[92:95], s53 offen sc1
    s_mov_b32 s53, 671744
    buffer_load_dword v49, v2, s[92:95], s53 offen sc1
    s_mov_b32 s53, 688128
    buffer_load_dword v50, v2, s[92:95], s53 offen sc1
    s_mov_b32 s53, 704512
    buffer_load_dword v51, v2, s[92:95], s53 offen sc1
    s_mov_b32 s53, 720896
    buffer_load_dword v52, v2, s[92:95], s53 offen sc1
    s_mov_b32 s53, 737280
    buffer_load_dword v53, v2, s[92:95], s53 offen sc1
    s_mov_b32 s53, 753664
    buffer_load_dword v54, v2, s[92:95], s53 offen sc1
    s_mov_b32 s53, 770048
    buffer_load_dword v55, v2, s[92:95], s53 offen sc1
    s_mov_b32 s53, 786432
    buffer_load_dword v56, v2, s[92:95], s53 offen sc1
    s_mov_b32 s53, 802816
    buffer_load_dword v57, v2, s[92:95], s53 offen sc1
    s_mov_b32 s53, 819200
    buffer_load_dword v58, v2, s[92:95], s53 offen sc1
    s_mov_b32 s53, 835584
    buffer_load_dword v59, v2, s[92:95], s53 offen sc1
    s_mov_b32 s53, 851968
    buffer_load_dword v60, v2, s[92:95], s53 offen sc1
    s_mov_b32 s53, 868352
    buffer_load_dword v61, v2, s[92:95], s53 offen sc1
    s_mov_b32 s53, 884736
    buffer_load_dword v62, v2, s[92:95], s53 offen sc1
    s_mov_b32 s53, 901120
    buffer_load_dword v63, v2, s[92:95], s53 offen sc1
    s_waitcnt vmcnt(56)
    v_and_b32 v7, 1, v3
    v_lshlrev_b32 v7, 4, v7
    v_lshrrev_b32 v67, v7, v67
    v_lshrrev_b32 v68, v7, v68
    v_lshlrev_b32 v67, 16, v67
    v_lshlrev_b32 v68, 16, v68
    v_mul_f32 v71, 0xbfb8aa3b, v69
    v_exp_f32 v71, v71
    s_nop 0
    v_add_f32 v71, 1.0, v71
    v_rcp_f32 v71, v71
    s_nop 0
    v_cvt_pk_bf16_f32 v71, v71, v71
    v_lshlrev_b32 v71, 16, v71
    s_waitcnt vmcnt(0)
    v_add_f32 v8, v8, v9
    v_add_f32 v10, v10, v11
    v_add_f32 v12, v12, v13
    v_add_f32 v14, v14, v15
    v_add_f32 v16, v16, v17
    v_add_f32 v18, v18, v19
    v_add_f32 v20, v20, v21
    v_add_f32 v22, v22, v23
    v_add_f32 v24, v24, v25
    v_add_f32 v26, v26, v27
    v_add_f32 v28, v28, v29
    v_add_f32 v30, v30, v31
    v_add_f32 v32, v32, v33
    v_add_f32 v34, v34, v35
    v_add_f32 v36, v36, v37
    v_add_f32 v38, v38, v39
    v_add_f32 v40, v40, v41
    v_add_f32 v42, v42, v43
    v_add_f32 v44, v44, v45
    v_add_f32 v46, v46, v47
    v_add_f32 v48, v48, v49
    v_add_f32 v50, v50, v51
    v_add_f32 v52, v52, v53
    v_add_f32 v54, v54, v55
    v_add_f32 v56, v56, v57
    v_add_f32 v58, v58, v59
    v_add_f32 v60, v60, v61
    v_add_f32 v62, v62, v63
    v_add_f32 v8, v8, v10
    v_add_f32 v12, v12, v14
    v_add_f32 v16, v16, v18
    v_add_f32 v20, v20, v22
    v_add_f32 v24, v24, v26
    v_add_f32 v28, v28, v30
    v_add_f32 v32, v32, v34
    v_add_f32 v36, v36, v38
    v_add_f32 v40, v40, v42
    v_add_f32 v44, v44, v46
    v_add_f32 v48, v48, v50
    v_add_f32 v52, v52, v54
    v_add_f32 v56, v56, v58
    v_add_f32 v60, v60, v62
    v_add_f32 v8, v8, v12
    v_add_f32 v16, v16, v20
    v_add_f32 v24, v24, v28
    v_add_f32 v32, v32, v36
    v_add_f32 v40, v40, v44
    v_add_f32 v48, v48, v52
    v_add_f32 v56, v56, v60
    v_add_f32 v8, v8, v16
    v_add_f32 v24, v24, v32
    v_add_f32 v40, v40, v48
    v_add_f32 v8, v8, v24
    v_add_f32 v40, v40, v56
    v_add_f32 v8, v8, v40
    v_cvt_pk_bf16_f32 v8, v8, v8
    v_lshlrev_b32 v8, 16, v8
    v_mul_f32 v8, v8, v71
    v_cvt_pk_bf16_f32 v8, v8, v8
    v_lshlrev_b32 v8, 16, v8
    v_add_f32 v8, v8, v67
    v_cvt_pk_bf16_f32 v8, v8, v8
    v_lshlrev_b32 v8, 16, v8
    v_mul_f32 v8, v8, v70
    v_cvt_pk_bf16_f32 v8, v8, v8
    v_lshlrev_b32 v8, 16, v8
    v_add_f32 v8, v8, v68
    v_cvt_pk_bf16_f32 v8, v8, v8
    buffer_store_short v8, v4, s[28:31], 0 offen sc1
    s_waitcnt vmcnt(0)
L_k5_done:
    s_endpgm
.section .rodata,"a"
.p2align 6
.amdhsa_kernel k1_mod_kernel
  .amdhsa_next_free_vgpr 112
  .amdhsa_next_free_sgpr 102
  .amdhsa_accum_offset 112
  .amdhsa_group_segment_fixed_size 0
  .amdhsa_kernarg_size 120
  .amdhsa_user_sgpr_count 2
  .amdhsa_user_sgpr_kernarg_segment_ptr 1
  .amdhsa_system_sgpr_workgroup_id_x 1
.end_amdhsa_kernel
.p2align 6
.amdhsa_kernel k2_ln1_kernel
  .amdhsa_next_free_vgpr 56
  .amdhsa_next_free_sgpr 102
  .amdhsa_accum_offset 56
  .amdhsa_group_segment_fixed_size 0
  .amdhsa_kernarg_size 120
  .amdhsa_user_sgpr_count 2
  .amdhsa_user_sgpr_kernarg_segment_ptr 1
  .amdhsa_system_sgpr_workgroup_id_x 1
.end_amdhsa_kernel
.p2align 6
.amdhsa_kernel k3_attn_kernel
  .amdhsa_next_free_vgpr 256
  .amdhsa_next_free_sgpr 102
  .amdhsa_accum_offset 256
  .amdhsa_group_segment_fixed_size 0
  .amdhsa_kernarg_size 120
  .amdhsa_user_sgpr_count 2
  .amdhsa_user_sgpr_kernarg_segment_ptr 1
  .amdhsa_system_sgpr_workgroup_id_x 1
.end_amdhsa_kernel
.p2align 6
.amdhsa_kernel k5_tail_kernel
  .amdhsa_next_free_vgpr 128
  .amdhsa_next_free_sgpr 102
  .amdhsa_accum_offset 128
  .amdhsa_group_segment_fixed_size 0
  .amdhsa_kernarg_size 120
  .amdhsa_user_sgpr_count 2
  .amdhsa_user_sgpr_kernarg_segment_ptr 1
  .amdhsa_system_sgpr_workgroup_id_x 1
.end_amdhsa_kernel
```
